```python
import torch

def _softmax(x, axis=-1):
    return torch.softmax(x, dim=axis)
def _gelu(x):
    return torch.nn.functional.gelu(x, approximate="tanh")
def _silu(x):
    return torch.nn.functional.silu(x)
def _sigmoid(x):
    return torch.sigmoid(x)
def _layernorm(x, axis=-1, eps=1e-5):
    m = x.mean(dim=axis, keepdim=True)
    v = x.var(dim=axis, keepdim=True, unbiased=False)
    return (x - m) / torch.sqrt(v + eps)
def _scatter_add(tgt, idx, src, axis=0):
    return tgt.clone().index_add_(axis, idx, src)
def _segment_sum(src, seg, n):
    out = torch.zeros((n,) + src.shape[1:], dtype=src.dtype)
    return out.index_add_(0, seg, src)
def _pad(x, pw):
    flat = tuple(v for pair in reversed(pw) for v in pair)
    return torch.nn.functional.pad(x, flat)

kernel_name = 'sequential_preLN__ssm_conv_h3__glu_gated_glu__prompt'

def setup_inputs():

    _w = (lambda a: (lambda t: t.to(torch.bfloat16) if t.is_floating_point() else t)(torch.as_tensor(a)))
    def _A_setup():
        B, S, D = 1, 2048, 512
        ks = 4
        return {
            "q": _w((lambda *s: torch.randn(*s, dtype=torch.bfloat16) * 0.05)(B, S, D)),
            "k": _w((lambda *s: torch.randn(*s, dtype=torch.bfloat16) * 0.4)(B, S, D)),
            "v": _w((lambda *s: torch.randn(*s, dtype=torch.bfloat16) * 0.4)(B, S, D)),
            "shift_k": _w((lambda *s: torch.randn(*s, dtype=torch.bfloat16) * 0.4)(D, ks) * 0.5),
            "ssm_k": _w((lambda *s: torch.randn(*s, dtype=torch.bfloat16) * 0.4)(D, S) * (1.0 / S ** 0.5)),
            "ssm_D": _w((lambda *s: torch.randn(*s, dtype=torch.bfloat16) * 0.4)(D)),
        }
    _A_in = _A_setup()

    def _B_setup():
        B, S, D, F = 1, 2048, 512, 1792
        return {
            "x": _w((lambda *s: torch.randn(*s, dtype=torch.bfloat16) * 0.05)(B, S, D)),
            "w_gate": _w((lambda *s: torch.randn(*s, dtype=torch.bfloat16) * 0.05)(D, F)),
            "w_up": _w((lambda *s: torch.randn(*s, dtype=torch.bfloat16) * 0.05)(D, F)),
            "w_down": _w((lambda *s: torch.randn(*s, dtype=torch.bfloat16) * 0.05)(F, D)),
        }
    _B_in = _B_setup()

    return {
        "A_q": _A_in["q"],
        "A_k": _A_in["k"],
        "A_v": _A_in["v"],
        "A_shift_k": _A_in["shift_k"],
        "A_ssm_k": _A_in["ssm_k"],
        "A_ssm_D": _A_in["ssm_D"],
        "B_x": _B_in["x"],
        "B_w_gate": _B_in["w_gate"],
        "B_w_up": _B_in["w_up"],
        "B_w_down": _B_in["w_down"],
    }

def reference(A_q, A_k, A_v, A_shift_k, A_ssm_k, A_ssm_D, B_x, B_w_gate, B_w_up, B_w_down):
    def _A_ref(q, k, v, shift_k, ssm_k, ssm_D):
        B, S, D = q.shape
        ks = shift_k.shape[-1]
        k_pad = _pad(k, ((0, 0), (ks - 1, 0), (0, 0)))
        k_shift = torch.zeros_like(k)
        for t in range(ks):
            k_shift = k_shift + k_pad[:, t:t + S, :] * shift_k[:, ks - 1 - t][None, None, :]
        kv = k_shift * v
        L = 2 * S
        kv_pad = _pad(kv, ((0, 0), (0, S), (0, 0)))
        kf_pad = _pad(ssm_k, ((0, 0), (0, S)))
        kv_f = (lambda x, axes=(-2,-1): torch.fft.rfft2(x.float(), dim=axes))(kv_pad[:, None, :, :], axes=(1, 2))
        kf_f = (lambda x, axes=(-2,-1): torch.fft.rfft2(x.float(), dim=axes))(kf_pad[:, None, :], axes=(1, 2))
        kf_f = (lambda x, *d: x.permute(*d))(kf_f, 1, 2, 0)
        y_f = kv_f * kf_f[None, :, :, :]
        y = (lambda x, s, axes=(-2,-1): torch.fft.irfft2(x, s=s, dim=axes).to(torch.bfloat16))(y_f, (1, L), axes=(1, 2))[:, 0, :S, :]
        y = y + kv * ssm_D[None, None, :]
        return q * y

    def _B_ref(x, w_gate, w_up, w_down):
        g = torch.einsum("bsd,df->bsf", x, w_gate)
        u = torch.einsum("bsd,df->bsf", x, w_up)
        h = _sigmoid(g) * u
        return torch.einsum("bsf,fd->bsd", h, w_down)

    x = A_q
    h = x + _A_ref(_layernorm(x, axis=-1), A_k, A_v, A_shift_k, A_ssm_k, A_ssm_D)
    h2 = h + _B_ref(_layernorm(h, axis=-1), B_w_gate, B_w_up, B_w_down)
    return h2
```

```asm
; @launch grid=(256,1,1) block=(256,1,1) lds=163840
.amdgcn_target "amdgcn-amd-amdhsa--gfx950"
.text
.globl sequential_preLN__ssm_conv_h3__glu_gated_glu__prompt_kernel
.p2align 8
.type sequential_preLN__ssm_conv_h3__glu_gated_glu__prompt_kernel,@function
sequential_preLN__ssm_conv_h3__glu_gated_glu__prompt_kernel:
    s_load_dwordx16 s[4:19], s[0:1], 0
    s_load_dwordx8 s[20:27], s[0:1], 64
    s_load_dwordx2 s[28:29], s[0:1], 96
    s_cmp_ge_u32 s2, 256
    s_cbranch_scc1 L_end
    s_getpc_b64 s[58:59]
L_pc:
    v_lshrrev_b32 v1, 6, v0
    s_and_b32 s44, s2, 7
    v_readfirstlane_b32 s3, v1
    s_lshr_b32 s45, s2, 3
    v_lshrrev_b32 v10, 4, v0
    v_min_u32 v10, 9, v10
    v_lshlrev_b32 v10, 7, v10
    s_mul_i32 s49, s45, 1280
    v_add_u32 v10, s49, v10
    v_min_u32 v10, L_end0-L_pc, v10
    global_load_dword v11, v10, s[58:59]
    v_and_b32 v2, 63, v0
    v_and_b32 v3, 7, v0
    v_lshrrev_b32 v4, 3, v0
    s_lshl_b32 s51, s44, 2
    s_and_b32 s52, s45, 3
    s_add_u32 s51, s51, s52
    s_lshr_b32 s52, s45, 2
    s_xor_b32 s52, s52, 4
    s_lshl_b32 s49, s51, 16
    s_lshl_b32 s50, s52, 7
    s_add_u32 s49, s49, s50
    v_lshlrev_b32 v5, 11, v4
    v_lshl_add_u32 v5, v3, 4, v5
    v_add_u32 v5, s49, v5
    s_lshl_b32 s53, s44, 5
    s_add_u32 s53, s53, s45
    s_lshl_b32 s49, s53, 13
    v_lshrrev_b32 v12, 5, v0
    v_lshlrev_b32 v12, 10, v12
    v_and_b32 v13, 31, v0
    v_lshl_add_u32 v12, v13, 4, v12
    v_add_u32 v12, s49, v12
    v_lshrrev_b32 v6, 3, v2
    v_lshlrev_b32 v6, 10, v6
    v_sub_u32 v6, v5, v6
    v_add_u32 v7, 0xffffe000, v6
    s_mul_i32 s50, s3, 3072
    s_add_u32 s79, s50, 43008
    s_add_u32 m0, s79, 1024
    s_movk_i32 s65, 7168
    s_lshl_b32 s50, s52, 9
    v_lshl_add_u32 v9, v2, 3, s50
    s_mov_b32 s34, 0x200000
    s_mov_b32 s35, 0x20000
    s_waitcnt lgkmcnt(0)
    s_mov_b32 s32, s6
    s_and_b32 s33, s7, 0xffff
    buffer_load_dwordx4 v6, s[32:35], 0 offen lds
    buffer_load_dwordx4 v6, s[32:35], s65 offen offset:1024 lds
    s_mov_b32 m0, s79
    s_mov_b32 exec_lo, 0
    s_mov_b32 exec_hi, 0xffffff00
    buffer_load_dwordx4 v7, s[32:35], 0 offen lds
    s_mov_b64 exec, -1
    global_load_dwordx2 v[182:183], v9, s[10:11]
    s_barrier
    v_xor_b32 v8, 256, v5
    global_load_dwordx4 v[44:47], v8, s[4:5]
    global_load_dwordx4 v[48:51], v8, s[4:5] offset:1024
    global_load_dwordx4 v[68:71], v12, s[4:5]
    global_load_dwordx4 v[72:75], v12, s[4:5] offset:512
    s_barrier
    global_load_dwordx4 v[36:39], v5, s[8:9]
    global_load_dwordx4 v[40:43], v5, s[8:9] offset:1024
    s_lshl_b32 s50, s53, 2
    v_mov_b32 v18, s50
    v_mov_b32 v19, 0
    global_load_dword v91, v18, s[14:15]
    global_load_dword v159, v19, s[28:29]
    v_lshlrev_b32 v13, 4, v0
    v_add_u32 v13, s49, v13
    v_add_u32 v14, 4096, v13
    v_subrev_u32 v15, 4, v13
    v_max_i32 v15, 0, v15
    s_mov_b32 s46, 0x05040100
    s_mov_b32 s47, 0x07060302
    s_mov_b32 s48, 0x3f803f80
    s_mov_b32 s76, 0xffff0000
    s_lshr_b32 s56, s3, 1
    s_mul_i32 s56, s56, 40960
    s_add_u32 s55, s56, 65536
    s_and_b32 s54, s3, 1
    s_lshl_b32 s56, s54, 12
    s_add_u32 s56, s56, s55
    s_lshl_b32 s77, s53, 7
    v_sub_u32 v6, 31, v4
    v_lshrrev_b32 v7, 2, v6
    v_xor_b32 v7, v7, v3
    v_lshlrev_b32 v7, 4, v7
    v_and_b32 v6, 3, v6
    v_lshl_add_u32 v6, v6, 2, v7
    v_lshl_add_u32 v154, v3, 10, v6
    v_lshrrev_b32 v7, 2, v4
    v_xor_b32 v7, v7, v3
    v_lshlrev_b32 v7, 4, v7
    v_and_b32 v8, 3, v4
    v_lshl_add_u32 v7, v8, 2, v7
    v_lshl_add_u32 v155, v3, 10, v7
    v_mov_b32 v90, 0
    v_and_b32 v8, 127, v0
    v_lshlrev_b32 v8, 2, v8
    v_lshrrev_b32 v9, 7, v0
    v_mul_u32_u24 v9, 4608, v9
    v_add_u32 v8, v8, v9
    ds_write_b32 v8, v90 offset:37376
    v_bfe_u32 v9, v0, 3, 2
    v_mul_u32_u24 v9, 4160, v9
    v_lshl_add_u32 v9, v3, 2, v9
    ds_write_b32 v9, v90 offset:16384
    v_xor_b32 v86, v3, v1
    v_lshlrev_b32 v86, 4, v86
    v_lshl_add_u32 v86, v4, 7, v86
    v_xor_b32 v87, 64, v86
    s_lshl_b32 s49, s52, 18
    s_lshl_b32 s50, s51, 7
    v_lshlrev_b32 v88, 12, v4
    v_lshl_add_u32 v88, v3, 4, v88
    v_add_u32 v88, s49, v88
    v_add_u32 v89, s50, v88
    v_xor_b32 v89, 524288, v89
    s_sub_u32 s50, 3968, s50
    v_add_u32 v88, s50, v88
    v_add_u32 v148, 0x20000, v88
    v_add_u32 v149, 0x20000, v89
    v_lshrrev_b32 v150, 5, v0
    v_lshlrev_b32 v150, 2, v150
    v_add_u32 v150, 42496, v150
    v_lshlrev_b32 v151, 4, v0
    v_min_u32 v152, 48, v151
    s_lshl_b32 s49, s53, 6
    s_add_u32 s49, s49, 131072
    v_add_u32 v153, s49, v151
    v_lshlrev_b32 v156, 3, v0
    v_lshlrev_b32 v157, 9, v1
    v_lshl_add_u32 v157, v3, 6, v157
    v_lshrrev_b32 v158, 3, v2
    v_lshlrev_b32 v158, 8, v158
    v_lshl_add_u32 v158, v3, 4, v158
    v_add_u32 v158, s79, v158
    v_lshlrev_b32 v180, 15, v4
    v_lshl_add_u32 v180, v3, 4, v180
    s_add_u32 s50, s77, 5242880
    v_add_u32 v180, s50, v180
    v_mov_b32 v176, -1
    v_mov_b32 v177, -1
    v_mov_b32 v178, -1
    v_mov_b32 v179, -1
    s_and_b32 s49, s44, 3
    s_mul_i32 s50, s49, 28
    s_add_u32 s50, s50, s45
    s_lshl_b32 s49, s49, 2
    s_add_u32 s49, s49, s45
    s_sub_u32 s49, s49, 28
    s_and_b32 s57, s44, 1
    s_lshl_b32 s57, s57, 5
    s_sub_u32 s57, s50, s57
    s_cmp_lt_u32 s45, 28
    s_cselect_b32 s64, 1, 0
    s_cselect_b32 s57, s50, s57
    s_cselect_b32 s50, s50, s49
    s_lshr_b32 s63, s50, 3
    s_and_b32 s78, s63, 1
    s_and_b32 s62, s50, 7
    s_and_b32 s72, s57, 7
    s_lshr_b32 s57, s57, 3
    s_brev_b32 s72, s72
    s_lshr_b32 s72, s72, 28
    s_and_b32 s49, s72, 7
    s_lshr_b32 s49, s49, 0
    s_and_b32 s72, s72, 8
    s_or_b32 s72, s72, s49
    s_lshr_b32 s49, s44, 2
    s_lshl_b32 s49, s49, 3
    s_add_u32 s62, s62, s49
    s_cmp_eq_u32 s54, 0
    s_cselect_b32 s36, s18, s20
    s_cselect_b32 s37, s19, s21
    s_add_u32 s40, s36, 27648
    s_addc_u32 s41, s37, 0
    s_and_b32 s37, s37, 0xffff
    s_mul_i32 s38, 1, 1835008
    s_mov_b32 s39, 0x20000
    s_and_b32 s41, s41, 0xffff
    s_mul_i32 s42, 1, 1807360
    s_mov_b32 s43, 0x20000
    s_lshr_b32 s74, s45, 2
    s_xor_b32 s74, s74, 4
    s_and_b32 s75, s45, 3
    s_lshl_b32 s70, s44, 1
    s_lshr_b32 s50, s75, 1
    s_add_u32 s70, s70, s50
    s_and_b32 s71, s75, 1
    s_lshl_b32 s49, s3, 2
    s_add_u32 s50, s49, 0
    s_xor_b32 s50, s50, s72
    s_lshl_b32 s50, s50, 11
    s_add_u32 s66, s50, 4096
    s_add_u32 s50, s49, 1
    s_xor_b32 s50, s50, s72
    s_lshl_b32 s50, s50, 11
    s_add_u32 s67, s50, 2048
    s_add_u32 s50, s49, 2
    s_xor_b32 s50, s50, s72
    s_lshl_b32 s50, s50, 11
    s_add_u32 s68, s50, 4096
    s_add_u32 s50, s49, 3
    s_xor_b32 s50, s50, s72
    s_lshl_b32 s50, s50, 11
    s_add_u32 s69, s50, 2048
    v_bfe_u32 v6, v2, 2, 3
    v_mul_u32_u24 v6, 3584, v6
    v_and_b32 v9, 3, v2
    v_lshl_add_u32 v6, v9, 4, v6
    v_lshrrev_b32 v9, 5, v2
    v_lshl_add_u32 v6, v9, 6, v6
    s_lshl_b32 s50, s57, 8
    s_lshr_b32 s51, s3, 1
    s_lshl_b32 s51, s51, 7
    s_add_u32 s50, s50, s51
    v_add_u32 v7, s50, v6
    v_add_u32 v8, 55296, v7
    s_add_u32 s58, s28, 1048576
    s_addc_u32 s59, s29, 0
    s_add_u32 s60, s28, 3145728
    s_addc_u32 s61, s29, 0
    v_mov_b32 v132, 0
    v_mov_b32 v133, 0
    v_mov_b32 v134, 0
    v_mov_b32 v135, 0
    v_mov_b32 v136, 0
    v_mov_b32 v137, 0
    v_mov_b32 v138, 0
    v_mov_b32 v139, 0
    v_mov_b32 v140, 0
    v_mov_b32 v141, 0
    v_mov_b32 v142, 0
    v_mov_b32 v143, 0
    v_mov_b32 v144, 0
    v_mov_b32 v145, 0
    v_mov_b32 v146, 0
    v_mov_b32 v147, 0
    s_waitcnt vmcnt(8)
    ds_write_b64 v156, v[182:183] offset:59392
    ds_read_b128 v[16:19], v158 offset:640
    ds_read_b128 v[20:23], v158 offset:768
    ds_read_b128 v[24:27], v158 offset:896
    ds_read_b128 v[28:31], v158 offset:1024
    ds_read_b128 v[32:35], v158 offset:1152
    ds_read_b128 v[52:55], v157 offset:59392
    ds_read_b128 v[56:59], v157 offset:59408
    ds_read_b128 v[60:63], v157 offset:59424
    ds_read_b128 v[64:67], v157 offset:59440
    global_load_dwordx4 v[76:79], v13, s[12:13]
    global_load_dwordx4 v[80:83], v14, s[12:13]
    global_load_dword v84, v15, s[12:13]
    global_load_dword v85, v14, s[12:13] offset:-4
    s_waitcnt lgkmcnt(4)
    v_perm_b32 v92, v24, v28, s46
    v_perm_b32 v93, v28, v32, s46
    v_perm_b32 v94, v16, v20, s46
    v_perm_b32 v95, v20, v24, s46
    v_perm_b32 v96, v24, v28, s47
    v_perm_b32 v97, v28, v32, s47
    v_perm_b32 v98, v16, v20, s47
    v_perm_b32 v99, v20, v24, s47
    v_perm_b32 v100, v25, v29, s46
    v_perm_b32 v101, v29, v33, s46
    v_perm_b32 v102, v17, v21, s46
    v_perm_b32 v103, v21, v25, s46
    v_perm_b32 v104, v25, v29, s47
    v_perm_b32 v105, v29, v33, s47
    v_perm_b32 v106, v17, v21, s47
    v_perm_b32 v107, v21, v25, s47
    v_perm_b32 v108, v26, v30, s46
    v_perm_b32 v109, v30, v34, s46
    v_perm_b32 v110, v18, v22, s46
    v_perm_b32 v111, v22, v26, s46
    v_perm_b32 v112, v26, v30, s47
    v_perm_b32 v113, v30, v34, s47
    v_perm_b32 v114, v18, v22, s47
    v_perm_b32 v115, v22, v26, s47
    v_perm_b32 v116, v27, v31, s46
    v_perm_b32 v117, v31, v35, s46
    v_perm_b32 v118, v19, v23, s46
    v_perm_b32 v119, v23, v27, s46
    v_perm_b32 v120, v27, v31, s47
    v_perm_b32 v121, v31, v35, s47
    v_perm_b32 v122, v19, v23, s47
    v_perm_b32 v123, v23, v27, s47
    s_waitcnt lgkmcnt(0)
    v_dot2c_f32_bf16 v132, v92, v52
    v_dot2c_f32_bf16 v133, v93, v52
    v_dot2c_f32_bf16 v132, v94, v53
    v_dot2c_f32_bf16 v133, v95, v53
    v_dot2c_f32_bf16 v134, v96, v54
    v_dot2c_f32_bf16 v135, v97, v54
    v_dot2c_f32_bf16 v134, v98, v55
    v_dot2c_f32_bf16 v135, v99, v55
    v_dot2c_f32_bf16 v136, v100, v56
    v_dot2c_f32_bf16 v137, v101, v56
    v_dot2c_f32_bf16 v136, v102, v57
    v_dot2c_f32_bf16 v137, v103, v57
    v_dot2c_f32_bf16 v138, v104, v58
    v_dot2c_f32_bf16 v139, v105, v58
    v_dot2c_f32_bf16 v138, v106, v59
    v_dot2c_f32_bf16 v139, v107, v59
    v_dot2c_f32_bf16 v140, v108, v60
    v_dot2c_f32_bf16 v141, v109, v60
    v_dot2c_f32_bf16 v140, v110, v61
    v_dot2c_f32_bf16 v141, v111, v61
    v_dot2c_f32_bf16 v142, v112, v62
    v_dot2c_f32_bf16 v143, v113, v62
    v_dot2c_f32_bf16 v142, v114, v63
    v_dot2c_f32_bf16 v143, v115, v63
    v_dot2c_f32_bf16 v144, v116, v64
    v_dot2c_f32_bf16 v145, v117, v64
    v_dot2c_f32_bf16 v144, v118, v65
    v_dot2c_f32_bf16 v145, v119, v65
    v_dot2c_f32_bf16 v146, v120, v66
    v_dot2c_f32_bf16 v147, v121, v66
    v_dot2c_f32_bf16 v146, v122, v67
    v_dot2c_f32_bf16 v147, v123, v67
    s_waitcnt vmcnt(8)
    s_and_b32 s49, s53, 15
    s_or_b32 s49, s49, s3
    s_cbranch_scc1 st_1
    s_lshl_b32 s49, s53, 3
    s_add_u32 s49, s49, 65536
    v_lshl_add_u32 v184, v2, 15, s49
    s_mov_b64 exec, 3
    global_store_dword v184, v90, s[28:29] sc1
    s_mov_b64 exec, -1
st_1:
    global_store_dwordx4 v180, v[176:179], s[28:29] sc1
    v_perm_b32 v92, v48, v44, s46
    ds_write_b32 v155, v92 offset:8192
    v_perm_b32 v93, v48, v44, s47
    ds_write_b32 v155, v93 offset:8320
    v_perm_b32 v94, v49, v45, s46
    ds_write_b32 v155, v94 offset:8448
    v_perm_b32 v95, v49, v45, s47
    ds_write_b32 v155, v95 offset:8576
    v_perm_b32 v96, v50, v46, s46
    ds_write_b32 v155, v96 offset:8704
    v_perm_b32 v97, v50, v46, s47
    ds_write_b32 v155, v97 offset:8832
    v_perm_b32 v98, v51, v47, s46
    ds_write_b32 v155, v98 offset:8960
    v_perm_b32 v99, v51, v47, s47
    ds_write_b32 v155, v99 offset:9088
    v_mov_b32 v100, 0
    v_mov_b32 v101, 0
    v_dot2c_f32_bf16 v100, s48, v68
    v_dot2c_f32_bf16 v101, v68, v68
    v_dot2c_f32_bf16 v100, s48, v69
    v_dot2c_f32_bf16 v101, v69, v69
    v_dot2c_f32_bf16 v100, s48, v70
    v_dot2c_f32_bf16 v101, v70, v70
    v_dot2c_f32_bf16 v100, s48, v71
    v_dot2c_f32_bf16 v101, v71, v71
    v_dot2c_f32_bf16 v100, s48, v72
    v_dot2c_f32_bf16 v101, v72, v72
    v_dot2c_f32_bf16 v100, s48, v73
    v_dot2c_f32_bf16 v101, v73, v73
    v_dot2c_f32_bf16 v100, s48, v74
    v_dot2c_f32_bf16 v101, v74, v74
    v_dot2c_f32_bf16 v100, s48, v75
    v_dot2c_f32_bf16 v101, v75, v75
    s_nop 2
    v_add_f32_dpp v100, v100, v100 quad_perm:[1,0,3,2] row_mask:0xf bank_mask:0xf
    v_add_f32_dpp v101, v101, v101 quad_perm:[1,0,3,2] row_mask:0xf bank_mask:0xf
    s_nop 0
    v_add_f32_dpp v100, v100, v100 quad_perm:[2,3,0,1] row_mask:0xf bank_mask:0xf
    v_add_f32_dpp v101, v101, v101 quad_perm:[2,3,0,1] row_mask:0xf bank_mask:0xf
    s_nop 0
    v_add_f32_dpp v100, v100, v100 row_half_mirror row_mask:0xf bank_mask:0xf
    v_add_f32_dpp v101, v101, v101 row_half_mirror row_mask:0xf bank_mask:0xf
    s_nop 0
    v_add_f32_dpp v100, v100, v100 row_mirror row_mask:0xf bank_mask:0xf
    v_add_f32_dpp v101, v101, v101 row_mirror row_mask:0xf bank_mask:0xf
    s_nop 0
    v_add_f32_dpp v100, v100, v100 row_bcast:15 row_mask:0xa bank_mask:0xf
    v_add_f32_dpp v101, v101, v101 row_bcast:15 row_mask:0xa bank_mask:0xf
    v_mul_f32 v100, 0x3b000000, v100
    v_mul_f32 v101, 0x3b000000, v101
    v_fma_f32 v101, -v100, v100, v101
    v_max_f32 v101, 0, v101
    v_cvt_pk_bf16_f32 v101, v101, v101
    v_lshlrev_b32 v101, 16, v101
    v_add_f32 v101, 0x3727c5ac, v101
    v_cvt_pk_bf16_f32 v101, v101, v101
    v_lshlrev_b32 v101, 16, v101
    v_sqrt_f32 v101, v101
    s_nop 0
    v_cvt_pk_bf16_f32 v101, v101, v101
    v_lshlrev_b32 v101, 16, v101
    v_rcp_f32 v101, v101
    v_cvt_pk_bf16_f32 v100, v100, v100
    v_lshlrev_b32 v100, 16, v100
    s_mov_b32 exec_lo, 0x80000000
    s_mov_b32 exec_hi, 0x80000000
    ds_write2_b32 v150, v100, v101 offset0:0 offset1:8
    s_mov_b64 exec, -1
    s_waitcnt lgkmcnt(0)
    s_barrier
    ds_read_b128 v[100:103], v86 offset:8192
    ds_read_b128 v[104:107], v87 offset:12288
    ds_read_b128 v[108:111], v152 offset:42496
    s_waitcnt lgkmcnt(2)
    global_store_dwordx4 v89, v[100:103], s[60:61] sc1
    s_waitcnt lgkmcnt(0)
    s_cmp_lg_u32 s3, 0
    s_cbranch_scc1 st_2
    s_mov_b64 exec, 15
    global_store_dwordx4 v153, v[108:111], s[28:29] sc1
    s_mov_b64 exec, -1
st_2:
    global_store_dwordx4 v149, v[104:107], s[60:61] sc1
    s_waitcnt vmcnt(9)
    v_lshlrev_b32 v160, 16, v36
    v_lshlrev_b32 v161, 16, v40
    v_mul_f32 v132, v132, v160
    v_mul_f32 v133, v133, v161
    v_cvt_pk_bf16_f32 v124, v133, v132
    ds_write_b32 v154, v124 offset:0
    v_and_b32 v162, s76, v36
    v_and_b32 v163, s76, v40
    v_mul_f32 v134, v134, v162
    v_mul_f32 v135, v135, v163
    v_cvt_pk_bf16_f32 v125, v135, v134
    ds_write_b32 v154, v125 offset:128
    v_lshlrev_b32 v164, 16, v37
    v_lshlrev_b32 v165, 16, v41
    v_mul_f32 v136, v136, v164
    v_mul_f32 v137, v137, v165
    v_cvt_pk_bf16_f32 v126, v137, v136
    ds_write_b32 v154, v126 offset:256
    v_and_b32 v166, s76, v37
    v_and_b32 v167, s76, v41
    v_mul_f32 v138, v138, v166
    v_mul_f32 v139, v139, v167
    v_cvt_pk_bf16_f32 v127, v139, v138
    ds_write_b32 v154, v127 offset:384
    v_lshlrev_b32 v168, 16, v38
    v_lshlrev_b32 v169, 16, v42
    v_mul_f32 v140, v140, v168
    v_mul_f32 v141, v141, v169
    v_cvt_pk_bf16_f32 v128, v141, v140
    ds_write_b32 v154, v128 offset:512
    v_and_b32 v170, s76, v38
    v_and_b32 v171, s76, v42
    v_mul_f32 v142, v142, v170
    v_mul_f32 v143, v143, v171
    v_cvt_pk_bf16_f32 v129, v143, v142
    ds_write_b32 v154, v129 offset:640
    v_lshlrev_b32 v172, 16, v39
    v_lshlrev_b32 v173, 16, v43
    v_mul_f32 v144, v144, v172
    v_mul_f32 v145, v145, v173
    v_cvt_pk_bf16_f32 v130, v145, v144
    ds_write_b32 v154, v130 offset:768
    v_and_b32 v174, s76, v39
    v_and_b32 v175, s76, v43
    v_mul_f32 v146, v146, v174
    v_mul_f32 v147, v147, v175
    v_cvt_pk_bf16_f32 v131, v147, v146
    ds_write_b32 v154, v131 offset:896
    s_waitcnt lgkmcnt(0)
    s_barrier
    ds_read_b128 v[92:95], v86
    ds_read_b128 v[96:99], v87 offset:4096
    s_waitcnt lgkmcnt(1)
    global_store_dwordx4 v88, v[92:95], s[58:59] sc1
    s_waitcnt lgkmcnt(0)
    global_store_dwordx4 v148, v[96:99], s[58:59] sc1
    s_xor_b32 s65, s72, 0
    s_add_u32 m0, s56, 0
    s_mul_i32 s65, s65, 114688
    buffer_load_dwordx4 v7, s[36:39], s65 offen offset:0  lds
    buffer_load_dwordx4 v7, s[40:43], s65 offen offset:1024  lds
    buffer_load_dwordx4 v8, s[36:39], s65 offen offset:2048  lds
    buffer_load_dwordx4 v8, s[40:43], s65 offen offset:3072  lds
    v_and_b32 v3, 15, v2
    v_lshrrev_b32 v4, 4, v2
    s_lshr_b32 s49, s3, 1
    v_lshrrev_b32 v14, 5, v2
    v_lshlrev_b32 v14, 9, v14
    v_lshrrev_b32 v15, 2, v3
    v_lshl_add_u32 v14, v15, 6, v14
    v_and_b32 v15, 1, v4
    v_lshl_add_u32 v14, v15, 5, v14
    v_and_b32 v15, 3, v3
    v_lshl_add_u32 v1, v15, 3, v14
    v_and_b32 v15, 512, v1
    s_lshl_b32 s50, s54, 9
    s_add_u32 s50, s50, s55
    v_add3_u32 v5, v1, v15, s50
    v_add_u32 v14, 2, v3
    v_and_b32 v14, 0x1e, v14
    v_lshl_add_u32 v14, v4, 3, v14
    v_lshlrev_b32 v14, 1, v14
    v_and_b32 v15, 1, v3
    v_xor_b32 v15, 1, v15
    v_mul_u32_u24 v15, 4160, v15
    s_mul_i32 s50, s49, 8320
    s_lshl_b32 s51, s54, 8
    s_add_u32 s50, s50, s51
    s_add_u32 s50, s50, 16384
    v_add3_u32 v184, v14, v15, s50
    v_add_u32 v185, 1024, v184
    v_add_u32 v186, 2048, v184
    v_add_u32 v187, 3072, v184
    s_lshl_b32 s53, s53, 1
    s_add_u32 s53, s53, s49
    v_lshlrev_b32 v13, 7, v0
    v_add_u32 v13, 32768, v13
    s_mul_i32 s79, s49, 4608
    s_add_u32 s79, s79, 33280
    s_lshl_b32 s52, s53, 12
    s_lshl_b32 s51, s54, 10
    s_add_u32 s50, s52, s51
    v_lshl_add_u32 v188, v2, 4, s50
    s_add_u32 s73, s79, s51
    s_lshl_b32 s46, s49, 12
    s_add_u32 s46, s46, s51
    s_lshl_b32 s47, s3, 11
    s_add_u32 s50, s47, 131072
    v_lshl_add_u32 v189, v2, 4, s50
    v_add_u32 v190, 8192, v189
    v_cmp_eq_u32 vcc, 0, v0
    s_waitcnt vmcnt(9)
    v_readfirstlane_b32 s30, v159
    s_nop 0
    v_cndmask_b32 v84, v84, v90, vcc
    v_cndmask_b32 v85, v85, v90, vcc
    v_cndmask_b32 v91, v90, v91, vcc
    s_add_u32 s30, s30, 1
    v_lshlrev_b32 v120, 16, v91
    v_and_b32 v121, s76, v91
    v_lshlrev_b32 v122, 16, v76
    v_lshlrev_b32 v123, 16, v80
    v_add_f32 v120, v120, v122
    v_add_f32 v121, v121, v123
    v_cvt_pk_bf16_f32 v120, v120, v121
    v_bfi_b32 v76, s76, v76, v120
    v_lshrrev_b32 v120, 16, v120
    v_bfi_b32 v80, s76, v80, v120
    v_alignbit_b32 v112, v76, v84, 16
    v_alignbit_b32 v113, v77, v76, 16
    v_alignbit_b32 v114, v78, v77, 16
    v_alignbit_b32 v115, v79, v78, 16
    ds_write_b128 v151, v[76:79] offset:16416
    ds_write_b128 v151, v[112:115] offset:20576
    v_alignbit_b32 v116, v80, v85, 16
    v_alignbit_b32 v117, v81, v80, 16
    v_alignbit_b32 v118, v82, v81, 16
    v_alignbit_b32 v119, v83, v82, 16
    ds_write_b128 v151, v[80:83] offset:24736
    ds_write_b128 v151, v[116:119] offset:28896
    s_waitcnt lgkmcnt(0)
    s_waitcnt vmcnt(4)
    s_barrier
    s_cmp_lg_u32 s3, 0
    s_cbranch_scc1 pub_3
    s_add_u32 s57, s77, 32768
    v_mov_b32 v158, s57
    v_mov_b32 v159, s30
    s_mov_b64 exec, 1
    global_store_dword v158, v159, s[28:29] sc1
    s_mov_b64 exec, -1
pub_3:
    ds_read2_b32 v[16:17], v184 offset0:0 offset1:1
    s_lshr_b32 s49, s3, 1
    s_add_u32 s50, s46, 152576
    ds_read2_b32 v[18:19], v184 offset0:2 offset1:3
    v_lshl_add_u32 v0, v2, 4, s50
    s_lshl_b32 s50, s54, 12
    s_xor_b32 s65, s72, 1
    s_add_u32 m0, s56, 8192
    s_mul_i32 s65, s65, 114688
    buffer_load_dwordx4 v7, s[36:39], s65 offen offset:0  lds
    ds_read2_b32 v[48:49], v184 offset0:16 offset1:17
    s_add_u32 s50, s50, 43008
    v_lshl_add_u32 v6, v2, 6, s50
    ds_read2_b32 v[50:51], v184 offset0:18 offset1:19
    s_lshl_b32 s50, s3, 2
    v_add_u32 v191, s50, v4
    buffer_load_dwordx4 v7, s[40:43], s65 offen offset:1024  lds
    ds_read2_b32 v[80:81], v184 offset0:32 offset1:33
    v_xor_b32 v191, s72, v191
    ds_read2_b32 v[82:83], v184 offset0:34 offset1:35
    v_lshlrev_b32 v191, 7, v191
    v_add_u32 v191, 65536, v191
    buffer_load_dwordx4 v8, s[36:39], s65 offen offset:2048  lds
    ds_read2_b32 v[112:113], v184 offset0:48 offset1:49
    v_lshlrev_b32 v9, 5, v3
    v_sub_u32 v9, 480, v9
    ds_read2_b32 v[114:115], v184 offset0:50 offset1:51
    v_lshl_add_u32 v9, v4, 4, v9
    s_lshl_b32 s50, s54, 8
    buffer_load_dwordx4 v8, s[40:43], s65 offen offset:3072  lds
    s_mul_i32 s38, s38, s64
    s_mul_i32 s42, s42, s64
    ds_read2_b32 v[20:21], v184 offset0:128 offset1:129
    s_add_u32 s50, s50, s79
    v_add_u32 v9, s50, v9
    ds_read2_b32 v[22:23], v184 offset0:130 offset1:131
    v_lshrrev_b32 v14, 1, v3
    v_xor_b32 v14, v14, v4
    s_xor_b32 s65, s72, 2
    s_add_u32 m0, s56, 16384
    s_mul_i32 s65, s65, 114688
    buffer_load_dwordx4 v7, s[36:39], s65 offen offset:0  lds
    ds_read2_b32 v[52:53], v184 offset0:144 offset1:145
    v_and_b32 v14, 3, v14
    v_lshlrev_b32 v14, 4, v14
    ds_read2_b32 v[54:55], v184 offset0:146 offset1:147
    v_lshl_add_u32 v14, v3, 6, v14
    s_lshl_b32 s50, s3, 12
    buffer_load_dwordx4 v7, s[40:43], s65 offen offset:1024  lds
    ds_read2_b32 v[84:85], v184 offset0:160 offset1:161
    v_add_u32 v10, s50, v14
    v_lshrrev_b32 v14, 2, v2
    ds_read2_b32 v[86:87], v184 offset0:162 offset1:163
    v_lshlrev_b32 v11, 1, v2
    v_xor_b32 v14, v14, v11
    ds_read2_b32 v[116:117], v184 offset0:176 offset1:177
    v_and_b32 v14, 3, v14
    v_lshlrev_b32 v14, 4, v14
    ds_read2_b32 v[118:119], v184 offset0:178 offset1:179
    v_lshrrev_b32 v11, 1, v2
    v_lshl_add_u32 v14, v11, 6, v14
    ds_read2_b32 v[24:25], v185 offset0:0 offset1:1
    s_lshl_b32 s50, s49, 13
    s_lshl_b32 s51, s54, 11
    ds_read2_b32 v[26:27], v185 offset0:2 offset1:3
    s_add_u32 s50, s50, s51
    v_add_u32 v11, s50, v14
    ds_read2_b32 v[56:57], v185 offset0:16 offset1:17
    v_lshrrev_b32 v12, 2, v2
    v_lshlrev_b32 v12, 15, v12
    ds_read2_b32 v[58:59], v185 offset0:18 offset1:19
    v_and_b32 v14, 3, v2
    v_lshl_add_u32 v12, v14, 4, v12
    ds_read2_b32 v[88:89], v185 offset0:32 offset1:33
    s_lshl_b32 s50, s54, 19
    s_lshl_b32 s51, s53, 6
    ds_read2_b32 v[90:91], v185 offset0:34 offset1:35
    s_add_u32 s50, s50, s51
    v_add_u32 v12, s50, v12
    ds_read2_b32 v[120:121], v185 offset0:48 offset1:49
    v_xor_b32 v14, v3, v4
    v_and_b32 v14, 1, v14
    ds_read2_b32 v[122:123], v185 offset0:50 offset1:51
    v_subrev_u32 v14, 1, v14
    v_and_b32 v144, s48, v14
    ds_read2_b32 v[28:29], v185 offset0:128 offset1:129
    v_mov_b32 v145, v144
    v_mov_b32 v146, v144
    ds_read2_b32 v[30:31], v185 offset0:130 offset1:131
    v_mov_b32 v147, v144
    s_add_u32 s32, s28, 5238784
    s_addc_u32 s33, s29, 0
    ds_read2_b32 v[60:61], v185 offset0:144 offset1:145
    s_and_b32 s33, s33, 0xffff
    s_mov_b32 s34, 2101248
    ds_read2_b32 v[62:63], v185 offset0:146 offset1:147
    s_mov_b32 s4, s22
    s_and_b32 s5, s23, 0xffff
    ds_read2_b32 v[92:93], v185 offset0:160 offset1:161
    s_mov_b32 s6, 1835008
    s_mov_b32 s7, 0x20000
    ds_read2_b32 v[94:95], v185 offset0:162 offset1:163
    s_add_u32 s12, s22, 7168
    s_addc_u32 s13, s23, 0
    s_and_b32 s13, s13, 0xffff
    ds_read2_b32 v[124:125], v185 offset0:176 offset1:177
    s_mov_b32 s14, 1827840
    s_mov_b32 s15, 0x20000
    ds_read2_b32 v[126:127], v185 offset0:178 offset1:179
    s_lshl_b32 s49, s62, 15
    s_lshl_b32 s50, s78, 19
    ds_read2_b32 v[32:33], v186 offset0:0 offset1:1
    s_mul_i32 s51, s50, s64
    s_sub_u32 s50, s50, s51
    ds_read2_b32 v[34:35], v186 offset0:2 offset1:3
    s_lshr_b32 s8, 0x100000, s64
    s_add_u32 s49, s49, s50
    ds_read2_b32 v[64:65], v186 offset0:16 offset1:17
    v_lshl_add_u32 v149, v2, 4, s49
    s_lshl_b32 s49, s3, 13
    ds_read2_b32 v[66:67], v186 offset0:18 offset1:19
    v_lshl_add_u32 v156, v2, 4, s49
    v_and_b32 v148, 1, v4
    ds_read2_b32 v[96:97], v186 offset0:32 offset1:33
    v_mul_u32_u24 v148, 57344, v148
    v_lshrrev_b32 v14, 5, v2
    ds_read2_b32 v[98:99], v186 offset0:34 offset1:35
    v_lshl_add_u32 v148, v14, 8, v148
    v_lshl_add_u32 v148, v3, 4, v148
    ds_read2_b32 v[128:129], v186 offset0:48 offset1:49
    s_lshl_b32 s50, s63, 2
    s_add_u32 s50, s50, s3
    ds_read2_b32 v[130:131], v186 offset0:50 offset1:51
    s_mul_i32 s51, s50, 37
    s_lshr_b32 s51, s51, 9
    ds_read2_b32 v[36:37], v186 offset0:128 offset1:129
    s_mul_i32 s51, s51, 14
    s_sub_u32 s50, s50, s51
    ds_read2_b32 v[38:39], v186 offset0:130 offset1:131
    s_add_u32 s52, s50, 4
    s_lshr_b32 s52, s52, 4
    ds_read2_b32 v[68:69], v186 offset0:144 offset1:145
    s_andn2_b32 s52, s62, s52
    s_and_b32 s52, s52, 1
    ds_read2_b32 v[70:71], v186 offset0:146 offset1:147
    s_lshl_b32 s52, s52, 1
    s_xor_b32 s50, s50, s52
    ds_read2_b32 v[100:101], v186 offset0:160 offset1:161
    v_and_b32 v153, 1, v4
    v_xor_b32 v153, s50, v153
    ds_read2_b32 v[102:103], v186 offset0:162 offset1:163
    v_lshl_add_u32 v148, v153, 10, v148
    s_mul_i32 s49, s62, 112
    ds_read2_b32 v[132:133], v186 offset0:176 offset1:177
    s_add_u32 s49, s49, s51
    s_lshl_b32 s49, s49, 10
    ds_read2_b32 v[134:135], v186 offset0:178 offset1:179
    v_add_u32 v148, s49, v148
    s_lshl_b32 s10, s75, 15
    ds_read2_b32 v[40:41], v187 offset0:0 offset1:1
    s_lshl_b32 s11, s71, 15
    v_bfe_u32 v150, v2, 2, 3
    ds_read2_b32 v[42:43], v187 offset0:2 offset1:3
    v_lshlrev_b32 v150, 10, v150
    v_lshl_add_u32 v150, v14, 6, v150
    ds_read2_b32 v[72:73], v187 offset0:16 offset1:17
    v_lshlrev_b32 v151, 11, v14
    v_and_b32 v14, 3, v2
    ds_read2_b32 v[74:75], v187 offset0:18 offset1:19
    v_lshl_add_u32 v150, v14, 4, v150
    v_lshl_add_u32 v151, v14, 3, v151
    ds_read2_b32 v[104:105], v187 offset0:32 offset1:33
    s_lshl_b32 s49, s3, 5
    v_xor_b32 v150, s49, v150
    ds_read2_b32 v[106:107], v187 offset0:34 offset1:35
    s_mul_i32 s49, s3, 458752
    s_lshl_b32 s50, s74, 7
    ds_read2_b32 v[136:137], v187 offset0:48 offset1:49
    s_add_u32 s49, s49, s50
    v_add_u32 v150, s49, v150
    ds_read2_b32 v[138:139], v187 offset0:50 offset1:51
    v_and_b32 v14, 1, v4
    v_lshl_add_u32 v151, v14, 8, v151
    ds_read2_b32 v[44:45], v187 offset0:128 offset1:129
    v_lshrrev_b32 v14, 2, v3
    v_lshl_add_u32 v151, v14, 6, v151
    ds_read2_b32 v[46:47], v187 offset0:130 offset1:131
    v_add_u32 v151, s56, v151
    v_and_b32 v14, 31, v2
    ds_read2_b32 v[76:77], v187 offset0:144 offset1:145
    s_lshl_b32 s49, s62, 8
    s_add_u32 s49, s49, 163840
    ds_read2_b32 v[78:79], v187 offset0:146 offset1:147
    v_lshl_add_u32 v152, v14, 3, s49
    s_lshl_b32 s49, s62, 13
    ds_read2_b32 v[108:109], v187 offset0:160 offset1:161
    s_lshl_b32 s50, s63, 9
    s_add_u32 s49, s49, s50
    ds_read2_b32 v[110:111], v187 offset0:162 offset1:163
    s_lshl_b32 s50, s3, 7
    s_add_u32 s49, s49, s50
    ds_read2_b32 v[140:141], v187 offset0:176 offset1:177
    s_add_u32 s49, s49, 524288
    v_lshl_add_u32 v154, v2, 2, s49
    ds_read2_b32 v[142:143], v187 offset0:178 offset1:179
    v_mov_b32 v157, s30
    s_lshl_b32 s49, s70, 13
    s_mul_i32 s50, s3, 1792
    s_add_u32 s49, s49, s50
    s_add_u32 s49, s49, 524288
    v_min_u32 v153, 13, v2
    v_lshl_add_u32 v153, v153, 7, s49
    s_mul_i32 s49, s70, 114688
    s_mul_i32 s50, s71, 57344
    s_add_u32 s49, s49, s50
    s_mul_i32 s50, s3, 14336
    s_add_u32 s49, s49, s50
    v_lshl_add_u32 v155, v2, 4, s49
    s_lshl_b32 s49, s62, 1
    s_add_u32 s49, s49, s78
    s_lshl_b32 s49, s49, 2
    s_add_u32 s49, s49, s3
    s_mul_i32 s49, s49, 14336
    v_min_u32 v14, 55, v2
    v_lshl_add_u32 v193, v14, 7, s49
    v_add_u32 v194, 7168, v193
    v_xor_b32 v14, 16, v11
    buffer_load_dwordx4 v8, s[36:39], s65 offen offset:2048  lds
    buffer_load_dwordx4 v8, s[40:43], s65 offen offset:3072  lds
    s_xor_b32 s65, s72, 3
    s_add_u32 m0, s56, 24576
    s_mul_i32 s65, s65, 114688
    buffer_load_dwordx4 v7, s[36:39], s65 offen offset:0  lds
    buffer_load_dwordx4 v7, s[40:43], s65 offen offset:1024  lds
    buffer_load_dwordx4 v8, s[36:39], s65 offen offset:2048  lds
    buffer_load_dwordx4 v8, s[40:43], s65 offen offset:3072  lds
    s_xor_b32 s65, s72, 4
    s_add_u32 m0, s56, 32768
    s_mul_i32 s65, s65, 114688
    buffer_load_dwordx4 v7, s[36:39], s65 offen offset:0  lds
    buffer_load_dwordx4 v7, s[40:43], s65 offen offset:1024  lds
    buffer_load_dwordx4 v8, s[36:39], s65 offen offset:2048  lds
    buffer_load_dwordx4 v8, s[40:43], s65 offen offset:3072  lds
    s_waitcnt vmcnt(16)
    s_barrier
    ds_read_b64_tr_b16 a[0:1], v5 offset:0
    ds_read_b64_tr_b16 a[2:3], v5 offset:256
    ds_read_b64_tr_b16 a[128:129], v5 offset:4096
    ds_read_b64_tr_b16 a[130:131], v5 offset:4352
    ds_read_b64_tr_b16 a[4:5], v5 offset:2048
    ds_read_b64_tr_b16 a[6:7], v5 offset:2304
    ds_read_b64_tr_b16 a[132:133], v5 offset:6144
    ds_read_b64_tr_b16 a[134:135], v5 offset:6400
    s_waitcnt vmcnt(12)
    s_waitcnt lgkmcnt(0)
    s_barrier
    ds_read_b64_tr_b16 a[8:9], v5 offset:8192
    ds_read_b64_tr_b16 a[10:11], v5 offset:8448
    ds_read_b64_tr_b16 a[136:137], v5 offset:12288
    ds_read_b64_tr_b16 a[138:139], v5 offset:12544
    ds_read_b64_tr_b16 a[12:13], v5 offset:10240
    ds_read_b64_tr_b16 a[14:15], v5 offset:10496
    ds_read_b64_tr_b16 a[140:141], v5 offset:14336
    ds_read_b64_tr_b16 a[142:143], v5 offset:14592
    s_xor_b32 s65, s72, 5
    s_add_u32 m0, s56, 0
    s_mul_i32 s65, s65, 114688
    buffer_load_dwordx4 v7, s[36:39], s65 offen offset:0  lds
    buffer_load_dwordx4 v7, s[40:43], s65 offen offset:1024  lds
    buffer_load_dwordx4 v8, s[36:39], s65 offen offset:2048  lds
    buffer_load_dwordx4 v8, s[40:43], s65 offen offset:3072  lds
    v_mfma_f32_16x16x32_bf16 v[248:251], a[0:3], v[144:147], 0
    v_mfma_f32_16x16x32_bf16 v[252:255], a[128:131], v[144:147], 0
    v_mfma_f32_16x16x32_bf16 v[248:251], a[4:7], v[144:147], v[248:251]
    v_mfma_f32_16x16x32_bf16 v[252:255], a[132:135], v[144:147], v[252:255]
    global_load_dword v15, v13, s[28:29] sc1
    s_waitcnt vmcnt(13)
    s_waitcnt lgkmcnt(0)
    s_barrier
    ds_read_b64_tr_b16 a[16:17], v5 offset:16384
    ds_read_b64_tr_b16 a[18:19], v5 offset:16640
    ds_read_b64_tr_b16 a[144:145], v5 offset:20480
    ds_read_b64_tr_b16 a[146:147], v5 offset:20736
    ds_read_b64_tr_b16 a[20:21], v5 offset:18432
    ds_read_b64_tr_b16 a[22:23], v5 offset:18688
    ds_read_b64_tr_b16 a[148:149], v5 offset:22528
    ds_read_b64_tr_b16 a[150:151], v5 offset:22784
    v_mfma_f32_16x16x32_bf16 v[248:251], a[8:11], v[144:147], v[248:251]
    v_mfma_f32_16x16x32_bf16 v[252:255], a[136:139], v[144:147], v[252:255]
    v_mfma_f32_16x16x32_bf16 v[248:251], a[12:15], v[144:147], v[248:251]
    v_mfma_f32_16x16x32_bf16 v[252:255], a[140:143], v[144:147], v[252:255]
    s_waitcnt vmcnt(9)
    s_waitcnt lgkmcnt(0)
    s_barrier
    ds_read_b64_tr_b16 a[24:25], v5 offset:24576
    ds_read_b64_tr_b16 a[26:27], v5 offset:24832
    ds_read_b64_tr_b16 a[152:153], v5 offset:28672
    ds_read_b64_tr_b16 a[154:155], v5 offset:28928
    ds_read_b64_tr_b16 a[28:29], v5 offset:26624
    ds_read_b64_tr_b16 a[30:31], v5 offset:26880
    ds_read_b64_tr_b16 a[156:157], v5 offset:30720
    ds_read_b64_tr_b16 a[158:159], v5 offset:30976
    v_mfma_f32_16x16x32_bf16 v[248:251], a[16:19], v[144:147], v[248:251]
    v_mfma_f32_16x16x32_bf16 v[252:255], a[144:147], v[144:147], v[252:255]
    v_mfma_f32_16x16x32_bf16 v[248:251], a[20:23], v[144:147], v[248:251]
    v_mfma_f32_16x16x32_bf16 v[252:255], a[148:151], v[144:147], v[252:255]
    s_waitcnt vmcnt(5)
    s_waitcnt lgkmcnt(0)
    s_barrier
    ds_read_b64_tr_b16 a[32:33], v5 offset:32768
    ds_read_b64_tr_b16 a[34:35], v5 offset:33024
    ds_read_b64_tr_b16 a[160:161], v5 offset:36864
    ds_read_b64_tr_b16 a[162:163], v5 offset:37120
    ds_read_b64_tr_b16 a[36:37], v5 offset:34816
    ds_read_b64_tr_b16 a[38:39], v5 offset:35072
    ds_read_b64_tr_b16 a[164:165], v5 offset:38912
    ds_read_b64_tr_b16 a[166:167], v5 offset:39168
    v_mfma_f32_16x16x32_bf16 v[248:251], a[24:27], v[144:147], v[248:251]
    v_mfma_f32_16x16x32_bf16 v[252:255], a[152:155], v[144:147], v[252:255]
    v_mfma_f32_16x16x32_bf16 v[248:251], a[28:31], v[144:147], v[248:251]
    v_mfma_f32_16x16x32_bf16 v[252:255], a[156:159], v[144:147], v[252:255]
    s_waitcnt vmcnt(1)
    s_waitcnt lgkmcnt(0)
    s_barrier
    ds_read_b64_tr_b16 a[40:41], v5 offset:0
    ds_read_b64_tr_b16 a[42:43], v5 offset:256
    ds_read_b64_tr_b16 a[168:169], v5 offset:4096
    ds_read_b64_tr_b16 a[170:171], v5 offset:4352
    ds_read_b64_tr_b16 a[44:45], v5 offset:2048
    ds_read_b64_tr_b16 a[46:47], v5 offset:2304
    ds_read_b64_tr_b16 a[172:173], v5 offset:6144
    ds_read_b64_tr_b16 a[174:175], v5 offset:6400
    v_mfma_f32_16x16x32_bf16 v[248:251], a[32:35], v[144:147], v[248:251]
    v_mfma_f32_16x16x32_bf16 v[252:255], a[160:163], v[144:147], v[252:255]
    v_mfma_f32_16x16x32_bf16 v[248:251], a[36:39], v[144:147], v[248:251]
    v_mfma_f32_16x16x32_bf16 v[252:255], a[164:167], v[144:147], v[252:255]
    s_waitcnt vmcnt(0)
    v_cmp_ne_u32 vcc, s30, v15
    s_cbranch_vccnz slow_pok_4
pok_4:
    s_add_u32 m0, s73, 0
    s_barrier
    global_load_lds_dwordx4 v188, s[58:59] offset:2048 sc1
    s_add_u32 m0, s46, 152576
    s_nop 0
    global_load_lds_dwordx4 v188, s[60:61] offset:0 sc1
    s_add_u32 m0, s47, 43008
    s_nop 0
    global_load_lds_dwordx4 v189, s[28:29] offset:0 sc1
    global_load_lds_dwordx4 v189, s[28:29] offset:1024 sc1
    s_add_u32 m0, s73, 0
    s_nop 0
    global_load_lds_dwordx4 v188, s[58:59] offset:0 sc1
    s_add_u32 m0, s46, 152576
    s_nop 0
    global_load_lds_dwordx4 v188, s[60:61] offset:2048 sc1
    s_add_u32 m0, s47, 51200
    s_nop 0
    global_load_lds_dwordx4 v190, s[28:29] offset:0 sc1
    global_load_lds_dwordx4 v190, s[28:29] offset:1024 sc1
    s_add_u32 s58, s28, 5242880
    s_addc_u32 s59, s29, 0
    s_add_u32 s60, s28, 7340032
    s_addc_u32 s61, s29, 0
    v_mov_b32 v13, v191
    s_lshl_b32 s73, s3, 13
    s_cmp_eq_u32 s64, 0
    s_cbranch_scc1 L_idle
    s_waitcnt lgkmcnt(0)
    v_mfma_f32_16x16x32_bf16 v[248:251], a[40:43], v[144:147], v[248:251]
    v_mfma_f32_16x16x32_bf16 v[252:255], a[168:171], v[144:147], v[252:255]
    v_mfma_f32_16x16x32_bf16 v[248:251], a[44:47], v[144:147], v[248:251]
    v_mfma_f32_16x16x32_bf16 v[252:255], a[172:175], v[144:147], v[252:255]
    s_xor_b32 s65, s72, 6
    s_add_u32 m0, s56, 8192
    s_mul_i32 s65, s65, 114688
    buffer_load_dwordx4 v7, s[36:39], s65 offen offset:0  lds
    buffer_load_dwordx4 v7, s[40:43], s65 offen offset:1024  lds
    buffer_load_dwordx4 v8, s[36:39], s65 offen offset:2048  lds
    buffer_load_dwordx4 v8, s[40:43], s65 offen offset:3072  lds
    s_waitcnt vmcnt(11)
    s_barrier
    ds_read_b128 v[160:163], v9 offset:3584
    ds_read_b128 v[164:167], v9 offset:3072
    ds_read_b128 v[168:171], v9 offset:2560
    ds_read_b128 v[172:175], v9 offset:2048
    ds_read_b128 v[176:179], v9 offset:3648
    ds_read_b128 v[180:183], v9 offset:3136
    s_waitcnt lgkmcnt(5)
    v_mfma_f32_16x16x32_bf16 v[184:187], v[16:19], v[160:163], 0
    s_xor_b32 s65, s72, 7
    s_add_u32 m0, s56, 16384
    s_mul_i32 s65, s65, 114688
    buffer_load_dwordx4 v7, s[36:39], s65 offen offset:0  lds
    v_mfma_f32_16x16x32_bf16 v[188:191], v[20:23], v[160:163], 0
    v_mfma_f32_16x16x32_bf16 v[192:195], v[24:27], v[160:163], 0
    v_mfma_f32_16x16x32_bf16 v[196:199], v[28:31], v[160:163], 0
    ds_read_b128 v[160:163], v9 offset:2624
    s_waitcnt lgkmcnt(5)
    v_mfma_f32_16x16x32_bf16 v[188:191], v[16:19], v[164:167], v[188:191]
    buffer_load_dwordx4 v7, s[40:43], s65 offen offset:1024  lds
    v_mfma_f32_16x16x32_bf16 v[192:195], v[20:23], v[164:167], v[192:195]
    v_mfma_f32_16x16x32_bf16 v[196:199], v[24:27], v[164:167], v[196:199]
    s_waitcnt vmcnt(9)
    s_barrier
    ds_read_b128 v[240:243], v0 offset:0
    ds_read_b128 v[164:167], v9 offset:2112
    s_waitcnt lgkmcnt(5)
    v_mfma_f32_16x16x32_bf16 v[192:195], v[16:19], v[168:171], v[192:195]
    buffer_load_dwordx4 v8, s[36:39], s65 offen offset:2048  lds
    ds_read_b128 v[216:219], v6 offset:0
    v_mfma_f32_16x16x32_bf16 v[196:199], v[20:23], v[168:171], v[196:199]
    ds_read_b128 v[220:223], v6 offset:16
    ds_read_b128 v[224:227], v6 offset:32
    ds_read_b128 v[168:171], v9 offset:3712
    v_mfma_f32_16x16x32_bf16 v[196:199], v[16:19], v[172:175], v[196:199]
    ds_read_b128 v[228:231], v6 offset:48
    ds_read_b128 v[172:175], v9 offset:3200
    s_waitcnt lgkmcnt(9)
    v_mfma_f32_16x16x32_bf16 v[184:187], v[48:51], v[176:179], v[184:187]
    buffer_load_dwordx4 v8, s[40:43], s65 offen offset:3072  lds
    v_mfma_f32_16x16x32_bf16 v[188:191], v[52:55], v[176:179], v[188:191]
    v_mfma_f32_16x16x32_bf16 v[192:195], v[56:59], v[176:179], v[192:195]
    s_waitcnt lgkmcnt(1)
    v_lshlrev_b32 v232, 16, v240
    v_mfma_f32_16x16x32_bf16 v[196:199], v[60:63], v[176:179], v[196:199]
    s_xor_b32 s65, s72, 8
    s_add_u32 m0, s56, 24576
    s_mul_i32 s65, s65, 114688
    buffer_load_dwordx4 v7, s[36:39], s65 offen offset:0  lds
    v_sub_f32 v216, v232, v216
    ds_read_b128 v[176:179], v9 offset:2688
    v_mfma_f32_16x16x32_bf16 v[188:191], v[48:51], v[180:183], v[188:191]
    v_mul_f32 v216, v216, v224
    v_and_b32 v233, s76, v240
    v_mfma_f32_16x16x32_bf16 v[192:195], v[52:55], v[180:183], v[192:195]
    s_cmp_lg_u32 s3, 0
    s_cbranch_scc1 pub_6
    s_lshr_b32 s57, s77, 11
    s_lshl_b32 s57, s57, 7
    s_add_u32 s57, s57, 65536
    v_mov_b32 v158, s57
    v_mov_b32 v159, 1
    s_mov_b64 exec, 1
    global_atomic_add v158, v159, s[28:29] sc1
    s_mov_b64 exec, -1
pub_6:
    buffer_load_dwordx4 v7, s[40:43], s65 offen offset:1024  lds
    v_sub_f32 v217, v233, v217
    v_mfma_f32_16x16x32_bf16 v[196:199], v[56:59], v[180:183], v[196:199]
    v_mul_f32 v217, v217, v225
    v_lshlrev_b32 v234, 16, v241
    ds_read_b128 v[180:183], v9 offset:2176
    v_mfma_f32_16x16x32_bf16 v[192:195], v[48:51], v[160:163], v[192:195]
    v_sub_f32 v218, v234, v218
    v_mul_f32 v218, v218, v226
    v_mfma_f32_16x16x32_bf16 v[196:199], v[52:55], v[160:163], v[196:199]
    v_and_b32 v235, s76, v241
    v_sub_f32 v219, v235, v219
    ds_read_b128 v[160:163], v9 offset:3776
    v_mfma_f32_16x16x32_bf16 v[196:199], v[48:51], v[164:167], v[196:199]
    v_mul_f32 v219, v219, v227
    v_lshlrev_b32 v236, 16, v242
    ds_read_b128 v[164:167], v9 offset:3264
    s_waitcnt lgkmcnt(4)
    v_mfma_f32_16x16x32_bf16 v[184:187], v[80:83], v[168:171], v[184:187]
    v_sub_f32 v220, v236, v220
    v_mul_f32 v220, v220, v228
    v_mfma_f32_16x16x32_bf16 v[188:191], v[84:87], v[168:171], v[188:191]
    v_and_b32 v237, s76, v242
    v_sub_f32 v221, v237, v221
    v_mfma_f32_16x16x32_bf16 v[192:195], v[88:91], v[168:171], v[192:195]
    v_mul_f32 v221, v221, v229
    v_lshlrev_b32 v238, 16, v243
    v_mfma_f32_16x16x32_bf16 v[196:199], v[92:95], v[168:171], v[196:199]
    v_sub_f32 v222, v238, v222
    v_mul_f32 v222, v222, v230
    ds_read_b128 v[168:171], v9 offset:2752
    v_mfma_f32_16x16x32_bf16 v[188:191], v[80:83], v[172:175], v[188:191]
    v_and_b32 v239, s76, v243
    v_sub_f32 v223, v239, v223
    v_mfma_f32_16x16x32_bf16 v[192:195], v[84:87], v[172:175], v[192:195]
    v_mul_f32 v223, v223, v231
    v_mfma_f32_16x16x32_bf16 v[196:199], v[88:91], v[172:175], v[196:199]
    ds_read_b128 v[172:175], v9 offset:2240
    s_waitcnt lgkmcnt(4)
    v_mfma_f32_16x16x32_bf16 v[192:195], v[80:83], v[176:179], v[192:195]
    v_mfma_f32_16x16x32_bf16 v[196:199], v[84:87], v[176:179], v[196:199]
    ds_read_b128 v[176:179], v9 offset:3584
    v_mfma_f32_16x16x32_bf16 v[196:199], v[80:83], v[180:183], v[196:199]
    ds_read_b128 v[180:183], v9 offset:3072
    s_waitcnt lgkmcnt(4)
    v_mfma_f32_16x16x32_bf16 v[184:187], v[112:115], v[160:163], v[184:187]
    v_mfma_f32_16x16x32_bf16 v[188:191], v[116:119], v[160:163], v[188:191]
    v_mfma_f32_16x16x32_bf16 v[192:195], v[120:123], v[160:163], v[192:195]
    v_mfma_f32_16x16x32_bf16 v[196:199], v[124:127], v[160:163], v[196:199]
    ds_read_b128 v[160:163], v9 offset:2560
    v_mfma_f32_16x16x32_bf16 v[188:191], v[112:115], v[164:167], v[188:191]
    v_mfma_f32_16x16x32_bf16 v[192:195], v[116:119], v[164:167], v[192:195]
    v_mfma_f32_16x16x32_bf16 v[196:199], v[120:123], v[164:167], v[196:199]
    ds_read_b128 v[164:167], v9 offset:2048
    s_waitcnt lgkmcnt(4)
    v_mfma_f32_16x16x32_bf16 v[192:195], v[112:115], v[168:171], v[192:195]
    v_mfma_f32_16x16x32_bf16 v[196:199], v[116:119], v[168:171], v[196:199]
    ds_read_b128 v[168:171], v9 offset:1536
    v_mfma_f32_16x16x32_bf16 v[196:199], v[112:115], v[172:175], v[196:199]
    buffer_load_dwordx4 v8, s[36:39], s65 offen offset:2048  lds
    ds_read_b128 v[172:175], v9 offset:1024
    s_waitcnt lgkmcnt(4)
    v_mfma_f32_16x16x32_bf16 v[200:203], v[32:35], v[176:179], 0
    v_mfma_f32_16x16x32_bf16 v[204:207], v[36:39], v[176:179], 0
    ds_write_b128 v10, v[184:187] offset:0
    v_mfma_f32_16x16x32_bf16 v[208:211], v[40:43], v[176:179], 0
    v_mfma_f32_16x16x32_bf16 v[212:215], v[44:47], v[176:179], 0
    buffer_load_dwordx4 v8, s[40:43], s65 offen offset:3072  lds
    ds_read_b128 v[176:179], v9 offset:512
    v_mfma_f32_16x16x32_bf16 v[200:203], v[28:31], v[180:183], v[200:203]
    ds_write_b128 v10, v[188:191] offset:1024
    v_mfma_f32_16x16x32_bf16 v[204:207], v[32:35], v[180:183], v[204:207]
    v_mfma_f32_16x16x32_bf16 v[208:211], v[36:39], v[180:183], v[208:211]
    v_mfma_f32_16x16x32_bf16 v[212:215], v[40:43], v[180:183], v[212:215]
    s_xor_b32 s65, s72, 9
    s_add_u32 m0, s56, 32768
    s_mul_i32 s65, s65, 114688
    buffer_load_dwordx4 v7, s[36:39], s65 offen offset:0  lds
    ds_write_b128 v10, v[192:195] offset:2048
    ds_read_b128 v[180:183], v9 offset:0
    s_waitcnt lgkmcnt(7)
    v_mfma_f32_16x16x32_bf16 v[200:203], v[24:27], v[160:163], v[200:203]
    v_mfma_f32_16x16x32_bf16 v[204:207], v[28:31], v[160:163], v[204:207]
    v_mfma_f32_16x16x32_bf16 v[208:211], v[32:35], v[160:163], v[208:211]
    buffer_load_dwordx4 v7, s[40:43], s65 offen offset:1024  lds
    ds_write_b128 v10, v[196:199] offset:3072
    v_mfma_f32_16x16x32_bf16 v[212:215], v[36:39], v[160:163], v[212:215]
    ds_read_b128 v[160:163], v9 offset:3648
    v_mfma_f32_16x16x32_bf16 v[200:203], v[20:23], v[164:167], v[200:203]
    v_mfma_f32_16x16x32_bf16 v[204:207], v[24:27], v[164:167], v[204:207]
    v_mfma_f32_16x16x32_bf16 v[208:211], v[28:31], v[164:167], v[208:211]
    buffer_load_dwordx4 v8, s[36:39], s65 offen offset:2048  lds
    v_mfma_f32_16x16x32_bf16 v[212:215], v[32:35], v[164:167], v[212:215]
    ds_read_b128 v[164:167], v9 offset:3136
    s_waitcnt lgkmcnt(8)
    v_mfma_f32_16x16x32_bf16 v[200:203], v[16:19], v[168:171], v[200:203]
    v_mfma_f32_16x16x32_bf16 v[204:207], v[20:23], v[168:171], v[204:207]
    s_waitcnt lgkmcnt(2)
    s_waitcnt vmcnt(15)
    s_waitcnt vmcnt(7)
    s_barrier
    ds_read_b128 v[184:187], v11 offset:0
    ds_read_b128 v[188:191], v11 offset:4096
    ds_read_b128 v[192:195], v14 offset:0
    v_mfma_f32_16x16x32_bf16 v[208:211], v[24:27], v[168:171], v[208:211]
    buffer_load_dwordx4 v8, s[40:43], s65 offen offset:3072  lds
    ds_read_b128 v[196:199], v14 offset:4096
    v_mfma_f32_16x16x32_bf16 v[212:215], v[28:31], v[168:171], v[212:215]
    ds_read_b64_tr_b16 a[48:49], v5 offset:8192
    ds_read_b128 v[168:171], v9 offset:2624
    v_mfma_f32_16x16x32_bf16 v[204:207], v[16:19], v[172:175], v[204:207]
    ds_read_b64_tr_b16 a[50:51], v5 offset:8448
    v_mfma_f32_16x16x32_bf16 v[208:211], v[20:23], v[172:175], v[208:211]
    ds_read_b64_tr_b16 a[176:177], v5 offset:12288
    s_waitcnt lgkmcnt(6)
    v_add_f32 v184, v184, v188
    v_add_f32 v185, v185, v189
    v_mfma_f32_16x16x32_bf16 v[212:215], v[24:27], v[172:175], v[212:215]
    s_xor_b32 s65, s72, 10
    s_add_u32 m0, s56, 0
    s_mul_i32 s65, s65, 114688
    buffer_load_dwordx4 v7, s[36:39], s65 offen offset:0  lds
    v_add_f32 v186, v186, v190
    v_add_f32 v187, v187, v191
    v_fmac_f32 v232, v216, v184
    v_fmac_f32 v233, v217, v185
    ds_read_b128 v[172:175], v9 offset:2112
    v_mfma_f32_16x16x32_bf16 v[208:211], v[16:19], v[176:179], v[208:211]
    ds_read_b64_tr_b16 a[178:179], v5 offset:12544
    v_fmac_f32 v234, v218, v186
    v_fmac_f32 v235, v219, v187
    v_cvt_pk_bf16_f32 v244, v232, v233
    v_cvt_pk_bf16_f32 v245, v234, v235
    v_mfma_f32_16x16x32_bf16 v[212:215], v[20:23], v[176:179], v[212:215]
    buffer_load_dwordx4 v7, s[40:43], s65 offen offset:1024  lds
    s_waitcnt lgkmcnt(6)
    v_add_f32 v192, v192, v196
    v_add_f32 v193, v193, v197
    v_add_f32 v194, v194, v198
    ds_read_b128 v[176:179], v9 offset:1600
    v_mfma_f32_16x16x32_bf16 v[212:215], v[16:19], v[180:183], v[212:215]
    ds_read_b64_tr_b16 a[52:53], v5 offset:10240
    v_add_f32 v195, v195, v199
    v_fmac_f32 v236, v220, v192
    v_fmac_f32 v237, v221, v193
    v_fmac_f32 v238, v222, v194
    ds_read_b128 v[180:183], v9 offset:1088
    v_mfma_f32_16x16x32_bf16 v[200:203], v[64:67], v[160:163], v[200:203]
    buffer_load_dwordx4 v8, s[36:39], s65 offen offset:2048  lds
    v_fmac_f32 v239, v223, v195
    v_cvt_pk_bf16_f32 v246, v236, v237
    v_cvt_pk_bf16_f32 v247, v238, v239
    global_store_dwordx4 v12, v[244:247], s[58:59] sc1
    v_mfma_f32_16x16x32_bf16 v[204:207], v[68:71], v[160:163], v[204:207]
    ds_read_b64_tr_b16 a[54:55], v5 offset:10496
    v_add_u32 v12, 0x100000, v12
    v_mfma_f32_16x16x32_bf16 v[208:211], v[72:75], v[160:163], v[208:211]
    ds_read_b64_tr_b16 a[180:181], v5 offset:14336
    v_mfma_f32_16x16x32_bf16 v[212:215], v[76:79], v[160:163], v[212:215]
    ds_read_b64_tr_b16 a[182:183], v5 offset:14592
    ds_read_b128 v[160:163], v9 offset:576
    v_mfma_f32_16x16x32_bf16 v[200:203], v[60:63], v[164:167], v[200:203]
    buffer_load_dwordx4 v8, s[40:43], s65 offen offset:3072  lds
    v_mfma_f32_16x16x32_bf16 v[204:207], v[64:67], v[164:167], v[204:207]
    ds_read_b64_tr_b16 a[56:57], v5 offset:16384
    v_mfma_f32_16x16x32_bf16 v[208:211], v[68:71], v[164:167], v[208:211]
    ds_read_b64_tr_b16 a[58:59], v5 offset:16640
    v_mfma_f32_16x16x32_bf16 v[212:215], v[72:75], v[164:167], v[212:215]
    ds_read_b64_tr_b16 a[184:185], v5 offset:20480
    ds_read_b128 v[164:167], v9 offset:64
    s_waitcnt lgkmcnt(12)
    v_mfma_f32_16x16x32_bf16 v[200:203], v[56:59], v[168:171], v[200:203]
    ds_read_b64_tr_b16 a[186:187], v5 offset:20736
    v_mfma_f32_16x16x32_bf16 v[204:207], v[60:63], v[168:171], v[204:207]
    ds_read_b64_tr_b16 a[60:61], v5 offset:18432
    v_mfma_f32_16x16x32_bf16 v[208:211], v[64:67], v[168:171], v[208:211]
    ds_read_b64_tr_b16 a[62:63], v5 offset:18688
    v_mfma_f32_16x16x32_bf16 v[212:215], v[68:71], v[168:171], v[212:215]
    s_waitcnt vmcnt(9)
    s_waitcnt lgkmcnt(8)
    s_barrier
    s_xor_b32 s65, s72, 11
    s_add_u32 m0, s56, 8192
    s_mul_i32 s65, s65, 114688
    buffer_load_dwordx4 v7, s[36:39], s65 offen offset:0  lds
    v_mfma_f32_16x16x32_bf16 v[248:251], a[48:51], v[144:147], v[248:251]
    ds_read_b64_tr_b16 a[188:189], v5 offset:22528
    ds_read_b128 v[168:171], v9 offset:3712
    v_mfma_f32_16x16x32_bf16 v[200:203], v[52:55], v[172:175], v[200:203]
    ds_read_b64_tr_b16 a[190:191], v5 offset:22784
    v_mfma_f32_16x16x32_bf16 v[252:255], a[176:179], v[144:147], v[252:255]
    ds_read_b64_tr_b16 a[64:65], v5 offset:24576
    v_mfma_f32_16x16x32_bf16 v[204:207], v[56:59], v[172:175], v[204:207]
    buffer_load_dwordx4 v7, s[40:43], s65 offen offset:1024  lds
    v_mfma_f32_16x16x32_bf16 v[248:251], a[52:55], v[144:147], v[248:251]
    ds_read_b64_tr_b16 a[66:67], v5 offset:24832
    v_mfma_f32_16x16x32_bf16 v[208:211], v[60:63], v[172:175], v[208:211]
    ds_read_b64_tr_b16 a[192:193], v5 offset:28672
    v_mfma_f32_16x16x32_bf16 v[252:255], a[180:183], v[144:147], v[252:255]
    ds_read_b64_tr_b16 a[194:195], v5 offset:28928
    v_mfma_f32_16x16x32_bf16 v[212:215], v[64:67], v[172:175], v[212:215]
    buffer_load_dwordx4 v8, s[36:39], s65 offen offset:2048  lds
    ds_read_b128 v[172:175], v9 offset:3200
    v_mfma_f32_16x16x32_bf16 v[200:203], v[48:51], v[176:179], v[200:203]
    ds_read_b64_tr_b16 a[68:69], v5 offset:26624
    v_mfma_f32_16x16x32_bf16 v[204:207], v[52:55], v[176:179], v[204:207]
    ds_read_b64_tr_b16 a[70:71], v5 offset:26880
    s_waitcnt lgkmcnt(7)
    v_mfma_f32_16x16x32_bf16 v[248:251], a[56:59], v[144:147], v[248:251]
    ds_read_b64_tr_b16 a[196:197], v5 offset:30720
    v_mfma_f32_16x16x32_bf16 v[208:211], v[56:59], v[176:179], v[208:211]
    buffer_load_dwordx4 v8, s[40:43], s65 offen offset:3072  lds
    v_mfma_f32_16x16x32_bf16 v[252:255], a[184:187], v[144:147], v[252:255]
    ds_read_b64_tr_b16 a[198:199], v5 offset:30976
    v_mfma_f32_16x16x32_bf16 v[212:215], v[60:63], v[176:179], v[212:215]
    ds_read_b128 v[240:243], v0 offset:2048
    v_mfma_f32_16x16x32_bf16 v[248:251], a[60:63], v[144:147], v[248:251]
    ds_read_b128 v[216:219], v6 offset:8192
    ds_read_b128 v[176:179], v9 offset:2688
    v_mfma_f32_16x16x32_bf16 v[204:207], v[48:51], v[180:183], v[204:207]
    s_waitcnt vmcnt(9)
    s_barrier
    s_xor_b32 s65, s72, 12
    s_add_u32 m0, s56, 16384
    s_mul_i32 s65, s65, 114688
    buffer_load_dwordx4 v7, s[36:39], s65 offen offset:0  lds
    v_mfma_f32_16x16x32_bf16 v[252:255], a[188:191], v[144:147], v[252:255]
    ds_read_b64_tr_b16 a[72:73], v5 offset:32768
    v_mfma_f32_16x16x32_bf16 v[208:211], v[52:55], v[180:183], v[208:211]
    ds_read_b64_tr_b16 a[74:75], v5 offset:33024
    s_waitcnt lgkmcnt(5)
    v_mfma_f32_16x16x32_bf16 v[248:251], a[64:67], v[144:147], v[248:251]
    ds_read_b64_tr_b16 a[200:201], v5 offset:36864
    v_mfma_f32_16x16x32_bf16 v[212:215], v[56:59], v[180:183], v[212:215]
    buffer_load_dwordx4 v7, s[40:43], s65 offen offset:1024  lds
    v_mfma_f32_16x16x32_bf16 v[252:255], a[192:195], v[144:147], v[252:255]
    ds_read_b64_tr_b16 a[202:203], v5 offset:37120
    ds_read_b128 v[180:183], v9 offset:2176
    v_mfma_f32_16x16x32_bf16 v[208:211], v[48:51], v[160:163], v[208:211]
    ds_read_b64_tr_b16 a[76:77], v5 offset:34816
    v_mfma_f32_16x16x32_bf16 v[248:251], a[68:71], v[144:147], v[248:251]
    ds_read_b64_tr_b16 a[78:79], v5 offset:35072
    v_mfma_f32_16x16x32_bf16 v[212:215], v[52:55], v[160:163], v[212:215]
    buffer_load_dwordx4 v8, s[36:39], s65 offen offset:2048  lds
    v_mfma_f32_16x16x32_bf16 v[252:255], a[196:199], v[144:147], v[252:255]
    ds_read_b64_tr_b16 a[204:205], v5 offset:38912
    ds_read_b128 v[160:163], v9 offset:1664
    v_mfma_f32_16x16x32_bf16 v[212:215], v[48:51], v[164:167], v[212:215]
    ds_read_b64_tr_b16 a[206:207], v5 offset:39168
    ds_read_b128 v[164:167], v9 offset:1152
    v_mfma_f32_16x16x32_bf16 v[200:203], v[96:99], v[168:171], v[200:203]
    ds_read_b128 v[220:223], v6 offset:8208
    v_mfma_f32_16x16x32_bf16 v[204:207], v[100:103], v[168:171], v[204:207]
    buffer_load_dwordx4 v8, s[40:43], s65 offen offset:3072  lds
    v_mfma_f32_16x16x32_bf16 v[208:211], v[104:107], v[168:171], v[208:211]
    ds_read_b128 v[224:227], v6 offset:8224
    v_mfma_f32_16x16x32_bf16 v[212:215], v[108:111], v[168:171], v[212:215]
    ds_read_b128 v[228:231], v6 offset:8240
    ds_read_b128 v[168:171], v9 offset:640
    v_mfma_f32_16x16x32_bf16 v[200:203], v[92:95], v[172:175], v[200:203]
    v_mfma_f32_16x16x32_bf16 v[204:207], v[96:99], v[172:175], v[204:207]
    s_barrier
    s_xor_b32 s65, s72, 13
    s_add_u32 m0, s56, 24576
    s_mul_i32 s65, s65, 114688
    buffer_load_dwordx4 v7, s[36:39], s65 offen offset:0  lds
    s_waitcnt lgkmcnt(5)
    v_mfma_f32_16x16x32_bf16 v[248:251], a[72:75], v[144:147], v[248:251]
    v_mfma_f32_16x16x32_bf16 v[208:211], v[100:103], v[172:175], v[208:211]
    v_mfma_f32_16x16x32_bf16 v[212:215], v[104:107], v[172:175], v[212:215]
    global_load_dword v15, v13, s[28:29] sc1
    v_mfma_f32_16x16x32_bf16 v[252:255], a[200:203], v[144:147], v[252:255]
    s_waitcnt lgkmcnt(1)
    ds_read_b128 v[172:175], v9 offset:128
    v_mfma_f32_16x16x32_bf16 v[200:203], v[88:91], v[176:179], v[200:203]
    s_barrier
    v_mfma_f32_16x16x32_bf16 v[248:251], a[76:79], v[144:147], v[248:251]
    v_lshlrev_b32 v232, 16, v240
    v_sub_f32 v216, v232, v216
    v_mfma_f32_16x16x32_bf16 v[204:207], v[92:95], v[176:179], v[204:207]
    v_mul_f32 v216, v216, v224
    v_and_b32 v233, s76, v240
    v_mfma_f32_16x16x32_bf16 v[252:255], a[204:207], v[144:147], v[252:255]
    s_waitcnt vmcnt(10)
    s_barrier
    v_mfma_f32_16x16x32_bf16 v[208:211], v[96:99], v[176:179], v[208:211]
    ds_read_b64_tr_b16 a[80:81], v5 offset:0
    v_mfma_f32_16x16x32_bf16 v[212:215], v[100:103], v[176:179], v[212:215]
    ds_read_b64_tr_b16 a[82:83], v5 offset:256
    ds_read_b128 v[176:179], v9 offset:3776
    v_mfma_f32_16x16x32_bf16 v[200:203], v[84:87], v[180:183], v[200:203]
    ds_read_b64_tr_b16 a[208:209], v5 offset:4096
    v_mfma_f32_16x16x32_bf16 v[204:207], v[88:91], v[180:183], v[204:207]
    ds_read_b64_tr_b16 a[210:211], v5 offset:4352
    v_mfma_f32_16x16x32_bf16 v[208:211], v[92:95], v[180:183], v[208:211]
    ds_read_b64_tr_b16 a[84:85], v5 offset:2048
    v_mfma_f32_16x16x32_bf16 v[212:215], v[96:99], v[180:183], v[212:215]
    ds_read_b64_tr_b16 a[86:87], v5 offset:2304
    ds_read_b128 v[180:183], v9 offset:3264
    v_mfma_f32_16x16x32_bf16 v[200:203], v[80:83], v[160:163], v[200:203]
    ds_read_b64_tr_b16 a[212:213], v5 offset:6144
    v_mfma_f32_16x16x32_bf16 v[204:207], v[84:87], v[160:163], v[204:207]
    buffer_load_dwordx4 v7, s[40:43], s65 offen offset:1024  lds
    v_mfma_f32_16x16x32_bf16 v[208:211], v[88:91], v[160:163], v[208:211]
    ds_read_b64_tr_b16 a[214:215], v5 offset:6400
    v_mfma_f32_16x16x32_bf16 v[212:215], v[92:95], v[160:163], v[212:215]
    v_sub_f32 v217, v233, v217
    ds_read_b128 v[160:163], v9 offset:2752
    v_mfma_f32_16x16x32_bf16 v[204:207], v[80:83], v[164:167], v[204:207]
    v_mul_f32 v217, v217, v225
    v_lshlrev_b32 v234, 16, v241
    v_mfma_f32_16x16x32_bf16 v[208:211], v[84:87], v[164:167], v[208:211]
    buffer_load_dwordx4 v8, s[36:39], s65 offen offset:2048  lds
    v_mfma_f32_16x16x32_bf16 v[212:215], v[88:91], v[164:167], v[212:215]
    v_sub_f32 v218, v234, v218
    ds_read_b128 v[164:167], v9 offset:2240
    s_waitcnt lgkmcnt(12)
    v_mfma_f32_16x16x32_bf16 v[208:211], v[80:83], v[168:171], v[208:211]
    v_mul_f32 v218, v218, v226
    v_and_b32 v235, s76, v241
    v_mfma_f32_16x16x32_bf16 v[212:215], v[84:87], v[168:171], v[212:215]
    v_sub_f32 v219, v235, v219
    ds_read_b128 v[168:171], v9 offset:1728
    v_mfma_f32_16x16x32_bf16 v[212:215], v[80:83], v[172:175], v[212:215]
    buffer_load_dwordx4 v8, s[40:43], s65 offen offset:3072  lds
    ds_read_b128 v[172:175], v9 offset:1216
    s_waitcnt lgkmcnt(6)
    v_mfma_f32_16x16x32_bf16 v[200:203], v[128:131], v[176:179], v[200:203]
    s_waitcnt vmcnt(9)
    s_waitcnt lgkmcnt(4)
    s_barrier
    v_mfma_f32_16x16x32_bf16 v[204:207], v[132:135], v[176:179], v[204:207]
    s_xor_b32 s65, s72, 14
    s_add_u32 m0, s56, 32768
    s_mul_i32 s65, s65, 114688
    buffer_load_dwordx4 v7, s[36:39], s65 offen offset:0  lds
    v_mfma_f32_16x16x32_bf16 v[208:211], v[136:139], v[176:179], v[208:211]
    ds_read_b64_tr_b16 a[88:89], v5 offset:8192
    v_mfma_f32_16x16x32_bf16 v[212:215], v[140:143], v[176:179], v[212:215]
    ds_read_b64_tr_b16 a[90:91], v5 offset:8448
    ds_read_b128 v[176:179], v9 offset:704
    v_mfma_f32_16x16x32_bf16 v[200:203], v[124:127], v[180:183], v[200:203]
    ds_read_b64_tr_b16 a[216:217], v5 offset:12288
    v_mfma_f32_16x16x32_bf16 v[204:207], v[128:131], v[180:183], v[204:207]
    ds_read_b64_tr_b16 a[218:219], v5 offset:12544
    v_mfma_f32_16x16x32_bf16 v[208:211], v[132:135], v[180:183], v[208:211]
    ds_read_b64_tr_b16 a[92:93], v5 offset:10240
    v_mfma_f32_16x16x32_bf16 v[212:215], v[136:139], v[180:183], v[212:215]
    ds_read_b64_tr_b16 a[94:95], v5 offset:10496
    ds_read_b128 v[180:183], v9 offset:192
    s_waitcnt lgkmcnt(10)
    v_mfma_f32_16x16x32_bf16 v[200:203], v[120:123], v[160:163], v[200:203]
    ds_read_b64_tr_b16 a[220:221], v5 offset:14336
    v_mfma_f32_16x16x32_bf16 v[204:207], v[124:127], v[160:163], v[204:207]
    ds_read_b64_tr_b16 a[222:223], v5 offset:14592
    v_mfma_f32_16x16x32_bf16 v[208:211], v[128:131], v[160:163], v[208:211]
    v_mul_f32 v219, v219, v227
    v_lshlrev_b32 v236, 16, v242
    v_mfma_f32_16x16x32_bf16 v[212:215], v[132:135], v[160:163], v[212:215]
    v_sub_f32 v220, v236, v220
    v_mfma_f32_16x16x32_bf16 v[200:203], v[116:119], v[164:167], v[200:203]
    v_mul_f32 v220, v220, v228
    v_and_b32 v237, s76, v242
    v_mfma_f32_16x16x32_bf16 v[204:207], v[120:123], v[164:167], v[204:207]
    s_waitcnt vmcnt(4)
    v_cmp_ne_u32 vcc, 16, v15
    s_cbranch_vccnz slow_pok_7
pok_7:
    v_mfma_f32_16x16x32_bf16 v[208:211], v[124:127], v[164:167], v[208:211]
    s_add_u32 m0, s73, 0
    s_nop 0
    buffer_load_dwordx4 v149, s[32:35], s66 offen offset:0 sc1 lds
    v_mfma_f32_16x16x32_bf16 v[212:215], v[128:131], v[164:167], v[212:215]
    v_sub_f32 v221, v237, v221
    s_waitcnt lgkmcnt(10)
    v_mfma_f32_16x16x32_bf16 v[200:203], v[112:115], v[168:171], v[200:203]
    v_mul_f32 v221, v221, v229
    v_lshlrev_b32 v238, 16, v243
    v_mfma_f32_16x16x32_bf16 v[204:207], v[116:119], v[168:171], v[204:207]
    buffer_load_dwordx4 v149, s[32:35], s66 offen offset:1024 sc1 lds
    v_mfma_f32_16x16x32_bf16 v[208:211], v[120:123], v[168:171], v[208:211]
    s_waitcnt lgkmcnt(0)
    s_barrier
    v_mfma_f32_16x16x32_bf16 v[212:215], v[124:127], v[168:171], v[212:215]
    buffer_load_dwordx4 v149, s[32:35], s67 offen offset:2048 sc1 lds
    v_mfma_f32_16x16x32_bf16 v[204:207], v[112:115], v[172:175], v[204:207]
    ds_read_b64_tr_b16 a[96:97], v5 offset:16384
    v_mfma_f32_16x16x32_bf16 v[208:211], v[116:119], v[172:175], v[208:211]
    ds_read_b64_tr_b16 a[98:99], v5 offset:16640
    v_mfma_f32_16x16x32_bf16 v[212:215], v[120:123], v[172:175], v[212:215]
    buffer_load_dwordx4 v149, s[32:35], s67 offen offset:3072 sc1 lds
    v_mfma_f32_16x16x32_bf16 v[208:211], v[112:115], v[176:179], v[208:211]
    ds_read_b64_tr_b16 a[224:225], v5 offset:20480
    v_mfma_f32_16x16x32_bf16 v[212:215], v[116:119], v[176:179], v[212:215]
    ds_read_b64_tr_b16 a[226:227], v5 offset:20736
    v_mfma_f32_16x16x32_bf16 v[212:215], v[112:115], v[180:183], v[212:215]
    s_add_u32 m0, s73, 4096
    s_nop 0
    buffer_load_dwordx4 v149, s[32:35], s68 offen offset:0 sc1 lds
    v_sub_f32 v222, v238, v222
    v_mul_f32 v222, v222, v230
    v_and_b32 v239, s76, v243
    v_sub_f32 v223, v239, v223
    v_mul_f32 v223, v223, v231
    ds_read_b64_tr_b16 a[100:101], v5 offset:18432
    ds_read_b64_tr_b16 a[102:103], v5 offset:18688
    ds_read_b64_tr_b16 a[228:229], v5 offset:22528
    ds_read_b64_tr_b16 a[230:231], v5 offset:22784
    buffer_load_dwordx4 v149, s[32:35], s68 offen offset:1024 sc1 lds
    s_nop 2
    s_nop 3
    ds_write_b128 v10, v[200:203] offset:43008
    ds_write_b128 v10, v[204:207] offset:44032
    ds_write_b128 v10, v[208:211] offset:45056
    ds_write_b128 v10, v[212:215] offset:46080
    v_mfma_f32_16x16x32_bf16 v[248:251], a[80:83], v[144:147], v[248:251]
    v_mfma_f32_16x16x32_bf16 v[252:255], a[208:211], v[144:147], v[252:255]
    buffer_load_dwordx4 v149, s[32:35], s69 offen offset:2048 sc1 lds
    v_mfma_f32_16x16x32_bf16 v[248:251], a[84:87], v[144:147], v[248:251]
    v_mfma_f32_16x16x32_bf16 v[252:255], a[212:215], v[144:147], v[252:255]
    v_mfma_f32_16x16x32_bf16 v[248:251], a[88:91], v[144:147], v[248:251]
    buffer_load_dwordx4 v149, s[32:35], s69 offen offset:3072 sc1 lds
    v_add_u32 v149, s8, v149
    v_mfma_f32_16x16x32_bf16 v[252:255], a[216:219], v[144:147], v[252:255]
    v_mfma_f32_16x16x32_bf16 v[248:251], a[92:95], v[144:147], v[248:251]
    v_mfma_f32_16x16x32_bf16 v[252:255], a[220:223], v[144:147], v[252:255]
    s_waitcnt lgkmcnt(4)
    v_mfma_f32_16x16x32_bf16 v[248:251], a[96:99], v[144:147], v[248:251]
    s_add_u32 m0, s56, 32768
    s_nop 0
    buffer_load_dwordx4 v7, s[40:43], s65 offen offset:1024  lds
    v_mfma_f32_16x16x32_bf16 v[252:255], a[224:227], v[144:147], v[252:255]
    v_mfma_f32_16x16x32_bf16 v[248:251], a[100:103], v[144:147], v[248:251]
    v_mfma_f32_16x16x32_bf16 v[252:255], a[228:231], v[144:147], v[252:255]
    s_waitcnt lgkmcnt(0)
    s_waitcnt vmcnt(10)
    s_barrier
    ds_read_b128 v[200:203], v11 offset:43008
    ds_read_b128 v[204:207], v11 offset:47104
    ds_read_b128 v[208:211], v14 offset:43008
    ds_read_b128 v[212:215], v14 offset:47104
    buffer_load_dwordx4 v8, s[36:39], s65 offen offset:2048  lds
    ds_read_b64_tr_b16 a[104:105], v5 offset:24576
    ds_read_b64_tr_b16 a[106:107], v5 offset:24832
    ds_read_b64_tr_b16 a[232:233], v5 offset:28672
    ds_read_b64_tr_b16 a[234:235], v5 offset:28928
    ds_read_b64_tr_b16 a[108:109], v5 offset:26624
    ds_read_b64_tr_b16 a[110:111], v5 offset:26880
    ds_read_b64_tr_b16 a[236:237], v5 offset:30720
    ds_read_b64_tr_b16 a[238:239], v5 offset:30976
    s_waitcnt lgkmcnt(10)
    v_add_f32 v200, v200, v204
    v_add_f32 v201, v201, v205
    v_add_f32 v202, v202, v206
    v_add_f32 v203, v203, v207
    v_fmac_f32 v232, v216, v200
    v_fmac_f32 v233, v217, v201
    v_fmac_f32 v234, v218, v202
    v_fmac_f32 v235, v219, v203
    v_cvt_pk_bf16_f32 v244, v232, v233
    v_cvt_pk_bf16_f32 v245, v234, v235
    s_waitcnt lgkmcnt(8)
    v_add_f32 v208, v208, v212
    v_add_f32 v209, v209, v213
    v_add_f32 v210, v210, v214
    v_add_f32 v211, v211, v215
    v_fmac_f32 v236, v220, v208
    v_fmac_f32 v237, v221, v209
    v_fmac_f32 v238, v222, v210
    v_fmac_f32 v239, v223, v211
    v_cvt_pk_bf16_f32 v246, v236, v237
    v_cvt_pk_bf16_f32 v247, v238, v239
    global_store_dwordx4 v12, v[244:247], s[58:59] sc1
    v_add_u32 v12, 0x100000, v12
    s_waitcnt lgkmcnt(0)
    v_mfma_f32_16x16x32_bf16 v[248:251], a[104:107], v[144:147], v[248:251]
    v_mfma_f32_16x16x32_bf16 v[252:255], a[232:235], v[144:147], v[252:255]
    v_mfma_f32_16x16x32_bf16 v[248:251], a[108:111], v[144:147], v[248:251]
    v_mfma_f32_16x16x32_bf16 v[252:255], a[236:239], v[144:147], v[252:255]
    buffer_load_dwordx4 v8, s[40:43], s65 offen offset:3072  lds
    s_xor_b32 s65, s72, 15
    s_add_u32 m0, s56, 0
    s_mul_i32 s65, s65, 114688
    buffer_load_dwordx4 v7, s[36:39], s65 offen offset:0  lds
    buffer_load_dwordx4 v7, s[40:43], s65 offen offset:1024  lds
    buffer_load_dwordx4 v8, s[36:39], s65 offen offset:2048  lds
    buffer_load_dwordx4 v8, s[40:43], s65 offen offset:3072  lds
    v_add_u32 v13, 0x8000, v13
    v_add_u32 v129, 14336, v150
    s_waitcnt vmcnt(8)
    ds_read_b128 v[48:51], v156 offset:0
    ds_read_b128 v[52:55], v156 offset:1024
    ds_read_b128 v[56:59], v156 offset:2048
    ds_read_b128 v[60:63], v156 offset:3072
    ds_read_b128 v[64:67], v156 offset:4096
    ds_read_b128 v[68:71], v156 offset:5120
    ds_read_b128 v[72:75], v156 offset:6144
    ds_read_b128 v[76:79], v156 offset:7168
    s_waitcnt lgkmcnt(4)
    v_max_u32 v48, v48, v49
    v_max3_u32 v48, v48, v50, v51
    v_max3_u32 v48, v48, v52, v53
    v_max3_u32 v48, v48, v54, v55
    v_max3_u32 v48, v48, v56, v57
    v_max3_u32 v48, v48, v58, v59
    v_max3_u32 v48, v48, v60, v61
    v_max3_u32 v48, v48, v62, v63
    s_waitcnt lgkmcnt(0)
    v_max3_u32 v48, v48, v64, v65
    v_max3_u32 v48, v48, v66, v67
    v_max3_u32 v48, v48, v68, v69
    v_max3_u32 v48, v48, v70, v71
    v_max3_u32 v48, v48, v72, v73
    v_max3_u32 v48, v48, v74, v75
    v_max3_u32 v48, v48, v76, v77
    v_max3_u32 v48, v48, v78, v79
    v_cmp_eq_u32 vcc, -1, v48
    s_cbranch_vccnz slow_pok_9
pok_9:
    s_waitcnt lgkmcnt(0)
    s_barrier
    ds_read_b64_tr_b16 v[80:81], v1 offset:0
    ds_read_b64_tr_b16 v[82:83], v1 offset:256
    ds_read_b64_tr_b16 v[84:85], v1 offset:1024
    ds_read_b64_tr_b16 v[86:87], v1 offset:1280
    ds_read_b64_tr_b16 v[88:89], v1 offset:2048
    ds_read_b64_tr_b16 v[90:91], v1 offset:2304
    ds_read_b64_tr_b16 v[92:93], v1 offset:3072
    ds_read_b64_tr_b16 v[94:95], v1 offset:3328
    ds_read_b64_tr_b16 v[96:97], v1 offset:4096
    ds_read_b64_tr_b16 v[98:99], v1 offset:4352
    s_waitcnt lgkmcnt(6)
    v_mfma_f32_32x32x16_bf16 v[16:31], a[0:3], v[80:83], 0
    ds_read_b64_tr_b16 v[100:101], v1 offset:5120
    s_add_u32 m0, s73, 32768
    s_nop 0
    buffer_load_dwordx4 v149, s[32:35], s66 offen offset:0 sc1 lds
    v_mfma_f32_32x32x16_bf16 v[32:47], a[128:131], v[80:83], 0
    ds_read_b64_tr_b16 v[102:103], v1 offset:5376
    v_mfma_f32_32x32x16_bf16 v[16:31], a[4:7], v[84:87], v[16:31]
    ds_read_b64_tr_b16 v[104:105], v1 offset:6144
    buffer_load_dwordx4 v149, s[32:35], s66 offen offset:1024 sc1 lds
    v_mfma_f32_32x32x16_bf16 v[32:47], a[132:135], v[84:87], v[32:47]
    ds_read_b64_tr_b16 v[106:107], v1 offset:6400
    s_waitcnt lgkmcnt(6)
    v_mfma_f32_32x32x16_bf16 v[16:31], a[8:11], v[88:91], v[16:31]
    ds_read_b64_tr_b16 v[108:109], v1 offset:7168
    buffer_load_dwordx4 v149, s[32:35], s67 offen offset:2048 sc1 lds
    v_mov_b32 v130, v148
    v_mfma_f32_32x32x16_bf16 v[32:47], a[136:139], v[88:91], v[32:47]
    ds_read_b64_tr_b16 v[110:111], v1 offset:7424
    v_mfma_f32_32x32x16_bf16 v[16:31], a[12:15], v[92:95], v[16:31]
    ds_read_b64_tr_b16 v[80:81], v1 offset:8192
    buffer_load_dwordx4 v149, s[32:35], s67 offen offset:3072 sc1 lds
    v_mfma_f32_32x32x16_bf16 v[32:47], a[140:143], v[92:95], v[32:47]
    ds_read_b64_tr_b16 v[82:83], v1 offset:8448
    s_waitcnt lgkmcnt(6)
    s_waitcnt vmcnt(9)
    s_barrier
    s_cmp_lg_u32 s3, 0
    s_cbranch_scc1 pub_13
    s_lshr_b32 s57, s77, 11
    s_lshl_b32 s57, s57, 7
    s_add_u32 s57, s57, 98304
    v_mov_b32 v158, s57
    v_mov_b32 v159, 1
    s_mov_b64 exec, 1
    global_atomic_add v158, v159, s[28:29] sc1
    s_mov_b64 exec, -1
pub_13:
    v_mfma_f32_32x32x16_bf16 v[16:31], a[16:19], v[96:99], v[16:31]
    ds_read_b64_tr_b16 v[84:85], v1 offset:9216
    s_waitcnt vmcnt(8)
    s_barrier
    v_mfma_f32_32x32x16_bf16 v[32:47], a[144:147], v[96:99], v[32:47]
    ds_read_b64_tr_b16 v[86:87], v1 offset:9472
    ds_read_b64_tr_b16 a[112:113], v5 offset:32768
    ds_read_b64_tr_b16 a[114:115], v5 offset:33024
    ds_read_b64_tr_b16 a[240:241], v5 offset:36864
    ds_read_b64_tr_b16 a[242:243], v5 offset:37120
    v_mfma_f32_32x32x16_bf16 v[16:31], a[20:23], v[100:103], v[16:31]
    ds_read_b64_tr_b16 v[88:89], v1 offset:10240
    ds_read_b64_tr_b16 a[116:117], v5 offset:34816
    ds_read_b64_tr_b16 a[118:119], v5 offset:35072
    ds_read_b64_tr_b16 a[244:245], v5 offset:38912
    ds_read_b64_tr_b16 a[246:247], v5 offset:39168
    v_mfma_f32_32x32x16_bf16 v[32:47], a[148:151], v[100:103], v[32:47]
    ds_read_b64_tr_b16 v[90:91], v1 offset:10496
    s_waitcnt lgkmcnt(14)
    s_add_u32 m0, s73, 36864
    s_nop 0
    buffer_load_dwordx4 v149, s[32:35], s68 offen offset:0 sc1 lds
    v_mfma_f32_32x32x16_bf16 v[16:31], a[24:27], v[104:107], v[16:31]
    ds_read_b64_tr_b16 v[92:93], v1 offset:11264
    v_mfma_f32_32x32x16_bf16 v[32:47], a[152:155], v[104:107], v[32:47]
    ds_read_b64_tr_b16 v[94:95], v1 offset:11520
    buffer_load_dwordx4 v149, s[32:35], s68 offen offset:1024 sc1 lds
    v_mfma_f32_32x32x16_bf16 v[16:31], a[28:31], v[108:111], v[16:31]
    ds_read_b64_tr_b16 v[96:97], v1 offset:12288
    v_mfma_f32_32x32x16_bf16 v[32:47], a[156:159], v[108:111], v[32:47]
    ds_read_b64_tr_b16 v[98:99], v1 offset:12544
    s_waitcnt lgkmcnt(14)
    s_waitcnt vmcnt(6)
    s_waitcnt lgkmcnt(5)
    s_barrier
    v_mfma_f32_16x16x32_bf16 v[248:251], a[112:115], v[144:147], v[248:251]
    v_mfma_f32_16x16x32_bf16 v[252:255], a[240:243], v[144:147], v[252:255]
    v_mfma_f32_16x16x32_bf16 v[248:251], a[116:119], v[144:147], v[248:251]
    v_mfma_f32_16x16x32_bf16 v[252:255], a[244:247], v[144:147], v[252:255]
    buffer_load_dwordx4 v149, s[32:35], s69 offen offset:2048 sc1 lds
    v_mfma_f32_32x32x16_bf16 v[16:31], a[32:35], v[80:83], v[16:31]
    ds_read_b64_tr_b16 v[100:101], v1 offset:13312
    ds_read_b64_tr_b16 a[120:121], v5 offset:0
    ds_read_b64_tr_b16 a[122:123], v5 offset:256
    ds_read_b64_tr_b16 a[248:249], v5 offset:4096
    ds_read_b64_tr_b16 a[250:251], v5 offset:4352
    v_mfma_f32_32x32x16_bf16 v[32:47], a[160:163], v[80:83], v[32:47]
    ds_read_b64_tr_b16 v[102:103], v1 offset:13568
    ds_read_b64_tr_b16 a[124:125], v5 offset:2048
    ds_read_b64_tr_b16 a[126:127], v5 offset:2304
    ds_read_b64_tr_b16 a[252:253], v5 offset:6144
    ds_read_b64_tr_b16 a[254:255], v5 offset:6400
    v_mfma_f32_32x32x16_bf16 v[16:31], a[36:39], v[84:87], v[16:31]
    ds_read_b64_tr_b16 v[104:105], v1 offset:14336
    buffer_load_dwordx4 v149, s[32:35], s69 offen offset:3072 sc1 lds
    v_add_u32 v149, s8, v149
    v_mfma_f32_32x32x16_bf16 v[32:47], a[164:167], v[84:87], v[32:47]
    ds_read_b64_tr_b16 v[106:107], v1 offset:14592
    s_waitcnt lgkmcnt(14)
    v_mfma_f32_32x32x16_bf16 v[16:31], a[40:43], v[88:91], v[16:31]
    ds_read_b64_tr_b16 v[108:109], v1 offset:15360
    s_add_u32 m0, s56, 8192
    s_xor_b32 s9, s10, 0
    buffer_load_dwordx4 v150, s[4:7], s9 offen offset:0 lds
    v_mfma_f32_32x32x16_bf16 v[32:47], a[168:171], v[88:91], v[32:47]
    ds_read_b64_tr_b16 v[110:111], v1 offset:15616
    v_mfma_f32_32x32x16_bf16 v[16:31], a[44:47], v[92:95], v[16:31]
    ds_read_b64_tr_b16 v[80:81], v1 offset:16384
    s_waitcnt lgkmcnt(5)
    v_mfma_f32_16x16x32_bf16 v[248:251], a[120:123], v[144:147], v[248:251]
    v_mfma_f32_16x16x32_bf16 v[252:255], a[248:251], v[144:147], v[252:255]
    v_mfma_f32_16x16x32_bf16 v[248:251], a[124:127], v[144:147], v[248:251]
    v_mfma_f32_16x16x32_bf16 v[252:255], a[252:255], v[144:147], v[252:255]
    buffer_load_dwordx4 v150, s[12:15], s9 offen offset:1024 lds
    v_mfma_f32_32x32x16_bf16 v[32:47], a[172:175], v[92:95], v[32:47]
    ds_read_b64_tr_b16 v[82:83], v1 offset:16640
    v_mfma_f32_32x32x16_bf16 v[16:31], a[48:51], v[96:99], v[16:31]
    ds_read_b64_tr_b16 v[84:85], v1 offset:17408
    buffer_load_dwordx4 v129, s[4:7], s9 offen offset:2048 lds
    v_mfma_f32_32x32x16_bf16 v[32:47], a[176:179], v[96:99], v[32:47]
    ds_read_b64_tr_b16 v[86:87], v1 offset:17664
    s_lshl_b32 s49, s3, 8
    s_add_u32 s49, s49, 151552
    v_lshlrev_b32 v132, 6, v3
    v_lshl_add_u32 v132, v4, 4, v132
    v_mfma_f32_32x32x16_bf16 v[16:31], a[52:55], v[100:103], v[16:31]
    ds_read_b64_tr_b16 v[88:89], v1 offset:18432
    buffer_load_dwordx4 v129, s[12:15], s9 offen offset:3072 lds
    v_add_u32 v132, s49, v132
    v_and_b32 v133, 31, v2
    v_mfma_f32_32x32x16_bf16 v[32:47], a[180:183], v[100:103], v[32:47]
    ds_read_b64_tr_b16 v[90:91], v1 offset:18688
    s_waitcnt lgkmcnt(6)
    v_lshl_add_u32 v133, v133, 2, s49
    v_mov_b32 v113, 0
    v_mov_b32 v117, 0
    v_mfma_f32_32x32x16_bf16 v[16:31], a[56:59], v[104:107], v[16:31]
    ds_read_b64_tr_b16 v[92:93], v1 offset:19456
    s_add_u32 m0, s56, 16384
    s_xor_b32 s9, s10, 32768
    buffer_load_dwordx4 v150, s[4:7], s9 offen offset:0 lds
    v_mfma_f32_32x32x16_bf16 v[32:47], a[184:187], v[104:107], v[32:47]
    ds_read_b64_tr_b16 v[94:95], v1 offset:19712
    v_mov_b32 v140, -1
    v_mov_b32 v141, -1
    v_mov_b32 v142, -1
    v_mov_b32 v143, -1
    v_mov_b32 v121, 0
    v_mfma_f32_32x32x16_bf16 v[16:31], a[60:63], v[108:111], v[16:31]
    ds_read_b64_tr_b16 v[96:97], v1 offset:20480
    global_store_dwordx4 v130, v[140:143], s[60:61] sc1
    v_mov_b32 v114, 0
    v_mov_b32 v118, 0
    v_mov_b32 v122, 0
    v_mfma_f32_32x32x16_bf16 v[32:47], a[188:191], v[108:111], v[32:47]
    ds_read_b64_tr_b16 v[98:99], v1 offset:20736
    s_waitcnt lgkmcnt(6)
    v_mov_b32 v115, 0
    v_mov_b32 v119, 0
    v_mov_b32 v123, 0
    v_mfma_f32_32x32x16_bf16 v[16:31], a[64:67], v[80:83], v[16:31]
    ds_read_b64_tr_b16 v[100:101], v1 offset:21504
    global_store_dwordx4 v130, v[140:143], s[60:61] offset:512 sc1
    v_add_u32 v130, 1835008, v130
    v_mfma_f32_32x32x16_bf16 v[32:47], a[192:195], v[80:83], v[32:47]
    ds_read_b64_tr_b16 v[102:103], v1 offset:21760
    s_mov_b32 exec_lo, 0x00030003
    s_mov_b32 exec_hi, 0x00030003
    ds_write_b128 v132, v[248:251]
    ds_write_b128 v132, v[252:255] offset:128
    s_mov_b64 exec, -1
    v_mfma_f32_32x32x16_bf16 v[16:31], a[68:71], v[84:87], v[16:31]
    ds_read_b64_tr_b16 v[104:105], v1 offset:22528
    buffer_load_dwordx4 v150, s[12:15], s9 offen offset:1024 lds
    ds_read_b32 v134, v133
    ds_read_b32 v135, v133 offset:128
    v_mfma_f32_32x32x16_bf16 v[32:47], a[196:199], v[84:87], v[32:47]
    ds_read_b64_tr_b16 v[106:107], v1 offset:22784
    s_waitcnt lgkmcnt(10)
    v_mfma_f32_32x32x16_bf16 v[16:31], a[72:75], v[88:91], v[16:31]
    ds_read_b64_tr_b16 v[108:109], v1 offset:23552
    buffer_load_dwordx4 v129, s[4:7], s9 offen offset:2048 lds
    v_mfma_f32_32x32x16_bf16 v[32:47], a[200:203], v[88:91], v[32:47]
    ds_read_b64_tr_b16 v[110:111], v1 offset:23808
    v_cmp_gt_u32 s[50:51], 32, v2
    v_mfma_f32_32x32x16_bf16 v[16:31], a[76:79], v[92:95], v[16:31]
    ds_read_b64_tr_b16 v[80:81], v1 offset:24576
    buffer_load_dwordx4 v129, s[12:15], s9 offen offset:3072 lds
    v_mfma_f32_32x32x16_bf16 v[32:47], a[204:207], v[92:95], v[32:47]
    ds_read_b64_tr_b16 v[82:83], v1 offset:24832
    s_waitcnt lgkmcnt(10)
    s_waitcnt lgkmcnt(5)
    v_mfma_f32_32x32x16_bf16 v[16:31], a[80:83], v[96:99], v[16:31]
    ds_read_b64_tr_b16 v[84:85], v1 offset:25600
    s_add_u32 m0, s56, 24576
    s_xor_b32 s9, s10, 65536
    buffer_load_dwordx4 v150, s[4:7], s9 offen offset:0 lds
    v_mfma_f32_32x32x16_bf16 v[32:47], a[208:211], v[96:99], v[32:47]
    ds_read_b64_tr_b16 v[86:87], v1 offset:25856
    v_cvt_pk_bf16_f32 v136, v134, 0
    v_lshlrev_b32 v137, 16, v136
    v_sub_f32 v137, v134, v137
    v_cvt_pk_bf16_f32 v137, v137, 0
    v_mfma_f32_32x32x16_bf16 v[16:31], a[84:87], v[100:103], v[16:31]
    ds_read_b64_tr_b16 v[88:89], v1 offset:26624
    buffer_load_dwordx4 v150, s[12:15], s9 offen offset:1024 lds
    v_cndmask_b32 v112, v137, v136, s[50:51]
    v_cvt_pk_bf16_f32 v136, v135, 0
    v_mfma_f32_32x32x16_bf16 v[32:47], a[212:215], v[100:103], v[32:47]
    ds_read_b64_tr_b16 v[90:91], v1 offset:26880
    s_waitcnt lgkmcnt(6)
    v_lshlrev_b32 v137, 16, v136
    v_sub_f32 v137, v135, v137
    v_cvt_pk_bf16_f32 v137, v137, 0
    v_mfma_f32_32x32x16_bf16 v[16:31], a[88:91], v[104:107], v[16:31]
    ds_read_b64_tr_b16 v[92:93], v1 offset:27648
    s_waitcnt vmcnt(12)
    ds_read_b128 v[48:51], v156 offset:32768
    ds_read_b128 v[52:55], v156 offset:33792
    ds_read_b128 v[56:59], v156 offset:34816
    v_mfma_f32_32x32x16_bf16 v[32:47], a[216:219], v[104:107], v[32:47]
    ds_read_b64_tr_b16 v[94:95], v1 offset:27904
    buffer_load_dwordx4 v129, s[4:7], s9 offen offset:2048 lds
    ds_read_b128 v[60:63], v156 offset:35840
    ds_read_b128 v[64:67], v156 offset:36864
    v_mfma_f32_32x32x16_bf16 v[16:31], a[92:95], v[108:111], v[16:31]
    ds_read_b64_tr_b16 v[96:97], v1 offset:28672
    ds_read_b128 v[68:71], v156 offset:37888
    ds_read_b128 v[72:75], v156 offset:38912
    ds_read_b128 v[76:79], v156 offset:39936
    v_cndmask_b32 v116, v137, v136, s[50:51]
    v_mfma_f32_32x32x16_bf16 v[32:47], a[220:223], v[108:111], v[32:47]
    ds_read_b64_tr_b16 v[98:99], v1 offset:28928
    s_waitcnt lgkmcnt(14)
    v_mfma_f32_32x32x16_bf16 v[16:31], a[96:99], v[80:83], v[16:31]
    ds_read_b64_tr_b16 v[100:101], v1 offset:29696
    s_waitcnt lgkmcnt(7)
    v_mfma_f32_32x32x16_bf16 v[32:47], a[224:227], v[80:83], v[32:47]
    ds_read_b64_tr_b16 v[102:103], v1 offset:29952
    buffer_load_dwordx4 v129, s[12:15], s9 offen offset:3072 lds
    v_max_u32 v48, v48, v49
    v_max3_u32 v48, v48, v50, v51
    v_max3_u32 v48, v48, v52, v53
    v_mfma_f32_32x32x16_bf16 v[16:31], a[100:103], v[84:87], v[16:31]
    ds_read_b64_tr_b16 v[104:105], v1 offset:30720
    v_max3_u32 v48, v48, v54, v55
    v_max3_u32 v48, v48, v56, v57
    v_max3_u32 v48, v48, v58, v59
    v_max3_u32 v48, v48, v60, v61
    v_max3_u32 v48, v48, v62, v63
    v_mfma_f32_32x32x16_bf16 v[32:47], a[228:231], v[84:87], v[32:47]
    ds_read_b64_tr_b16 v[106:107], v1 offset:30976
    s_add_u32 m0, s56, 32768
    s_xor_b32 s9, s10, 98304
    buffer_load_dwordx4 v150, s[4:7], s9 offen offset:0 lds
    v_mfma_f32_32x32x16_bf16 v[16:31], a[104:107], v[88:91], v[16:31]
    ds_read_b64_tr_b16 v[108:109], v1 offset:31744
    s_waitcnt lgkmcnt(6)
    v_max3_u32 v48, v48, v64, v65
    v_max3_u32 v48, v48, v66, v67
    v_max3_u32 v48, v48, v68, v69
    v_max3_u32 v48, v48, v70, v71
    v_mfma_f32_32x32x16_bf16 v[32:47], a[232:235], v[88:91], v[32:47]
    ds_read_b64_tr_b16 v[110:111], v1 offset:32000
    buffer_load_dwordx4 v150, s[12:15], s9 offen offset:1024 lds
    v_max3_u32 v48, v48, v72, v73
    v_max3_u32 v48, v48, v74, v75
    v_max3_u32 v48, v48, v76, v77
    v_mfma_f32_32x32x16_bf16 v[16:31], a[108:111], v[92:95], v[16:31]
    v_max3_u32 v48, v48, v78, v79
    s_waitcnt vmcnt(12)
    ds_read_b64_tr_b16 v[160:161], v151 offset:8192
    ds_read_b64_tr_b16 v[162:163], v151 offset:9216
    ds_read_b64_tr_b16 v[164:165], v151 offset:8224
    v_mfma_f32_32x32x16_bf16 v[32:47], a[236:239], v[92:95], v[32:47]
    s_waitcnt lgkmcnt(7)
    buffer_load_dwordx4 v129, s[4:7], s9 offen offset:2048 lds
    ds_read_b64_tr_b16 v[166:167], v151 offset:9248
    ds_read_b64_tr_b16 v[168:169], v151 offset:8704
    v_cmp_eq_u32 vcc, -1, v48
    s_cbranch_vccnz slow_pok_14
pok_14:
    s_waitcnt lgkmcnt(5)
    s_barrier
    v_mfma_f32_32x32x16_bf16 v[16:31], a[112:115], v[96:99], v[16:31]
    ds_read_b64_tr_b16 v[80:81], v1 offset:32768
    ds_read_b64_tr_b16 v[82:83], v1 offset:33024
    s_add_u32 m0, s56, 32768
    s_nop 0
    buffer_load_dwordx4 v129, s[12:15], s9 offen offset:3072 lds
    v_mfma_f32_32x32x16_bf16 v[32:47], a[240:243], v[96:99], v[32:47]
    ds_read_b64_tr_b16 v[84:85], v1 offset:33792
    ds_read_b64_tr_b16 v[86:87], v1 offset:34048
    ds_read_b64_tr_b16 v[170:171], v151 offset:9728
    ds_read_b64_tr_b16 v[172:173], v151 offset:8736
    ds_read_b64_tr_b16 v[174:175], v151 offset:9760
    v_mfma_f32_32x32x16_bf16 v[16:31], a[116:119], v[100:103], v[16:31]
    ds_read_b64_tr_b16 v[88:89], v1 offset:34816
    global_load_dwordx2 v[126:127], v152, s[28:29] sc1
    s_lshl_b32 s49, s70, 15
    s_lshl_b32 s50, s74, 12
    s_add_u32 s49, s49, s50
    v_mfma_f32_32x32x16_bf16 v[32:47], a[244:247], v[100:103], v[32:47]
    ds_read_b64_tr_b16 v[90:91], v1 offset:35072
    s_lshl_b32 s50, s3, 10
    s_add_u32 s49, s49, s50
    v_lshl_add_u32 v5, v2, 4, s49
    s_lshl_b32 s46, s3, 12
    v_mfma_f32_32x32x16_bf16 v[16:31], a[120:123], v[104:107], v[16:31]
    ds_read_b64_tr_b16 v[92:93], v1 offset:35840
    s_add_u32 m0, s56, 0
    s_xor_b32 s9, s10, 131072
    buffer_load_dwordx4 v150, s[4:7], s9 offen offset:0 lds
    v_mfma_f32_32x32x16_bf16 v[32:47], a[248:251], v[104:107], v[32:47]
    ds_read_b64_tr_b16 v[94:95], v1 offset:36096
    v_mul_u32_u24 v7, 272, v4
    v_lshl_add_u32 v7, v3, 4, v7
    s_mul_i32 s50, s3, 1088
    v_add_u32 v7, s50, v7
    v_mfma_f32_32x32x16_bf16 v[16:31], a[124:127], v[108:111], v[16:31]
    ds_read_b64_tr_b16 v[96:97], v1 offset:36864
    buffer_load_dwordx4 v150, s[12:15], s9 offen offset:1024 lds
    v_mul_u32_u24 v14, 272, v3
    v_lshl_add_u32 v14, v4, 4, v14
    v_mfma_f32_32x32x16_bf16 v[32:47], a[252:255], v[108:111], v[32:47]
    ds_read_b64_tr_b16 v[98:99], v1 offset:37120
    s_waitcnt lgkmcnt(9)
    s_mul_i32 s50, s3, 4352
    v_add_u32 v14, s50, v14
    s_lshl_b32 s50, s3, 6
    v_mfma_f32_32x32x16_bf16 v[48:63], a[0:3], v[80:83], 0
    ds_read_b64_tr_b16 v[100:101], v1 offset:37888
    global_store_dwordx4 v130, v[140:143], s[60:61] sc1
    v_add_u32 v6, s50, v14
    s_xor_b32 s49, s50, 64
    v_add_u32 v0, s49, v14
    v_mfma_f32_32x32x16_bf16 v[64:79], a[128:131], v[80:83], 0
    ds_read_b64_tr_b16 v[102:103], v1 offset:38144
    s_xor_b32 s49, s50, 128
    v_add_u32 v15, s49, v14
    s_xor_b32 s49, s50, 192
    v_add_u32 v156, s49, v14
    v_mfma_f32_32x32x16_bf16 v[48:63], a[4:7], v[84:87], v[48:63]
    ds_read_b64_tr_b16 v[104:105], v1 offset:38912
    global_store_dwordx4 v130, v[140:143], s[60:61] offset:512 sc1
    v_add_u32 v130, 1835008, v130
    v_lshlrev_b32 v9, 8, v4
    v_mfma_f32_32x32x16_bf16 v[64:79], a[132:135], v[84:87], v[64:79]
    ds_read_b64_tr_b16 v[106:107], v1 offset:39168
    s_waitcnt lgkmcnt(6)
    v_lshrrev_b32 v14, 2, v3
    v_lshl_add_u32 v9, v14, 6, v9
    v_and_b32 v14, 3, v3
    v_mfma_f32_32x32x16_bf16 v[48:63], a[8:11], v[88:91], v[48:63]
    ds_read_b64_tr_b16 v[108:109], v1 offset:39936
    global_load_dword v128, v13, s[28:29] sc1
    v_lshl_add_u32 v9, v14, 3, v9
    s_lshl_b32 s50, s71, 5
    v_mfma_f32_32x32x16_bf16 v[64:79], a[136:139], v[88:91], v[64:79]
    ds_read_b64_tr_b16 v[110:111], v1 offset:40192
    s_add_u32 s50, s50, s46
    s_add_u32 s50, s50, 147456
    v_add_u32 v9, s50, v9
    v_lshlrev_b32 v8, 10, v4
    v_mfma_f32_32x32x16_bf16 v[48:63], a[12:15], v[92:95], v[48:63]
    ds_read_b64_tr_b16 v[80:81], v1 offset:40960
    buffer_load_dwordx4 v129, s[4:7], s9 offen offset:2048 lds
    v_lshl_add_u32 v8, v3, 3, v8
    s_lshl_b32 s49, s70, 15
    v_mfma_f32_32x32x16_bf16 v[64:79], a[140:143], v[92:95], v[64:79]
    ds_read_b64_tr_b16 v[82:83], v1 offset:41216
    s_waitcnt lgkmcnt(6)
    s_lshl_b32 s50, s71, 14
    s_add_u32 s49, s49, s50
    s_lshl_b32 s50, s74, 7
    s_add_u32 s49, s49, s50
    v_mfma_f32_32x32x16_bf16 v[48:63], a[16:19], v[96:99], v[48:63]
    ds_read_b64_tr_b16 v[84:85], v1 offset:41984
    s_add_u32 s49, s49, s46
    v_add_u32 v8, s49, v8
    s_sub_u32 s49, s73, s56
    v_add_u32 v4, s49, v151
    v_mfma_f32_32x32x16_bf16 v[64:79], a[144:147], v[96:99], v[64:79]
    ds_read_b64_tr_b16 v[86:87], v1 offset:42240
    s_waitcnt vmcnt(15)
    ds_read_b64_tr_b16 v[176:177], v151 offset:16384
    ds_read_b64_tr_b16 v[178:179], v151 offset:17408
    ds_read_b64_tr_b16 v[180:181], v151 offset:16416
    v_mfma_f32_32x32x16_bf16 v[48:63], a[20:23], v[100:103], v[48:63]
    ds_read_b64_tr_b16 v[88:89], v1 offset:43008
    buffer_load_dwordx4 v129, s[12:15], s9 offen offset:3072 lds
    ds_read_b64_tr_b16 v[182:183], v151 offset:17440
    ds_read_b64_tr_b16 v[184:185], v151 offset:16896
    v_mfma_f32_32x32x16_bf16 v[64:79], a[148:151], v[100:103], v[64:79]
    ds_read_b64_tr_b16 v[90:91], v1 offset:43264
    s_waitcnt lgkmcnt(11)
    ds_read_b64_tr_b16 v[186:187], v151 offset:17920
    ds_read_b64_tr_b16 v[188:189], v151 offset:16928
    ds_read_b64_tr_b16 v[190:191], v151 offset:17952
    v_mfma_f32_32x32x16_bf16 v[48:63], a[24:27], v[104:107], v[48:63]
    ds_read_b64_tr_b16 v[92:93], v1 offset:44032
    s_add_u32 m0, s56, 8192
    s_xor_b32 s9, s10, 163840
    buffer_load_dwordx4 v150, s[4:7], s9 offen offset:0 lds
    v_mfma_f32_32x32x16_bf16 v[64:79], a[152:155], v[104:107], v[64:79]
    ds_read_b64_tr_b16 v[94:95], v1 offset:44288
    s_waitcnt vmcnt(13)
    ds_read_b64_tr_b16 v[192:193], v151 offset:24576
    ds_read_b64_tr_b16 v[194:195], v151 offset:25600
    ds_read_b64_tr_b16 v[196:197], v151 offset:24608
    v_mfma_f32_32x32x16_bf16 v[48:63], a[28:31], v[108:111], v[48:63]
    ds_read_b64_tr_b16 v[96:97], v1 offset:45056
    buffer_load_dwordx4 v150, s[12:15], s9 offen offset:1024 lds
    ds_read_b64_tr_b16 v[198:199], v151 offset:25632
    ds_read_b64_tr_b16 v[200:201], v151 offset:25088
    v_mfma_f32_32x32x16_bf16 v[64:79], a[156:159], v[108:111], v[64:79]
    ds_read_b64_tr_b16 v[98:99], v1 offset:45312
    s_waitcnt lgkmcnt(15)
    ds_read_b64_tr_b16 v[202:203], v151 offset:26112
    ds_read_b64_tr_b16 v[204:205], v151 offset:25120
    ds_read_b64_tr_b16 v[206:207], v151 offset:26144
    v_mfma_f32_32x32x16_bf16 v[48:63], a[32:35], v[80:83], v[48:63]
    ds_read_b64_tr_b16 v[100:101], v1 offset:46080
    buffer_load_dwordx4 v129, s[4:7], s9 offen offset:2048 lds
    v_mfma_f32_32x32x16_bf16 v[64:79], a[160:163], v[80:83], v[64:79]
    ds_read_b64_tr_b16 v[102:103], v1 offset:46336
    v_mfma_f32_32x32x16_bf16 v[48:63], a[36:39], v[84:87], v[48:63]
    ds_read_b64_tr_b16 v[104:105], v1 offset:47104
    v_mfma_f32_32x32x16_bf16 v[64:79], a[164:167], v[84:87], v[64:79]
    ds_read_b64_tr_b16 v[106:107], v1 offset:47360
    s_waitcnt lgkmcnt(14)
    buffer_load_dwordx4 v129, s[12:15], s9 offen offset:3072 lds
    v_mfma_f32_32x32x16_bf16 v[48:63], a[40:43], v[88:91], v[48:63]
    ds_read_b64_tr_b16 v[108:109], v1 offset:48128
    v_mfma_f32_32x32x16_bf16 v[64:79], a[168:171], v[88:91], v[64:79]
    ds_read_b64_tr_b16 v[110:111], v1 offset:48384
    s_add_u32 m0, s56, 16384
    s_xor_b32 s9, s10, 196608
    buffer_load_dwordx4 v150, s[4:7], s9 offen offset:0 lds
    v_mfma_f32_32x32x16_bf16 v[48:63], a[44:47], v[92:95], v[48:63]
    ds_read_b64_tr_b16 v[80:81], v1 offset:49152
    s_waitcnt vmcnt(13)
    ds_read_b64_tr_b16 v[208:209], v151 offset:32768
    ds_read_b64_tr_b16 v[210:211], v151 offset:33792
    ds_read_b64_tr_b16 v[212:213], v151 offset:32800
    v_mfma_f32_32x32x16_bf16 v[64:79], a[172:175], v[92:95], v[64:79]
    ds_read_b64_tr_b16 v[82:83], v1 offset:49408
    s_waitcnt lgkmcnt(9)
    buffer_load_dwordx4 v150, s[12:15], s9 offen offset:1024 lds
    ds_read_b64_tr_b16 v[214:215], v151 offset:33824
    v_mfma_f32_32x32x16_bf16 v[48:63], a[48:51], v[96:99], v[48:63]
    ds_read_b64_tr_b16 v[84:85], v1 offset:50176
    s_waitcnt vmcnt(8)
    v_cmp_ne_u32 vcc, 16, v128
    s_cbranch_vccnz slow_pok_17
pok_17:
    v_mfma_f32_32x32x16_bf16 v[64:79], a[176:179], v[96:99], v[64:79]
    ds_read_b64_tr_b16 v[86:87], v1 offset:50432
    buffer_load_dwordx4 v129, s[4:7], s9 offen offset:2048 lds
    v_cmp_ne_u32 vcc, s30, v126
    s_cbranch_vccnz slow_pok_21
pok_21:
    v_and_b32 v125, s76, v127
    v_mfma_f32_32x32x16_bf16 v[48:63], a[52:55], v[100:103], v[48:63]
    ds_read_b64_tr_b16 v[88:89], v1 offset:51200
    v_mov_b32 v120, v127
    v_rcp_f32 v124, v125
    v_add_u32 v152, 4096, v152
    v_mfma_f32_32x32x16_bf16 v[64:79], a[180:183], v[100:103], v[64:79]
    ds_read_b64_tr_b16 v[90:91], v1 offset:51456
    s_waitcnt lgkmcnt(10)
    s_add_u32 m0, s73, 0
    s_nop 0
    buffer_load_dwordx4 v149, s[32:35], s66 offen offset:0 sc1 lds
    v_mul_f32 v124, 0xbfb8aa3b, v124
    s_nop 0
    v_mfma_f32_32x32x16_bf16 v[16:31], v[112:115], v[120:123], v[16:31]
    v_mfma_f32_32x32x16_bf16 v[32:47], v[116:119], v[120:123], v[32:47]
    v_mfma_f32_32x32x16_bf16 v[48:63], a[56:59], v[104:107], v[48:63]
    ds_read_b64_tr_b16 v[92:93], v1 offset:52224
    buffer_load_dwordx4 v149, s[32:35], s66 offen offset:1024 sc1 lds
    ds_read_b64_tr_b16 v[216:217], v151 offset:33280
    ds_read_b64_tr_b16 v[218:219], v151 offset:34304
    v_mfma_f32_32x32x16_bf16 v[64:79], a[184:187], v[104:107], v[64:79]
    ds_read_b64_tr_b16 v[94:95], v1 offset:52480
    ds_read_b64_tr_b16 v[220:221], v151 offset:33312
    ds_read_b64_tr_b16 v[222:223], v151 offset:34336
    s_waitcnt vmcnt(9)
    ds_read_b64_tr_b16 v[224:225], v151 offset:0
    v_mfma_f32_32x32x16_bf16 v[48:63], a[60:63], v[108:111], v[48:63]
    ds_read_b64_tr_b16 v[96:97], v1 offset:53248
    global_load_dwordx2 v[126:127], v152, s[28:29] sc1
    buffer_load_dwordx4 v149, s[32:35], s67 offen offset:2048 sc1 lds
    v_mfma_f32_32x32x16_bf16 v[64:79], a[188:191], v[108:111], v[64:79]
    ds_read_b64_tr_b16 v[98:99], v1 offset:53504
    s_waitcnt lgkmcnt(11)
    ds_read_b64_tr_b16 v[226:227], v151 offset:1024
    ds_read_b64_tr_b16 v[228:229], v151 offset:32
    ds_read_b64_tr_b16 v[230:231], v151 offset:1056
    v_mfma_f32_32x32x16_bf16 v[48:63], a[64:67], v[80:83], v[48:63]
    ds_read_b64_tr_b16 v[100:101], v1 offset:54272
    buffer_load_dwordx4 v149, s[32:35], s67 offen offset:3072 sc1 lds
    v_mul_f32 v132, v124, v16
    v_mul_f32 v133, v124, v17
    v_mul_f32 v134, v124, v18
    v_mfma_f32_32x32x16_bf16 v[64:79], a[192:195], v[80:83], v[64:79]
    ds_read_b64_tr_b16 v[102:103], v1 offset:54528
    v_mul_f32 v135, v124, v19
    v_exp_f32 v132, v132
    v_exp_f32 v133, v133
    v_mfma_f32_32x32x16_bf16 v[48:63], a[68:71], v[84:87], v[48:63]
    ds_read_b64_tr_b16 v[104:105], v1 offset:55296
    s_add_u32 m0, s73, 4096
    s_nop 0
    buffer_load_dwordx4 v149, s[32:35], s68 offen offset:0 sc1 lds
    v_mfma_f32_32x32x16_bf16 v[64:79], a[196:199], v[84:87], v[64:79]
    ds_read_b64_tr_b16 v[106:107], v1 offset:55552
    s_waitcnt lgkmcnt(12)
    v_exp_f32 v134, v134
    v_exp_f32 v135, v135
    v_mfma_f32_32x32x16_bf16 v[48:63], a[72:75], v[88:91], v[48:63]
    ds_read_b64_tr_b16 v[108:109], v1 offset:56320
    buffer_load_dwordx4 v149, s[32:35], s68 offen offset:1024 sc1 lds
    v_fma_f32 v132, v132, v125, v125
    v_fma_f32 v133, v133, v125, v125
    v_mfma_f32_32x32x16_bf16 v[64:79], a[200:203], v[88:91], v[64:79]
    ds_read_b64_tr_b16 v[110:111], v1 offset:56576
    v_fma_f32 v134, v134, v125, v125
    v_fma_f32 v135, v135, v125, v125
    v_rcp_f32 v132, v132
    v_mfma_f32_32x32x16_bf16 v[48:63], a[76:79], v[92:95], v[48:63]
    ds_read_b64_tr_b16 v[80:81], v1 offset:57344
    buffer_load_dwordx4 v149, s[32:35], s69 offen offset:2048 sc1 lds
    v_rcp_f32 v133, v133
    v_mul_f32 v136, v124, v20
    v_mfma_f32_32x32x16_bf16 v[64:79], a[204:207], v[92:95], v[64:79]
    ds_read_b64_tr_b16 v[82:83], v1 offset:57600
    s_waitcnt lgkmcnt(6)
    v_rcp_f32 v134, v134
    v_rcp_f32 v135, v135
    v_mfma_f32_32x32x16_bf16 v[48:63], a[80:83], v[96:99], v[48:63]
    ds_read_b64_tr_b16 v[84:85], v1 offset:58368
    buffer_load_dwordx4 v149, s[32:35], s69 offen offset:3072 sc1 lds
    v_add_u32 v149, s8, v149
    v_mul_f32 v132, v32, v132
    v_mul_f32 v133, v33, v133
    v_mfma_f32_32x32x16_bf16 v[64:79], a[208:211], v[96:99], v[64:79]
    ds_read_b64_tr_b16 v[86:87], v1 offset:58624
    v_mul_f32 v134, v34, v134
    v_mul_f32 v135, v35, v135
    v_cvt_pk_bf16_f32 v140, v132, v133
    v_cvt_pk_bf16_f32 v141, v134, v135
    v_mfma_f32_32x32x16_bf16 v[48:63], a[84:87], v[100:103], v[48:63]
    ds_read_b64_tr_b16 v[88:89], v1 offset:59392
    s_mov_b64 exec, 1
    global_store_dword v154, v157, s[28:29] sc1
    s_mov_b64 exec, -1
    v_add_u32 v154, 0x20000, v154
    v_mfma_f32_32x32x16_bf16 v[64:79], a[212:215], v[100:103], v[64:79]
    ds_read_b64_tr_b16 v[90:91], v1 offset:59648
    s_waitcnt lgkmcnt(6)
    s_add_u32 m0, s56, 16384
    s_nop 0
    buffer_load_dwordx4 v129, s[12:15], s9 offen offset:3072 lds
    v_mfma_f32_32x32x16_bf16 v[48:63], a[88:91], v[104:107], v[48:63]
    ds_read_b64_tr_b16 v[92:93], v1 offset:60416
    v_mul_f32 v137, v124, v21
    v_mul_f32 v138, v124, v22
    v_mul_f32 v139, v124, v23
    v_exp_f32 v136, v136
    v_mfma_f32_32x32x16_bf16 v[64:79], a[216:219], v[104:107], v[64:79]
    ds_read_b64_tr_b16 v[94:95], v1 offset:60672
    v_exp_f32 v137, v137
    v_exp_f32 v138, v138
    v_mul_f32 v132, v124, v24
    v_mfma_f32_32x32x16_bf16 v[48:63], a[92:95], v[108:111], v[48:63]
    ds_read_b64_tr_b16 v[96:97], v1 offset:61440
    v_exp_f32 v139, v139
    v_fma_f32 v136, v136, v125, v125
    v_fma_f32 v137, v137, v125, v125
    v_mfma_f32_32x32x16_bf16 v[64:79], a[220:223], v[108:111], v[64:79]
    ds_read_b64_tr_b16 v[98:99], v1 offset:61696
    s_waitcnt lgkmcnt(6)
    v_fma_f32 v138, v138, v125, v125
    v_fma_f32 v139, v139, v125, v125
    v_mul_f32 v133, v124, v25
    v_mfma_f32_32x32x16_bf16 v[48:63], a[96:99], v[80:83], v[48:63]
    ds_read_b64_tr_b16 v[100:101], v1 offset:62464
    v_rcp_f32 v136, v136
    v_rcp_f32 v137, v137
    v_mul_f32 v134, v124, v26
    v_mfma_f32_32x32x16_bf16 v[64:79], a[224:227], v[80:83], v[64:79]
    ds_read_b64_tr_b16 v[102:103], v1 offset:62720
    s_add_u32 m0, s56, 24576
    s_xor_b32 s9, s10, 229376
    buffer_load_dwordx4 v150, s[4:7], s9 offen offset:0 lds
    v_mfma_f32_32x32x16_bf16 v[48:63], a[100:103], v[84:87], v[48:63]
    ds_read_b64_tr_b16 v[104:105], v1 offset:63488
    v_rcp_f32 v138, v138
    v_rcp_f32 v139, v139
    v_mul_f32 v136, v36, v136
    v_mfma_f32_32x32x16_bf16 v[64:79], a[228:231], v[84:87], v[64:79]
    ds_read_b64_tr_b16 v[106:107], v1 offset:63744
    s_waitcnt lgkmcnt(6)
    buffer_load_dwordx4 v150, s[12:15], s9 offen offset:1024 lds
    v_mul_f32 v137, v37, v137
    v_mul_f32 v138, v38, v138
    v_mfma_f32_32x32x16_bf16 v[48:63], a[104:107], v[88:91], v[48:63]
    ds_read_b64_tr_b16 v[108:109], v1 offset:64512
    v_mul_f32 v139, v39, v139
    v_cvt_pk_bf16_f32 v142, v136, v137
    v_cvt_pk_bf16_f32 v143, v138, v139
    v_mul_f32 v135, v124, v27
    v_mfma_f32_32x32x16_bf16 v[64:79], a[232:235], v[88:91], v[64:79]
    ds_read_b64_tr_b16 v[110:111], v1 offset:64768
    global_store_dwordx4 v148, v[140:143], s[60:61] offset:0 sc1
    v_mul_f32 v136, v124, v28
    v_mul_f32 v137, v124, v29
    v_mul_f32 v138, v124, v30
    v_mfma_f32_32x32x16_bf16 v[48:63], a[108:111], v[92:95], v[48:63]
    v_exp_f32 v132, v132
    v_exp_f32 v133, v133
    v_exp_f32 v134, v134
    v_mfma_f32_32x32x16_bf16 v[64:79], a[236:239], v[92:95], v[64:79]
    s_waitcnt lgkmcnt(4)
    buffer_load_dwordx4 v129, s[4:7], s9 offen offset:2048 lds
    v_exp_f32 v135, v135
    v_fma_f32 v132, v132, v125, v125
    s_waitcnt vmcnt(6)
    s_waitcnt lgkmcnt(0)
    s_barrier
    v_mfma_f32_32x32x16_bf16 v[48:63], a[112:115], v[96:99], v[48:63]
    ds_read_b64_tr_b16 v[80:81], v1 offset:0
    ds_read_b64_tr_b16 v[82:83], v1 offset:256
    s_add_u32 m0, s73, 32768
    s_nop 0
    buffer_load_dwordx4 v149, s[32:35], s66 offen offset:0 sc1 lds
    v_mfma_f32_32x32x16_bf16 v[64:79], a[240:243], v[96:99], v[64:79]
    ds_read_b64_tr_b16 v[84:85], v1 offset:1024
    ds_read_b64_tr_b16 v[86:87], v1 offset:1280
    v_fma_f32 v133, v133, v125, v125
    v_fma_f32 v134, v134, v125, v125
    v_fma_f32 v135, v135, v125, v125
    v_mfma_f32_32x32x16_bf16 v[48:63], a[116:119], v[100:103], v[48:63]
    ds_read_b64_tr_b16 v[88:89], v1 offset:2048
    buffer_load_dwordx4 v149, s[32:35], s66 offen offset:1024 sc1 lds
    v_rcp_f32 v132, v132
    v_mul_f32 v139, v124, v31
    v_mfma_f32_32x32x16_bf16 v[64:79], a[244:247], v[100:103], v[64:79]
    ds_read_b64_tr_b16 v[90:91], v1 offset:2304
    v_rcp_f32 v133, v133
    v_rcp_f32 v134, v134
    v_mfma_f32_32x32x16_bf16 v[48:63], a[120:123], v[104:107], v[48:63]
    ds_read_b64_tr_b16 v[92:93], v1 offset:3072
    buffer_load_dwordx4 v149, s[32:35], s67 offen offset:2048 sc1 lds
    v_rcp_f32 v135, v135
    v_mul_f32 v132, v40, v132
    v_mfma_f32_32x32x16_bf16 v[64:79], a[248:251], v[104:107], v[64:79]
    ds_read_b64_tr_b16 v[94:95], v1 offset:3328
    v_mul_f32 v133, v41, v133
    v_mul_f32 v134, v42, v134
    v_mul_f32 v135, v43, v135
    v_cvt_pk_bf16_f32 v144, v132, v133
    v_cvt_pk_bf16_f32 v145, v134, v135
    v_exp_f32 v136, v136
    v_exp_f32 v137, v137
    v_exp_f32 v138, v138
    v_exp_f32 v139, v139
    v_fma_f32 v136, v136, v125, v125
    v_fma_f32 v137, v137, v125, v125
    v_fma_f32 v138, v138, v125, v125
    v_fma_f32 v139, v139, v125, v125
    v_rcp_f32 v136, v136
    v_rcp_f32 v137, v137
    v_rcp_f32 v138, v138
    v_rcp_f32 v139, v139
    v_mul_f32 v136, v44, v136
    v_mul_f32 v137, v45, v137
    v_mul_f32 v138, v46, v138
    v_mul_f32 v139, v47, v139
    v_cvt_pk_bf16_f32 v146, v136, v137
    v_cvt_pk_bf16_f32 v147, v138, v139
    global_store_dwordx4 v148, v[144:147], s[60:61] offset:512 sc1
    v_add_u32 v148, 1835008, v148
    v_mfma_f32_32x32x16_bf16 v[48:63], a[124:127], v[108:111], v[48:63]
    ds_read_b64_tr_b16 v[96:97], v1 offset:4096
    buffer_load_dwordx4 v149, s[32:35], s67 offen offset:3072 sc1 lds
    ds_read_b64_tr_b16 v[232:233], v151 offset:512
    ds_read_b64_tr_b16 v[234:235], v151 offset:1536
    v_mfma_f32_32x32x16_bf16 v[64:79], a[252:255], v[108:111], v[64:79]
    ds_read_b64_tr_b16 v[98:99], v1 offset:4352
    s_waitcnt lgkmcnt(8)
    ds_read_b64_tr_b16 v[236:237], v151 offset:544
    ds_read_b64_tr_b16 v[238:239], v151 offset:1568
    ds_read_b64_tr_b16 v[240:241], v151 offset:8192
    v_mfma_f32_32x32x16_bf16 v[16:31], a[0:3], v[80:83], 0
    ds_read_b64_tr_b16 v[100:101], v1 offset:5120
    s_add_u32 m0, s73, 36864
    s_nop 0
    buffer_load_dwordx4 v149, s[32:35], s68 offen offset:0 sc1 lds
    v_mfma_f32_32x32x16_bf16 v[32:47], a[128:131], v[80:83], 0
    ds_read_b64_tr_b16 v[102:103], v1 offset:5376
    v_cmp_ne_u32 vcc, s30, v126
    s_cbranch_vccnz slow_pok_25
pok_25:
    v_and_b32 v125, s76, v127
    v_mov_b32 v120, v127
    v_mov_b32 v140, -1
    v_mfma_f32_32x32x16_bf16 v[16:31], a[4:7], v[84:87], v[16:31]
    ds_read_b64_tr_b16 v[104:105], v1 offset:6144
    buffer_load_dwordx4 v149, s[32:35], s68 offen offset:1024 sc1 lds
    v_rcp_f32 v124, v125
    v_mov_b32 v141, -1
    v_mfma_f32_32x32x16_bf16 v[32:47], a[132:135], v[84:87], v[32:47]
    ds_read_b64_tr_b16 v[106:107], v1 offset:6400
    s_waitcnt lgkmcnt(11)
    v_add_u32 v152, 4096, v152
    v_mul_f32 v124, 0xbfb8aa3b, v124
    v_mov_b32 v142, -1
    s_nop 0
    v_mfma_f32_32x32x16_bf16 v[48:63], v[112:115], v[120:123], v[48:63]
    v_mfma_f32_32x32x16_bf16 v[64:79], v[116:119], v[120:123], v[64:79]
    v_mfma_f32_32x32x16_bf16 v[16:31], a[8:11], v[88:91], v[16:31]
    ds_read_b64_tr_b16 v[108:109], v1 offset:7168
    buffer_load_dwordx4 v149, s[32:35], s69 offen offset:2048 sc1 lds
    v_mov_b32 v143, -1
    ds_read_b64_tr_b16 v[242:243], v151 offset:9216
    v_mfma_f32_32x32x16_bf16 v[32:47], a[136:139], v[88:91], v[32:47]
    ds_read_b64_tr_b16 v[110:111], v1 offset:7424
    ds_read_b64_tr_b16 v[244:245], v151 offset:8224
    ds_read_b64_tr_b16 v[246:247], v151 offset:9248
    ds_read_b64_tr_b16 v[248:249], v151 offset:8704
    ds_read_b64_tr_b16 v[250:251], v151 offset:9728
    v_mfma_f32_32x32x16_bf16 v[16:31], a[12:15], v[92:95], v[16:31]
    ds_read_b64_tr_b16 v[80:81], v1 offset:8192
    global_store_dwordx4 v130, v[140:143], s[60:61] sc1
    ds_read_b64_tr_b16 v[252:253], v151 offset:8736
    ds_read_b64_tr_b16 v[254:255], v151 offset:9760
    v_mfma_f32_32x32x16_bf16 v[32:47], a[140:143], v[92:95], v[32:47]
    ds_read_b64_tr_b16 v[82:83], v1 offset:8448
    s_waitcnt lgkmcnt(13)
    v_mfma_f32_32x32x16_bf16 v[16:31], a[16:19], v[96:99], v[16:31]
    ds_read_b64_tr_b16 v[84:85], v1 offset:9216
    global_store_dwordx4 v130, v[140:143], s[60:61] offset:512 sc1
    v_add_u32 v130, 1835008, v130
    v_mfma_f32_32x32x16_bf16 v[32:47], a[144:147], v[96:99], v[32:47]
    ds_read_b64_tr_b16 v[86:87], v1 offset:9472
    v_mfma_f32_32x32x16_bf16 v[16:31], a[20:23], v[100:103], v[16:31]
    ds_read_b64_tr_b16 v[88:89], v1 offset:10240
    buffer_load_dwordx4 v149, s[32:35], s69 offen offset:3072 sc1 lds
    v_add_u32 v149, s8, v149
    v_mul_f32 v132, v124, v48
    v_mul_f32 v133, v124, v49
    v_mfma_f32_32x32x16_bf16 v[32:47], a[148:151], v[100:103], v[32:47]
    ds_read_b64_tr_b16 v[90:91], v1 offset:10496
    s_waitcnt lgkmcnt(12)
    v_mul_f32 v134, v124, v50
    v_mul_f32 v135, v124, v51
    v_exp_f32 v132, v132
    v_mfma_f32_32x32x16_bf16 v[16:31], a[24:27], v[104:107], v[16:31]
    ds_read_b64_tr_b16 v[92:93], v1 offset:11264
    s_add_u32 m0, s56, 24576
    s_nop 0
    buffer_load_dwordx4 v129, s[12:15], s9 offen offset:3072 lds
    v_mfma_f32_32x32x16_bf16 v[32:47], a[152:155], v[104:107], v[32:47]
    ds_read_b64_tr_b16 v[94:95], v1 offset:11520
    v_exp_f32 v133, v133
    v_exp_f32 v134, v134
    v_mul_f32 v136, v124, v52
    v_mfma_f32_32x32x16_bf16 v[16:31], a[28:31], v[108:111], v[16:31]
    ds_read_b64_tr_b16 v[96:97], v1 offset:12288
    s_add_u32 m0, s56, 32768
    s_xor_b32 s9, s10, 262144
    buffer_load_dwordx4 v150, s[4:7], s9 offen offset:0 lds
    v_mfma_f32_32x32x16_bf16 v[32:47], a[156:159], v[108:111], v[32:47]
    ds_read_b64_tr_b16 v[98:99], v1 offset:12544
    s_waitcnt lgkmcnt(6)
    v_exp_f32 v135, v135
    v_fma_f32 v132, v132, v125, v125
    v_mfma_f32_32x32x16_bf16 v[16:31], a[32:35], v[80:83], v[16:31]
    ds_read_b64_tr_b16 v[100:101], v1 offset:13312
    buffer_load_dwordx4 v150, s[12:15], s9 offen offset:1024 lds
    v_fma_f32 v133, v133, v125, v125
    v_fma_f32 v134, v134, v125, v125
    v_mfma_f32_32x32x16_bf16 v[32:47], a[160:163], v[80:83], v[32:47]
    ds_read_b64_tr_b16 v[102:103], v1 offset:13568
    v_fma_f32 v135, v135, v125, v125
    v_rcp_f32 v132, v132
    v_mul_f32 v137, v124, v53
    v_mfma_f32_32x32x16_bf16 v[16:31], a[36:39], v[84:87], v[16:31]
    ds_read_b64_tr_b16 v[104:105], v1 offset:14336
    buffer_load_dwordx4 v129, s[4:7], s9 offen offset:2048 lds
    v_rcp_f32 v133, v133
    v_mul_f32 v138, v124, v54
    v_mfma_f32_32x32x16_bf16 v[32:47], a[164:167], v[84:87], v[32:47]
    ds_read_b64_tr_b16 v[106:107], v1 offset:14592
    s_waitcnt lgkmcnt(6)
    v_rcp_f32 v134, v134
    v_rcp_f32 v135, v135
    v_mfma_f32_32x32x16_bf16 v[16:31], a[40:43], v[88:91], v[16:31]
    ds_read_b64_tr_b16 v[108:109], v1 offset:15360
    v_mul_f32 v132, v64, v132
    v_mul_f32 v133, v65, v133
    v_mul_f32 v134, v66, v134
    v_mul_f32 v135, v67, v135
    v_mul_f32 v139, v124, v55
    v_mfma_f32_32x32x16_bf16 v[32:47], a[168:171], v[88:91], v[32:47]
    ds_read_b64_tr_b16 v[110:111], v1 offset:15616
    v_cvt_pk_bf16_f32 v140, v132, v133
    v_cvt_pk_bf16_f32 v141, v134, v135
    v_mul_f32 v132, v124, v56
    v_mul_f32 v133, v124, v57
    v_mfma_f32_32x32x16_bf16 v[16:31], a[44:47], v[92:95], v[16:31]
    ds_read_b64_tr_b16 v[80:81], v1 offset:16384
    v_exp_f32 v136, v136
    v_exp_f32 v137, v137
    v_mul_f32 v134, v124, v58
    v_mfma_f32_32x32x16_bf16 v[32:47], a[172:175], v[92:95], v[32:47]
    ds_read_b64_tr_b16 v[82:83], v1 offset:16640
    s_waitcnt lgkmcnt(6)
    buffer_load_dwordx4 v129, s[12:15], s9 offen offset:3072 lds
    v_exp_f32 v138, v138
    v_mfma_f32_32x32x16_bf16 v[16:31], a[48:51], v[96:99], v[16:31]
    ds_read_b64_tr_b16 v[84:85], v1 offset:17408
    global_load_dwordx2 v[126:127], v152, s[28:29] sc1
    v_mfma_f32_32x32x16_bf16 v[32:47], a[176:179], v[96:99], v[32:47]
    ds_read_b64_tr_b16 v[86:87], v1 offset:17664
    v_exp_f32 v139, v139
    v_fma_f32 v136, v136, v125, v125
    v_fma_f32 v137, v137, v125, v125
    v_mfma_f32_32x32x16_bf16 v[16:31], a[52:55], v[100:103], v[16:31]
    ds_read_b64_tr_b16 v[88:89], v1 offset:18432
    v_fma_f32 v138, v138, v125, v125
    v_fma_f32 v139, v139, v125, v125
    v_rcp_f32 v136, v136
    v_mfma_f32_32x32x16_bf16 v[32:47], a[180:183], v[100:103], v[32:47]
    ds_read_b64_tr_b16 v[90:91], v1 offset:18688
    s_waitcnt lgkmcnt(6)
    s_add_u32 m0, s56, 0
    s_xor_b32 s9, s10, 294912
    buffer_load_dwordx4 v150, s[4:7], s9 offen offset:0 lds
    v_mfma_f32_32x32x16_bf16 v[16:31], a[56:59], v[104:107], v[16:31]
    ds_read_b64_tr_b16 v[92:93], v1 offset:19456
    v_rcp_f32 v137, v137
    v_rcp_f32 v138, v138
    v_mul_f32 v135, v124, v59
    v_mfma_f32_32x32x16_bf16 v[32:47], a[184:187], v[104:107], v[32:47]
    ds_read_b64_tr_b16 v[94:95], v1 offset:19712
    buffer_load_dwordx4 v150, s[12:15], s9 offen offset:1024 lds
    v_rcp_f32 v139, v139
    v_mul_f32 v136, v68, v136
    v_mfma_f32_32x32x16_bf16 v[16:31], a[60:63], v[108:111], v[16:31]
    ds_read_b64_tr_b16 v[96:97], v1 offset:20480
    v_mul_f32 v137, v69, v137
    v_mul_f32 v138, v70, v138
    v_mul_f32 v139, v71, v139
    v_cvt_pk_bf16_f32 v142, v136, v137
    v_mfma_f32_32x32x16_bf16 v[32:47], a[188:191], v[108:111], v[32:47]
    ds_read_b64_tr_b16 v[98:99], v1 offset:20736
    s_waitcnt lgkmcnt(6)
    buffer_load_dwordx4 v129, s[4:7], s9 offen offset:2048 lds
    v_cvt_pk_bf16_f32 v143, v138, v139
    v_mfma_f32_32x32x16_bf16 v[16:31], a[64:67], v[80:83], v[16:31]
    ds_read_b64_tr_b16 v[100:101], v1 offset:21504
    v_exp_f32 v132, v132
    v_exp_f32 v133, v133
    v_mfma_f32_32x32x16_bf16 v[32:47], a[192:195], v[80:83], v[32:47]
    ds_read_b64_tr_b16 v[102:103], v1 offset:21760
    v_exp_f32 v134, v134
    v_exp_f32 v135, v135
    v_mfma_f32_32x32x16_bf16 v[16:31], a[68:71], v[84:87], v[16:31]
    ds_read_b64_tr_b16 v[104:105], v1 offset:22528
    global_store_dwordx4 v148, v[140:143], s[60:61] offset:0 sc1
    v_mul_f32 v136, v124, v60
    v_mul_f32 v137, v124, v61
    v_mul_f32 v138, v124, v62
    v_mfma_f32_32x32x16_bf16 v[32:47], a[196:199], v[84:87], v[32:47]
    ds_read_b64_tr_b16 v[106:107], v1 offset:22784
    s_waitcnt lgkmcnt(6)
    v_fma_f32 v132, v132, v125, v125
    v_fma_f32 v133, v133, v125, v125
    v_fma_f32 v134, v134, v125, v125
    v_mfma_f32_32x32x16_bf16 v[16:31], a[72:75], v[88:91], v[16:31]
    ds_read_b64_tr_b16 v[108:109], v1 offset:23552
    buffer_load_dwordx4 v129, s[12:15], s9 offen offset:3072 lds
    v_fma_f32 v135, v135, v125, v125
    v_mul_f32 v139, v124, v63
    v_mfma_f32_32x32x16_bf16 v[32:47], a[200:203], v[88:91], v[32:47]
    ds_read_b64_tr_b16 v[110:111], v1 offset:23808
    v_rcp_f32 v132, v132
    v_rcp_f32 v133, v133
    v_mfma_f32_32x32x16_bf16 v[16:31], a[76:79], v[92:95], v[16:31]
    ds_read_b64_tr_b16 v[80:81], v1 offset:24576
    global_load_dword v128, v153, s[28:29] sc1
    v_rcp_f32 v134, v134
    v_mfma_f32_32x32x16_bf16 v[32:47], a[204:207], v[92:95], v[32:47]
    ds_read_b64_tr_b16 v[82:83], v1 offset:24832
    s_waitcnt lgkmcnt(6)
    v_rcp_f32 v135, v135
    v_mul_f32 v132, v72, v132
    v_mul_f32 v133, v73, v133
    v_mfma_f32_32x32x16_bf16 v[16:31], a[80:83], v[96:99], v[16:31]
    ds_read_b64_tr_b16 v[84:85], v1 offset:25600
    s_waitcnt vmcnt(13)
    s_mov_b64 exec, 1
    global_store_dword v154, v157, s[28:29] sc1
    s_mov_b64 exec, -1
    v_add_u32 v154, 0x20000, v154
    v_mfma_f32_32x32x16_bf16 v[32:47], a[208:211], v[96:99], v[32:47]
    ds_read_b64_tr_b16 v[86:87], v1 offset:25856
    v_mul_f32 v134, v74, v134
    v_mul_f32 v135, v75, v135
    v_cvt_pk_bf16_f32 v144, v132, v133
    v_cvt_pk_bf16_f32 v145, v134, v135
    v_mfma_f32_32x32x16_bf16 v[16:31], a[84:87], v[100:103], v[16:31]
    ds_read_b64_tr_b16 v[88:89], v1 offset:26624
    s_add_u32 m0, s56, 8192
    s_xor_b32 s9, s10, 327680
    buffer_load_dwordx4 v150, s[4:7], s9 offen offset:0 lds
    v_mfma_f32_32x32x16_bf16 v[32:47], a[212:215], v[100:103], v[32:47]
    ds_read_b64_tr_b16 v[90:91], v1 offset:26880
    s_waitcnt lgkmcnt(6)
    v_exp_f32 v136, v136
    v_exp_f32 v137, v137
    v_mfma_f32_32x32x16_bf16 v[16:31], a[88:91], v[104:107], v[16:31]
    ds_read_b64_tr_b16 v[92:93], v1 offset:27648
    s_add_u32 m0, s46, 147456
    s_nop 0
    global_load_lds_dwordx4 v5, s[58:59] offset:0 sc1
    v_add_u32 v5, 523264, v5
    v_mfma_f32_32x32x16_bf16 v[32:47], a[216:219], v[104:107], v[32:47]
    ds_read_b64_tr_b16 v[94:95], v1 offset:27904
    v_exp_f32 v138, v138
    v_exp_f32 v139, v139
    v_mfma_f32_32x32x16_bf16 v[16:31], a[92:95], v[108:111], v[16:31]
    ds_read_b64_tr_b16 v[96:97], v1 offset:28672
    global_load_lds_dwordx4 v5, s[58:59] offset:1024 sc1
    v_add_u32 v5, 523264, v5
    v_fma_f32 v136, v136, v125, v125
    v_mfma_f32_32x32x16_bf16 v[32:47], a[220:223], v[108:111], v[32:47]
    ds_read_b64_tr_b16 v[98:99], v1 offset:28928
    s_waitcnt lgkmcnt(6)
    v_fma_f32 v137, v137, v125, v125
    v_fma_f32 v138, v138, v125, v125
    v_fma_f32 v139, v139, v125, v125
    v_mfma_f32_32x32x16_bf16 v[16:31], a[96:99], v[80:83], v[16:31]
    ds_read_b64_tr_b16 v[100:101], v1 offset:29696
    v_rcp_f32 v136, v136
    v_rcp_f32 v137, v137
    v_mfma_f32_32x32x16_bf16 v[32:47], a[224:227], v[80:83], v[32:47]
    ds_read_b64_tr_b16 v[102:103], v1 offset:29952
    global_load_lds_dwordx4 v5, s[58:59] offset:2048 sc1
    v_add_u32 v5, 523264, v5
    v_mfma_f32_32x32x16_bf16 v[16:31], a[100:103], v[84:87], v[16:31]
    ds_read_b64_tr_b16 v[104:105], v1 offset:30720
    v_rcp_f32 v138, v138
    v_rcp_f32 v139, v139
    v_mul_f32 v136, v76, v136
    v_mfma_f32_32x32x16_bf16 v[32:47], a[228:231], v[84:87], v[32:47]
    ds_read_b64_tr_b16 v[106:107], v1 offset:30976
    s_waitcnt lgkmcnt(6)
    global_load_lds_dwordx4 v5, s[58:59] offset:3072 sc1
    v_mul_f32 v137, v77, v137
    v_mul_f32 v138, v78, v138
    v_mfma_f32_32x32x16_bf16 v[16:31], a[104:107], v[88:91], v[16:31]
    ds_read_b64_tr_b16 v[108:109], v1 offset:31744
    v_mul_f32 v139, v79, v139
    v_cvt_pk_bf16_f32 v146, v136, v137
    v_cvt_pk_bf16_f32 v147, v138, v139
    v_mfma_f32_32x32x16_bf16 v[32:47], a[232:235], v[88:91], v[32:47]
    ds_read_b64_tr_b16 v[110:111], v1 offset:32000
    v_mfma_f32_32x32x16_bf16 v[16:31], a[108:111], v[92:95], v[16:31]
    global_store_dwordx4 v148, v[144:147], s[60:61] offset:512 sc1
    v_add_u32 v148, 1835008, v148
    v_mfma_f32_32x32x16_bf16 v[32:47], a[236:239], v[92:95], v[32:47]
    s_waitcnt lgkmcnt(4)
    s_waitcnt vmcnt(19)
    s_waitcnt lgkmcnt(0)
    s_barrier
    v_mfma_f32_32x32x16_bf16 v[16:31], a[112:115], v[96:99], v[16:31]
    ds_read_b64_tr_b16 v[80:81], v1 offset:32768
    ds_read_b64_tr_b16 v[82:83], v1 offset:33024
    s_add_u32 m0, s56, 8192
    s_nop 0
    buffer_load_dwordx4 v150, s[12:15], s9 offen offset:1024 lds
    v_mfma_f32_32x32x16_bf16 v[32:47], a[240:243], v[96:99], v[32:47]
    ds_read_b64_tr_b16 v[84:85], v1 offset:33792
    ds_read_b64_tr_b16 v[86:87], v1 offset:34048
    v_mfma_f32_32x32x16_bf16 v[16:31], a[116:119], v[100:103], v[16:31]
    ds_read_b64_tr_b16 v[88:89], v1 offset:34816
    buffer_load_dwordx4 v129, s[4:7], s9 offen offset:2048 lds
    s_waitcnt vmcnt(15)
    v_cmp_ne_u32 vcc, s30, v126
    s_cbranch_vccnz slow_pok_27
pok_27:
    v_mfma_f32_32x32x16_bf16 v[32:47], a[244:247], v[100:103], v[32:47]
    ds_read_b64_tr_b16 v[90:91], v1 offset:35072
    v_and_b32 v125, s76, v127
    v_mov_b32 v120, v127
    v_rcp_f32 v124, v125
    v_mfma_f32_32x32x16_bf16 v[16:31], a[120:123], v[104:107], v[16:31]
    ds_read_b64_tr_b16 v[92:93], v1 offset:35840
    buffer_load_dwordx4 v129, s[12:15], s9 offen offset:3072 lds
    v_add_u32 v152, 4096, v152
    v_mul_f32 v124, 0xbfb8aa3b, v124
    v_mfma_f32_32x32x16_bf16 v[32:47], a[248:251], v[104:107], v[32:47]
    ds_read_b64_tr_b16 v[94:95], v1 offset:36096
    v_mfma_f32_32x32x16_bf16 v[16:31], a[124:127], v[108:111], v[16:31]
    ds_read_b64_tr_b16 v[96:97], v1 offset:36864
    s_add_u32 m0, s73, 0
    s_xor_b32 s9, s10, 360448
    buffer_load_dwordx4 v150, s[4:7], s9 offen offset:0 lds
    v_mfma_f32_32x32x16_bf16 v[32:47], a[252:255], v[108:111], v[32:47]
    ds_read_b64_tr_b16 v[98:99], v1 offset:37120
    s_waitcnt lgkmcnt(6)
    s_nop 0
    v_mfma_f32_32x32x16_bf16 v[16:31], v[112:115], v[120:123], v[16:31]
    v_mfma_f32_32x32x16_bf16 v[32:47], v[116:119], v[120:123], v[32:47]
    v_mfma_f32_32x32x16_bf16 v[48:63], a[0:3], v[80:83], 0
    ds_read_b64_tr_b16 v[100:101], v1 offset:37888
    s_waitcnt vmcnt(11)
    v_cmp_ne_u32 vcc, s30, v128
    s_cbranch_vccnz slow_pok_29
pok_29:
    v_add_u32 v153, 0x20000, v153
    v_mfma_f32_32x32x16_bf16 v[64:79], a[128:131], v[80:83], 0
    ds_read_b64_tr_b16 v[102:103], v1 offset:38144
    v_mov_b32 v149, v155
    v_add_u32 v153, 0x20000, v153
    buffer_load_dwordx4 v150, s[12:15], s9 offen offset:1024 lds
    v_mfma_f32_32x32x16_bf16 v[48:63], a[4:7], v[84:87], v[48:63]
    ds_read_b64_tr_b16 v[104:105], v1 offset:38912
    v_mov_b32 v140, -1
    v_mov_b32 v141, -1
    v_mov_b32 v142, -1
    v_mov_b32 v143, -1
    v_mfma_f32_32x32x16_bf16 v[64:79], a[132:135], v[84:87], v[64:79]
    ds_read_b64_tr_b16 v[106:107], v1 offset:39168
    s_waitcnt lgkmcnt(6)
    buffer_load_dwordx4 v129, s[4:7], s9 offen offset:2048 lds
    v_mfma_f32_32x32x16_bf16 v[48:63], a[8:11], v[88:91], v[48:63]
    ds_read_b64_tr_b16 v[108:109], v1 offset:39936
    v_mfma_f32_32x32x16_bf16 v[64:79], a[136:139], v[88:91], v[64:79]
    ds_read_b64_tr_b16 v[110:111], v1 offset:40192
    global_store_dwordx4 v130, v[140:143], s[60:61] sc1
    v_mfma_f32_32x32x16_bf16 v[48:63], a[12:15], v[92:95], v[48:63]
    ds_read_b64_tr_b16 v[80:81], v1 offset:40960
    v_mfma_f32_32x32x16_bf16 v[64:79], a[140:143], v[92:95], v[64:79]
    ds_read_b64_tr_b16 v[82:83], v1 offset:41216
    s_waitcnt lgkmcnt(6)
    global_store_dwordx4 v130, v[140:143], s[60:61] offset:512 sc1
    v_add_u32 v130, 1835008, v130
    v_mfma_f32_32x32x16_bf16 v[48:63], a[16:19], v[96:99], v[48:63]
    ds_read_b64_tr_b16 v[84:85], v1 offset:41984
    v_mul_f32 v132, v124, v16
    v_mul_f32 v133, v124, v17
    v_mul_f32 v134, v124, v18
    v_mul_f32 v135, v124, v19
    v_mul_f32 v136, v124, v20
    v_mfma_f32_32x32x16_bf16 v[64:79], a[144:147], v[96:99], v[64:79]
    ds_read_b64_tr_b16 v[86:87], v1 offset:42240
    v_exp_f32 v132, v132
    v_exp_f32 v133, v133
    v_mul_f32 v137, v124, v21
    v_mfma_f32_32x32x16_bf16 v[48:63], a[20:23], v[100:103], v[48:63]
    ds_read_b64_tr_b16 v[88:89], v1 offset:43008
    v_exp_f32 v134, v134
    v_exp_f32 v135, v135
    v_mul_f32 v138, v124, v22
    v_mfma_f32_32x32x16_bf16 v[64:79], a[148:151], v[100:103], v[64:79]
    ds_read_b64_tr_b16 v[90:91], v1 offset:43264
    s_waitcnt lgkmcnt(6)
    buffer_load_dwordx4 v129, s[12:15], s9 offen offset:3072 lds
    v_fma_f32 v132, v132, v125, v125
    v_mfma_f32_32x32x16_bf16 v[48:63], a[24:27], v[104:107], v[48:63]
    ds_read_b64_tr_b16 v[92:93], v1 offset:44032
    v_fma_f32 v133, v133, v125, v125
    v_fma_f32 v134, v134, v125, v125
    v_fma_f32 v135, v135, v125, v125
    v_mul_f32 v139, v124, v23
    v_mfma_f32_32x32x16_bf16 v[64:79], a[152:155], v[104:107], v[64:79]
    ds_read_b64_tr_b16 v[94:95], v1 offset:44288
    v_rcp_f32 v132, v132
    v_rcp_f32 v133, v133
    s_waitcnt vmcnt(10)
    v_mfma_f32_32x32x16_bf16 v[48:63], a[28:31], v[108:111], v[48:63]
    ds_read_b64_tr_b16 v[96:97], v1 offset:45056
    v_rcp_f32 v134, v134
    v_rcp_f32 v135, v135
    v_mul_f32 v132, v32, v132
    v_mfma_f32_32x32x16_bf16 v[64:79], a[156:159], v[108:111], v[64:79]
    ds_read_b64_tr_b16 v[98:99], v1 offset:45312
    s_waitcnt lgkmcnt(6)
    s_add_u32 m0, s73, 4096
    s_xor_b32 s9, s11, 393216
    buffer_load_dwordx4 v150, s[4:7], s9 offen offset:0 lds
    v_mfma_f32_32x32x16_bf16 v[48:63], a[32:35], v[80:83], v[48:63]
    ds_read_b64_tr_b16 v[100:101], v1 offset:46080
    v_mul_f32 v133, v33, v133
    v_mul_f32 v134, v34, v134
    v_mul_f32 v135, v35, v135
    v_cvt_pk_bf16_f32 v140, v132, v133
    v_mfma_f32_32x32x16_bf16 v[64:79], a[160:163], v[80:83], v[64:79]
    ds_read_b64_tr_b16 v[102:103], v1 offset:46336
    v_cvt_pk_bf16_f32 v141, v134, v135
    v_mul_f32 v132, v124, v24
    v_mul_f32 v133, v124, v25
    v_mul_f32 v134, v124, v26
    v_mfma_f32_32x32x16_bf16 v[48:63], a[36:39], v[84:87], v[48:63]
    ds_read_b64_tr_b16 v[104:105], v1 offset:47104
    v_exp_f32 v136, v136
    v_exp_f32 v137, v137
    v_mul_f32 v135, v124, v27
    v_mfma_f32_32x32x16_bf16 v[64:79], a[164:167], v[84:87], v[64:79]
    ds_read_b64_tr_b16 v[106:107], v1 offset:47360
    s_waitcnt lgkmcnt(6)
    buffer_load_dwordx4 v150, s[12:15], s9 offen offset:1024 lds
    v_exp_f32 v138, v138
    v_mfma_f32_32x32x16_bf16 v[48:63], a[40:43], v[88:91], v[48:63]
    ds_read_b64_tr_b16 v[108:109], v1 offset:48128
    v_exp_f32 v139, v139
    v_fma_f32 v136, v136, v125, v125
    v_fma_f32 v137, v137, v125, v125
    v_mfma_f32_32x32x16_bf16 v[64:79], a[168:171], v[88:91], v[64:79]
    ds_read_b64_tr_b16 v[110:111], v1 offset:48384
    v_fma_f32 v138, v138, v125, v125
    v_fma_f32 v139, v139, v125, v125
    v_rcp_f32 v136, v136
    v_mfma_f32_32x32x16_bf16 v[48:63], a[44:47], v[92:95], v[48:63]
    ds_read_b64_tr_b16 v[80:81], v1 offset:49152
    v_rcp_f32 v137, v137
    v_rcp_f32 v138, v138
    v_mfma_f32_32x32x16_bf16 v[64:79], a[172:175], v[92:95], v[64:79]
    ds_read_b64_tr_b16 v[82:83], v1 offset:49408
    s_waitcnt lgkmcnt(6)
    buffer_load_dwordx4 v129, s[4:7], s9 offen offset:2048 lds
    v_rcp_f32 v139, v139
    v_mfma_f32_32x32x16_bf16 v[48:63], a[48:51], v[96:99], v[48:63]
    ds_read_b64_tr_b16 v[84:85], v1 offset:50176
    global_load_dwordx2 v[126:127], v152, s[28:29] sc1
    v_mul_f32 v136, v36, v136
    v_mul_f32 v137, v37, v137
    v_mul_f32 v138, v38, v138
    v_mfma_f32_32x32x16_bf16 v[64:79], a[176:179], v[96:99], v[64:79]
    ds_read_b64_tr_b16 v[86:87], v1 offset:50432
    v_mul_f32 v139, v39, v139
    v_cvt_pk_bf16_f32 v142, v136, v137
    v_cvt_pk_bf16_f32 v143, v138, v139
    ds_read_b64_tr_b16 v[158:159], v9 offset:0
    v_mfma_f32_32x32x16_bf16 v[48:63], a[52:55], v[100:103], v[48:63]
    ds_read_b64_tr_b16 v[88:89], v1 offset:51200
    v_exp_f32 v132, v132
    v_exp_f32 v133, v133
    v_mfma_f32_32x32x16_bf16 v[64:79], a[180:183], v[100:103], v[64:79]
    ds_read_b64_tr_b16 v[90:91], v1 offset:51456
    s_waitcnt lgkmcnt(7)
    global_store_dwordx4 v148, v[140:143], s[60:61] offset:0 sc1
    v_mul_f32 v136, v124, v28
    v_mul_f32 v137, v124, v29
    v_mfma_f32_32x32x16_bf16 v[48:63], a[56:59], v[104:107], v[48:63]
    ds_read_b64_tr_b16 v[92:93], v1 offset:52224
    v_exp_f32 v134, v134
    v_exp_f32 v135, v135
    v_mul_f32 v138, v124, v30
    v_mfma_f32_32x32x16_bf16 v[64:79], a[184:187], v[104:107], v[64:79]
    ds_read_b64_tr_b16 v[94:95], v1 offset:52480
    v_fma_f32 v132, v132, v125, v125
    v_fma_f32 v133, v133, v125, v125
    v_fma_f32 v134, v134, v125, v125
    v_fma_f32 v135, v135, v125, v125
    v_mfma_f32_32x32x16_bf16 v[48:63], a[60:63], v[108:111], v[48:63]
    ds_read_b64_tr_b16 v[96:97], v1 offset:53248
    v_rcp_f32 v132, v132
    v_rcp_f32 v133, v133
    v_mul_f32 v139, v124, v31
    v_mfma_f32_32x32x16_bf16 v[64:79], a[188:191], v[108:111], v[64:79]
    ds_read_b64_tr_b16 v[98:99], v1 offset:53504
    s_waitcnt lgkmcnt(7)
    global_load_dwordx4 a[128:131], v155, s[60:61] offset:0 sc1
    v_rcp_f32 v134, v134
    v_mfma_f32_32x32x16_bf16 v[48:63], a[64:67], v[80:83], v[48:63]
    ds_read_b64_tr_b16 v[100:101], v1 offset:54272
    v_rcp_f32 v135, v135
    v_mul_f32 v132, v40, v132
    v_mul_f32 v133, v41, v133
    v_mul_f32 v134, v42, v134
    v_mfma_f32_32x32x16_bf16 v[64:79], a[192:195], v[80:83], v[64:79]
    ds_read_b64_tr_b16 v[102:103], v1 offset:54528
    v_mul_f32 v135, v43, v135
    v_cvt_pk_bf16_f32 v144, v132, v133
    v_cvt_pk_bf16_f32 v145, v134, v135
    ds_read_b64_tr_b16 v[130:131], v9 offset:1024
    v_mfma_f32_32x32x16_bf16 v[48:63], a[68:71], v[84:87], v[48:63]
    ds_read_b64_tr_b16 v[104:105], v1 offset:55296
    v_exp_f32 v136, v136
    v_exp_f32 v137, v137
    v_mfma_f32_32x32x16_bf16 v[64:79], a[196:199], v[84:87], v[64:79]
    ds_read_b64_tr_b16 v[106:107], v1 offset:55552
    s_waitcnt lgkmcnt(7)
    global_load_dwordx4 a[132:135], v155, s[60:61] offset:1024 sc1
    v_exp_f32 v138, v138
    v_mfma_f32_32x32x16_bf16 v[48:63], a[72:75], v[88:91], v[48:63]
    ds_read_b64_tr_b16 v[108:109], v1 offset:56320
    v_exp_f32 v139, v139
    v_fma_f32 v136, v136, v125, v125
    v_fma_f32 v137, v137, v125, v125
    v_mfma_f32_32x32x16_bf16 v[64:79], a[200:203], v[88:91], v[64:79]
    ds_read_b64_tr_b16 v[110:111], v1 offset:56576
    v_fma_f32 v138, v138, v125, v125
    v_fma_f32 v139, v139, v125, v125
    v_rcp_f32 v136, v136
    v_mfma_f32_32x32x16_bf16 v[48:63], a[76:79], v[92:95], v[48:63]
    ds_read_b64_tr_b16 v[80:81], v1 offset:57344
    v_rcp_f32 v137, v137
    v_rcp_f32 v138, v138
    v_mfma_f32_32x32x16_bf16 v[64:79], a[204:207], v[92:95], v[64:79]
    ds_read_b64_tr_b16 v[82:83], v1 offset:57600
    s_waitcnt lgkmcnt(7)
    s_waitcnt vmcnt(8)
    s_mov_b64 exec, 1
    global_store_dword v154, v157, s[28:29] sc1
    s_mov_b64 exec, -1
    v_add_u32 v154, 0x20000, v154
    v_mfma_f32_32x32x16_bf16 v[48:63], a[80:83], v[96:99], v[48:63]
    ds_read_b64_tr_b16 v[84:85], v1 offset:58368
    global_load_dwordx4 a[136:139], v155, s[60:61] offset:2048 sc1
    v_rcp_f32 v139, v139
    v_mul_f32 v136, v44, v136
    v_mfma_f32_32x32x16_bf16 v[64:79], a[208:211], v[96:99], v[64:79]
    ds_read_b64_tr_b16 v[86:87], v1 offset:58624
    v_mul_f32 v137, v45, v137
    v_mul_f32 v138, v46, v138
    v_mul_f32 v139, v47, v139
    v_cvt_pk_bf16_f32 v146, v136, v137
    v_mfma_f32_32x32x16_bf16 v[48:63], a[84:87], v[100:103], v[48:63]
    ds_read_b64_tr_b16 v[88:89], v1 offset:59392
    v_cvt_pk_bf16_f32 v147, v138, v139
    ds_read_b64_tr_b16 v[10:11], v9 offset:2048
    ds_read_b64_tr_b16 v[12:13], v9 offset:3072
    ds_read_b64_tr_b16 a[0:1], v151 offset:16384
    v_mfma_f32_32x32x16_bf16 v[64:79], a[212:215], v[100:103], v[64:79]
    ds_read_b64_tr_b16 v[90:91], v1 offset:59648
    s_waitcnt lgkmcnt(9)
    global_store_dwordx4 v148, v[144:147], s[60:61] offset:512 sc1
    ds_read_b64_tr_b16 a[2:3], v151 offset:17408
    v_mfma_f32_32x32x16_bf16 v[48:63], a[88:91], v[104:107], v[48:63]
    ds_read_b64_tr_b16 v[92:93], v1 offset:60416
    ds_read_b64_tr_b16 a[4:5], v151 offset:16416
    ds_read_b64_tr_b16 a[6:7], v151 offset:17440
    ds_read_b64_tr_b16 a[8:9], v151 offset:16896
    v_add_u32 v148, 1835008, v148
    v_mfma_f32_32x32x16_bf16 v[64:79], a[216:219], v[104:107], v[64:79]
    ds_read_b64_tr_b16 v[94:95], v1 offset:60672
    global_load_dwordx4 a[140:143], v155, s[60:61] offset:3072 sc1
    v_add_u32 v155, 4096, v155
    ds_read_b64_tr_b16 a[10:11], v151 offset:17920
    v_mfma_f32_32x32x16_bf16 v[48:63], a[92:95], v[108:111], v[48:63]
    ds_read_b64_tr_b16 v[96:97], v1 offset:61440
    ds_read_b64_tr_b16 a[12:13], v151 offset:16928
    ds_read_b64_tr_b16 a[14:15], v151 offset:17952
    ds_read_b64_tr_b16 a[16:17], v151 offset:24576
    ds_read_b64_tr_b16 a[18:19], v151 offset:25600
    v_mfma_f32_32x32x16_bf16 v[64:79], a[220:223], v[108:111], v[64:79]
    ds_read_b64_tr_b16 v[98:99], v1 offset:61696
    s_waitcnt lgkmcnt(15)
    global_load_dwordx4 a[144:147], v155, s[60:61] offset:0 sc1
    ds_read_b64_tr_b16 a[20:21], v151 offset:24608
    v_mfma_f32_32x32x16_bf16 v[48:63], a[96:99], v[80:83], v[48:63]
    ds_read_b64_tr_b16 v[100:101], v1 offset:62464
    ds_read_b64_tr_b16 a[22:23], v151 offset:25632
    ds_read_b64_tr_b16 a[24:25], v151 offset:25088
    ds_read_b64_tr_b16 a[26:27], v151 offset:26112
    ds_read_b64_tr_b16 a[28:29], v151 offset:25120
    v_mfma_f32_32x32x16_bf16 v[64:79], a[224:227], v[80:83], v[64:79]
    ds_read_b64_tr_b16 v[102:103], v1 offset:62720
    global_load_dwordx4 a[148:151], v155, s[60:61] offset:1024 sc1
    ds_read_b64_tr_b16 a[30:31], v151 offset:26144
    ds_read_b64_tr_b16 a[32:33], v151 offset:32768
    v_mfma_f32_32x32x16_bf16 v[48:63], a[100:103], v[84:87], v[48:63]
    ds_read_b64_tr_b16 v[104:105], v1 offset:63488
    ds_read_b64_tr_b16 a[34:35], v151 offset:33792
    ds_read_b64_tr_b16 a[36:37], v151 offset:32800
    ds_read_b64_tr_b16 a[38:39], v151 offset:33824
    ds_read_b64_tr_b16 a[40:41], v151 offset:33280
    v_mfma_f32_32x32x16_bf16 v[64:79], a[228:231], v[84:87], v[64:79]
    ds_read_b64_tr_b16 v[106:107], v1 offset:63744
    s_waitcnt lgkmcnt(15)
    global_load_dwordx4 a[152:155], v155, s[60:61] offset:2048 sc1
    ds_read_b64_tr_b16 a[42:43], v151 offset:34304
    v_mfma_f32_32x32x16_bf16 v[48:63], a[104:107], v[88:91], v[48:63]
    ds_read_b64_tr_b16 v[108:109], v1 offset:64512
    ds_read_b64_tr_b16 a[44:45], v151 offset:33312
    ds_read_b64_tr_b16 a[46:47], v151 offset:34336
    ds_read_b64_tr_b16 a[48:49], v151 offset:0
    ds_read_b64_tr_b16 a[50:51], v151 offset:1024
    v_mfma_f32_32x32x16_bf16 v[64:79], a[232:235], v[88:91], v[64:79]
    ds_read_b64_tr_b16 v[110:111], v1 offset:64768
    global_load_dwordx4 a[156:159], v155, s[60:61] offset:3072 sc1
    v_add_u32 v155, 4096, v155
    ds_read_b64_tr_b16 a[52:53], v151 offset:32
    v_mfma_f32_32x32x16_bf16 v[48:63], a[108:111], v[92:95], v[48:63]
    ds_read_b64_tr_b16 a[54:55], v151 offset:1056
    ds_read_b64_tr_b16 a[56:57], v151 offset:512
    ds_read_b64_tr_b16 a[58:59], v151 offset:1536
    ds_read_b64_tr_b16 a[60:61], v151 offset:544
    ds_read_b64_tr_b16 a[62:63], v151 offset:1568
    v_mfma_f32_32x32x16_bf16 v[64:79], a[236:239], v[92:95], v[64:79]
    s_waitcnt lgkmcnt(15)
    global_load_dwordx4 a[160:163], v155, s[60:61] offset:0 sc1
    ds_read_b64_tr_b16 a[64:65], v151 offset:8192
    ds_read_b64_tr_b16 a[66:67], v151 offset:9216
    v_mfma_f32_32x32x16_bf16 v[48:63], a[112:115], v[96:99], v[48:63]
    ds_read_b64_tr_b16 a[68:69], v151 offset:8224
    ds_read_b64_tr_b16 a[70:71], v151 offset:9248
    ds_read_b64_tr_b16 a[72:73], v151 offset:8704
    ds_read_b64_tr_b16 a[74:75], v151 offset:9728
    ds_read_b64_tr_b16 a[76:77], v151 offset:8736
    v_mfma_f32_32x32x16_bf16 v[64:79], a[240:243], v[96:99], v[64:79]
    buffer_load_dwordx4 v129, s[12:15], s9 offen offset:3072 lds
    ds_read_b64_tr_b16 a[78:79], v151 offset:9760
    s_waitcnt vmcnt(17)
    ds_read_b64_tr_b16 a[80:81], v4 offset:0
    v_mfma_f32_32x32x16_bf16 v[48:63], a[116:119], v[100:103], v[48:63]
    s_waitcnt vmcnt(13)
    v_cmp_ne_u32 vcc, s30, v126
    s_cbranch_vccnz slow_pok_31
pok_31:
    v_and_b32 v125, s76, v127
    v_mov_b32 v120, v127
    ds_read_b64_tr_b16 a[82:83], v4 offset:1024
    v_mfma_f32_32x32x16_bf16 v[64:79], a[244:247], v[100:103], v[64:79]
    s_waitcnt lgkmcnt(15)
    global_load_dwordx4 a[164:167], v155, s[60:61] offset:1024 sc1
    v_rcp_f32 v124, v125
    v_add_u32 v152, 4096, v152
    v_mfma_f32_32x32x16_bf16 v[48:63], a[120:123], v[104:107], v[48:63]
    v_mul_f32 v124, 0xbfb8aa3b, v124
    ds_read_b64_tr_b16 a[84:85], v4 offset:32
    ds_read_b64_tr_b16 a[86:87], v4 offset:1056
    ds_read_b64_tr_b16 a[88:89], v4 offset:512
    ds_read_b64_tr_b16 a[90:91], v4 offset:1536
    v_mfma_f32_32x32x16_bf16 v[64:79], a[248:251], v[104:107], v[64:79]
    s_add_u32 m0, s56, 16384
    s_xor_b32 s9, s11, 425984
    buffer_load_dwordx4 v150, s[4:7], s9 offen offset:0 lds
    ds_read_b64_tr_b16 a[92:93], v4 offset:544
    v_mfma_f32_32x32x16_bf16 v[48:63], a[124:127], v[108:111], v[48:63]
    ds_read_b64_tr_b16 a[94:95], v4 offset:1568
    v_mfma_f32_32x32x16_bf16 v[64:79], a[252:255], v[108:111], v[64:79]
    buffer_load_dwordx4 v150, s[12:15], s9 offen offset:1024 lds
    s_nop 0
    v_mfma_f32_32x32x16_bf16 v[48:63], v[112:115], v[120:123], v[48:63]
    v_mfma_f32_32x32x16_bf16 v[64:79], v[116:119], v[120:123], v[64:79]
    buffer_load_dwordx4 v129, s[4:7], s9 offen offset:2048 lds
    v_lshlrev_b32 v16, 16, v158
    v_and_b32 v17, s76, v158
    v_lshlrev_b32 v18, 16, v159
    v_and_b32 v19, s76, v159
    s_nop 1
    s_nop 1
    s_waitcnt vmcnt(15)
    v_mfma_f32_16x16x32_bf16 v[16:19], v[160:163], a[128:131], v[16:19]
    v_lshlrev_b32 v32, 16, v130
    v_and_b32 v33, s76, v130
    v_mfma_f32_16x16x32_bf16 v[20:23], v[164:167], a[128:131], 0
    v_lshlrev_b32 v34, 16, v131
    v_and_b32 v35, s76, v131
    v_mul_f32 v132, v124, v48
    v_mul_f32 v133, v124, v49
    v_mul_f32 v134, v124, v50
    v_mul_f32 v135, v124, v51
    v_exp_f32 v132, v132
    v_exp_f32 v133, v133
    v_mfma_f32_16x16x32_bf16 v[24:27], v[168:171], a[128:131], 0
    v_exp_f32 v134, v134
    v_exp_f32 v135, v135
    v_fma_f32 v132, v132, v125, v125
    v_fma_f32 v133, v133, v125, v125
    v_fma_f32 v134, v134, v125, v125
    v_fma_f32 v135, v135, v125, v125
    v_mfma_f32_16x16x32_bf16 v[28:31], v[172:175], a[128:131], 0
    v_rcp_f32 v132, v132
    v_rcp_f32 v133, v133
    v_rcp_f32 v134, v134
    v_rcp_f32 v135, v135
    v_mul_f32 v132, v64, v132
    s_waitcnt vmcnt(14)
    v_mfma_f32_16x16x32_bf16 v[16:19], v[176:179], a[132:135], v[16:19]
    buffer_load_dwordx4 v129, s[12:15], s9 offen offset:3072 lds
    v_mul_f32 v133, v65, v133
    v_mul_f32 v134, v66, v134
    v_mul_f32 v135, v67, v135
    s_mov_b64 exec, 1
    global_store_dword v154, v157, s[28:29] sc1
    s_mov_b64 exec, -1
    v_add_u32 v154, 0x20000, v154
    v_mfma_f32_16x16x32_bf16 v[20:23], v[180:183], a[132:135], v[20:23]
    v_cvt_pk_bf16_f32 v140, v132, v133
    v_cvt_pk_bf16_f32 v141, v134, v135
    v_mul_f32 v136, v124, v52
    v_mul_f32 v137, v124, v53
    v_mul_f32 v138, v124, v54
    v_mul_f32 v139, v124, v55
    v_exp_f32 v136, v136
    v_exp_f32 v137, v137
    global_load_dwordx4 a[168:171], v155, s[60:61] offset:2048 sc1
    v_mfma_f32_16x16x32_bf16 v[24:27], v[184:187], a[132:135], v[24:27]
    v_exp_f32 v138, v138
    v_exp_f32 v139, v139
    v_fma_f32 v136, v136, v125, v125
    v_fma_f32 v137, v137, v125, v125
    v_fma_f32 v138, v138, v125, v125
    v_fma_f32 v139, v139, v125, v125
    v_mfma_f32_16x16x32_bf16 v[28:31], v[188:191], a[132:135], v[28:31]
    v_rcp_f32 v136, v136
    v_rcp_f32 v137, v137
    global_load_dwordx4 a[172:175], v155, s[60:61] offset:3072 sc1
    v_add_u32 v155, 4096, v155
    v_rcp_f32 v138, v138
    s_waitcnt vmcnt(16)
    v_mfma_f32_16x16x32_bf16 v[16:19], v[192:195], a[136:139], v[16:19]
    v_rcp_f32 v139, v139
    v_mul_f32 v136, v68, v136
    v_mul_f32 v137, v69, v137
    v_mul_f32 v138, v70, v138
    v_mul_f32 v139, v71, v139
    v_cvt_pk_bf16_f32 v142, v136, v137
    v_cvt_pk_bf16_f32 v143, v138, v139
    global_store_dwordx4 v148, v[140:143], s[60:61] offset:0 sc1
    v_mfma_f32_16x16x32_bf16 v[20:23], v[196:199], a[136:139], v[20:23]
    v_mul_f32 v132, v124, v56
    v_mul_f32 v133, v124, v57
    v_mul_f32 v134, v124, v58
    v_mul_f32 v135, v124, v59
    v_exp_f32 v132, v132
    v_exp_f32 v133, v133
    v_exp_f32 v134, v134
    global_load_dwordx4 a[176:179], v155, s[60:61] offset:0 sc1
    v_mfma_f32_16x16x32_bf16 v[24:27], v[200:203], a[136:139], v[24:27]
    v_exp_f32 v135, v135
    v_fma_f32 v132, v132, v125, v125
    v_fma_f32 v133, v133, v125, v125
    v_fma_f32 v134, v134, v125, v125
    v_fma_f32 v135, v135, v125, v125
    v_rcp_f32 v132, v132
    v_mfma_f32_16x16x32_bf16 v[28:31], v[204:207], a[136:139], v[28:31]
    v_rcp_f32 v133, v133
    v_rcp_f32 v134, v134
    global_load_dwordx4 a[180:183], v155, s[60:61] offset:1024 sc1
    v_add_u32 v155, 1822720, v155
    v_rcp_f32 v135, v135
    s_waitcnt vmcnt(17)
    v_mfma_f32_16x16x32_bf16 v[16:19], v[208:211], a[140:143], v[16:19]
    v_mul_f32 v132, v72, v132
    v_mul_f32 v133, v73, v133
    v_mul_f32 v134, v74, v134
    v_mul_f32 v135, v75, v135
    v_cvt_pk_bf16_f32 v144, v132, v133
    v_cvt_pk_bf16_f32 v145, v134, v135
    v_mul_f32 v136, v124, v60
    v_mul_f32 v137, v124, v61
    v_mul_f32 v138, v124, v62
    global_load_dword v128, v153, s[28:29] sc1
    v_mfma_f32_16x16x32_bf16 v[20:23], v[212:215], a[140:143], v[20:23]
    v_mul_f32 v139, v124, v63
    v_exp_f32 v136, v136
    v_exp_f32 v137, v137
    v_exp_f32 v138, v138
    v_exp_f32 v139, v139
    v_mfma_f32_16x16x32_bf16 v[24:27], v[216:219], a[140:143], v[24:27]
    s_waitcnt vmcnt(12)
    ds_read_b64_tr_b16 a[96:97], v4 offset:4096
    v_fma_f32 v136, v136, v125, v125
    global_load_dwordx4 a[184:187], v155, s[60:61] offset:0 sc1
    v_fma_f32 v137, v137, v125, v125
    v_fma_f32 v138, v138, v125, v125
    v_fma_f32 v139, v139, v125, v125
    v_mfma_f32_16x16x32_bf16 v[28:31], v[220:223], a[140:143], v[28:31]
    ds_read_b64_tr_b16 a[98:99], v4 offset:5120
    ds_read_b64_tr_b16 a[100:101], v4 offset:4128
    v_rcp_f32 v136, v136
    v_rcp_f32 v137, v137
    v_rcp_f32 v138, v138
    v_rcp_f32 v139, v139
    global_load_dwordx4 a[188:191], v155, s[60:61] offset:1024 sc1
    v_mfma_f32_16x16x32_bf16 v[16:19], v[224:227], a[144:147], v[16:19]
    ds_read_b64_tr_b16 a[102:103], v4 offset:5152
    ds_read_b64_tr_b16 a[104:105], v4 offset:4608
    v_mul_f32 v136, v76, v136
    v_mul_f32 v137, v77, v137
    v_mul_f32 v138, v78, v138
    v_mul_f32 v139, v79, v139
    v_cvt_pk_bf16_f32 v146, v136, v137
    v_cvt_pk_bf16_f32 v147, v138, v139
    v_mfma_f32_16x16x32_bf16 v[20:23], v[228:231], a[144:147], v[20:23]
    ds_read_b64_tr_b16 a[106:107], v4 offset:5632
    ds_read_b64_tr_b16 a[108:109], v4 offset:4640
    global_store_dwordx4 v148, v[144:147], s[60:61] offset:512 sc1
    v_add_u32 v148, 1835008, v148
    v_mfma_f32_16x16x32_bf16 v[24:27], v[232:235], a[144:147], v[24:27]
    ds_read_b64_tr_b16 a[110:111], v4 offset:5664
    v_lshlrev_b32 v48, 16, v10
    v_mfma_f32_16x16x32_bf16 v[28:31], v[236:239], a[144:147], v[28:31]
    global_load_dwordx4 a[192:195], v155, s[60:61] offset:2048 sc1
    v_mfma_f32_16x16x32_bf16 v[16:19], v[240:243], a[148:151], v[16:19]
    v_and_b32 v49, s76, v10
    v_lshlrev_b32 v50, 16, v11
    v_mfma_f32_16x16x32_bf16 v[20:23], v[244:247], a[148:151], v[20:23]
    v_and_b32 v51, s76, v11
    v_mfma_f32_16x16x32_bf16 v[24:27], v[248:251], a[148:151], v[24:27]
    v_mfma_f32_16x16x32_bf16 v[28:31], v[252:255], a[148:151], v[28:31]
    v_mfma_f32_16x16x32_bf16 v[16:19], a[0:3], a[152:155], v[16:19]
    v_mfma_f32_16x16x32_bf16 v[20:23], a[4:7], a[152:155], v[20:23]
    v_mfma_f32_16x16x32_bf16 v[24:27], a[8:11], a[152:155], v[24:27]
    v_mfma_f32_16x16x32_bf16 v[28:31], a[12:15], a[152:155], v[28:31]
    global_load_dwordx4 a[196:199], v155, s[60:61] offset:3072 sc1
    v_add_u32 v155, 4096, v155
    v_mfma_f32_16x16x32_bf16 v[16:19], a[16:19], a[156:159], v[16:19]
    v_mfma_f32_16x16x32_bf16 v[20:23], a[20:23], a[156:159], v[20:23]
    v_mfma_f32_16x16x32_bf16 v[24:27], a[24:27], a[156:159], v[24:27]
    s_waitcnt vmcnt(12)
    ds_read_b64_tr_b16 a[112:113], v151 offset:16384
    v_mfma_f32_16x16x32_bf16 v[28:31], a[28:31], a[156:159], v[28:31]
    ds_read_b64_tr_b16 a[114:115], v151 offset:17408
    global_load_dwordx4 a[200:203], v155, s[60:61] offset:0 sc1
    v_mfma_f32_16x16x32_bf16 v[16:19], a[32:35], a[160:163], v[16:19]
    ds_read_b64_tr_b16 a[116:117], v151 offset:16416
    ds_read_b64_tr_b16 a[118:119], v151 offset:17440
    v_mfma_f32_16x16x32_bf16 v[20:23], a[36:39], a[160:163], v[20:23]
    ds_read_b64_tr_b16 a[120:121], v151 offset:16896
    ds_read_b64_tr_b16 a[122:123], v151 offset:17920
    v_mfma_f32_16x16x32_bf16 v[24:27], a[40:43], a[160:163], v[24:27]
    ds_read_b64_tr_b16 a[124:125], v151 offset:16928
    ds_read_b64_tr_b16 a[126:127], v151 offset:17952
    v_mfma_f32_16x16x32_bf16 v[28:31], a[44:47], a[160:163], v[28:31]
    global_load_dwordx4 a[204:207], v155, s[60:61] offset:1024 sc1
    s_waitcnt lgkmcnt(15)
    v_mfma_f32_16x16x32_bf16 v[16:19], a[48:51], a[164:167], v[16:19]
    v_mfma_f32_16x16x32_bf16 v[20:23], a[52:55], a[164:167], v[20:23]
    v_mfma_f32_16x16x32_bf16 v[24:27], a[56:59], a[164:167], v[24:27]
    v_mfma_f32_16x16x32_bf16 v[28:31], a[60:63], a[164:167], v[28:31]
    global_load_dwordx4 a[208:211], v155, s[60:61] offset:2048 sc1
    s_waitcnt vmcnt(13)
    v_mfma_f32_16x16x32_bf16 v[16:19], a[64:67], a[168:171], v[16:19]
    v_mfma_f32_16x16x32_bf16 v[20:23], a[68:71], a[168:171], v[20:23]
    v_mfma_f32_16x16x32_bf16 v[24:27], a[72:75], a[168:171], v[24:27]
    v_mfma_f32_16x16x32_bf16 v[28:31], a[76:79], a[168:171], v[28:31]
    s_waitcnt vmcnt(12)
    v_mfma_f32_16x16x32_bf16 v[16:19], a[80:83], a[172:175], v[16:19]
    v_mfma_f32_16x16x32_bf16 v[20:23], a[84:87], a[172:175], v[20:23]
    v_mfma_f32_16x16x32_bf16 v[24:27], a[88:91], a[172:175], v[24:27]
    global_load_dwordx4 a[212:215], v155, s[60:61] offset:3072 sc1
    v_add_u32 v155, 4096, v155
    v_mfma_f32_16x16x32_bf16 v[28:31], a[92:95], a[172:175], v[28:31]
    s_waitcnt lgkmcnt(8)
    s_waitcnt vmcnt(11)
    v_mfma_f32_16x16x32_bf16 v[16:19], a[96:99], a[176:179], v[16:19]
    v_mfma_f32_16x16x32_bf16 v[20:23], a[100:103], a[176:179], v[20:23]
    global_load_dwordx4 a[216:219], v155, s[60:61] offset:0 sc1
    v_mfma_f32_16x16x32_bf16 v[24:27], a[104:107], a[176:179], v[24:27]
    v_mfma_f32_16x16x32_bf16 v[28:31], a[108:111], a[176:179], v[28:31]
    s_waitcnt lgkmcnt(0)
    s_waitcnt vmcnt(11)
    v_mfma_f32_16x16x32_bf16 v[16:19], a[112:115], a[180:183], v[16:19]
    v_mfma_f32_16x16x32_bf16 v[20:23], a[116:119], a[180:183], v[20:23]
    v_mfma_f32_16x16x32_bf16 v[24:27], a[120:123], a[180:183], v[24:27]
    global_load_dwordx4 a[220:223], v155, s[60:61] offset:1024 sc1
    v_mfma_f32_16x16x32_bf16 v[28:31], a[124:127], a[180:183], v[28:31]
    s_nop 1
    global_load_dwordx4 a[224:227], v155, s[60:61] offset:2048 sc1
    s_waitcnt vmcnt(11)
    v_mfma_f32_16x16x32_bf16 v[32:35], v[160:163], a[184:187], v[32:35]
    v_cmp_ne_u32 vcc, s30, v128
    s_cbranch_vccnz slow_pok_33
pok_33:
    v_add_u32 v153, 0x20000, v153
    v_mfma_f32_16x16x32_bf16 v[36:39], v[164:167], a[184:187], 0
    global_load_dwordx4 a[228:231], v155, s[60:61] offset:3072 sc1
    v_add_u32 v155, 4096, v155
    v_mfma_f32_16x16x32_bf16 v[40:43], v[168:171], a[184:187], 0
    v_mfma_f32_16x16x32_bf16 v[44:47], v[172:175], a[184:187], 0
    global_load_dword v128, v153, s[28:29] sc1
    s_waitcnt vmcnt(12)
    v_mfma_f32_16x16x32_bf16 v[32:35], v[176:179], a[188:191], v[32:35]
    v_mfma_f32_16x16x32_bf16 v[36:39], v[180:183], a[188:191], v[36:39]
    v_mfma_f32_16x16x32_bf16 v[40:43], v[184:187], a[188:191], v[40:43]
    v_mfma_f32_16x16x32_bf16 v[44:47], v[188:191], a[188:191], v[44:47]
    v_cmp_u_f32 vcc, v16, v16
    s_cbranch_vccnz slow_pok_35
pok_35:
    s_barrier
    ds_write_b128 v6, v[16:19] offset:0
    s_waitcnt vmcnt(10)
    v_mfma_f32_16x16x32_bf16 v[32:35], v[192:195], a[192:195], v[32:35]
    global_load_dwordx4 a[232:235], v155, s[60:61] offset:0 sc1
    v_mfma_f32_16x16x32_bf16 v[36:39], v[196:199], a[192:195], v[36:39]
    ds_write_b128 v0, v[20:23] offset:0
    v_mfma_f32_16x16x32_bf16 v[40:43], v[200:203], a[192:195], v[40:43]
    v_mfma_f32_16x16x32_bf16 v[44:47], v[204:207], a[192:195], v[44:47]
    global_load_dwordx4 a[236:239], v155, s[60:61] offset:1024 sc1
    v_add_u32 v155, 1822720, v155
    s_waitcnt vmcnt(11)
    v_mfma_f32_16x16x32_bf16 v[32:35], v[208:211], a[196:199], v[32:35]
    ds_write_b128 v15, v[24:27] offset:0
    v_mfma_f32_16x16x32_bf16 v[36:39], v[212:215], a[196:199], v[36:39]
    v_mfma_f32_16x16x32_bf16 v[40:43], v[216:219], a[196:199], v[40:43]
    v_mfma_f32_16x16x32_bf16 v[44:47], v[220:223], a[196:199], v[44:47]
    global_load_dwordx4 v[80:83], v155, s[60:61] offset:0 sc1
    s_waitcnt vmcnt(11)
    v_mfma_f32_16x16x32_bf16 v[32:35], v[224:227], a[200:203], v[32:35]
    ds_write_b128 v156, v[28:31] offset:0
    v_mfma_f32_16x16x32_bf16 v[36:39], v[228:231], a[200:203], v[36:39]
    v_mfma_f32_16x16x32_bf16 v[40:43], v[232:235], a[200:203], v[40:43]
    v_mfma_f32_16x16x32_bf16 v[44:47], v[236:239], a[200:203], v[44:47]
    global_load_dwordx4 v[84:87], v155, s[60:61] offset:1024 sc1
    s_waitcnt vmcnt(11)
    v_mfma_f32_16x16x32_bf16 v[32:35], v[240:243], a[204:207], v[32:35]
    v_mfma_f32_16x16x32_bf16 v[36:39], v[244:247], a[204:207], v[36:39]
    v_mfma_f32_16x16x32_bf16 v[40:43], v[248:251], a[204:207], v[40:43]
    v_mfma_f32_16x16x32_bf16 v[44:47], v[252:255], a[204:207], v[44:47]
    global_load_dwordx4 v[88:91], v155, s[60:61] offset:2048 sc1
    s_waitcnt vmcnt(11)
    v_mfma_f32_16x16x32_bf16 v[32:35], a[0:3], a[208:211], v[32:35]
    s_waitcnt lgkmcnt(0)
    s_barrier
    v_mfma_f32_16x16x32_bf16 v[36:39], a[4:7], a[208:211], v[36:39]
    ds_read_b128 v[132:135], v7 offset:0
    ds_read_b128 v[136:139], v7 offset:4352
    v_mfma_f32_16x16x32_bf16 v[40:43], a[8:11], a[208:211], v[40:43]
    global_load_dwordx4 v[92:95], v155, s[60:61] offset:3072 sc1
    v_add_u32 v155, 4096, v155
    v_mfma_f32_16x16x32_bf16 v[44:47], a[12:15], a[208:211], v[44:47]
    ds_read_b128 v[140:143], v7 offset:8704
    ds_read_b128 v[144:147], v7 offset:13056
    s_waitcnt vmcnt(11)
    v_mfma_f32_16x16x32_bf16 v[32:35], a[16:19], a[212:215], v[32:35]
    v_mfma_f32_16x16x32_bf16 v[36:39], a[20:23], a[212:215], v[36:39]
    v_mfma_f32_16x16x32_bf16 v[40:43], a[24:27], a[212:215], v[40:43]
    global_load_dwordx4 v[96:99], v155, s[60:61] offset:0 sc1
    v_mfma_f32_16x16x32_bf16 v[44:47], a[28:31], a[212:215], v[44:47]
    s_waitcnt vmcnt(11)
    v_mfma_f32_16x16x32_bf16 v[32:35], a[32:35], a[216:219], v[32:35]
    s_waitcnt lgkmcnt(2)
    v_add_f32 v132, v132, v136
    v_mfma_f32_16x16x32_bf16 v[36:39], a[36:39], a[216:219], v[36:39]
    v_add_f32 v133, v133, v137
    v_add_f32 v134, v134, v138
    v_mfma_f32_16x16x32_bf16 v[40:43], a[40:43], a[216:219], v[40:43]
    v_add_f32 v135, v135, v139
    global_load_dwordx4 v[100:103], v155, s[60:61] offset:1024 sc1
    v_mfma_f32_16x16x32_bf16 v[44:47], a[44:47], a[216:219], v[44:47]
    s_waitcnt lgkmcnt(0)
    v_add_f32 v140, v140, v144
    s_waitcnt vmcnt(11)
    v_mfma_f32_16x16x32_bf16 v[32:35], a[48:51], a[220:223], v[32:35]
    v_add_f32 v141, v141, v145
    v_add_f32 v142, v142, v146
    v_mfma_f32_16x16x32_bf16 v[36:39], a[52:55], a[220:223], v[36:39]
    v_add_f32 v143, v143, v147
    v_add_f32 v132, v132, v140
    v_mfma_f32_16x16x32_bf16 v[40:43], a[56:59], a[220:223], v[40:43]
    global_load_dwordx4 v[104:107], v155, s[60:61] offset:2048 sc1
    v_mfma_f32_16x16x32_bf16 v[44:47], a[60:63], a[220:223], v[44:47]
    v_add_f32 v133, v133, v141
    v_add_f32 v134, v134, v142
    s_waitcnt vmcnt(11)
    v_mfma_f32_16x16x32_bf16 v[32:35], a[64:67], a[224:227], v[32:35]
    v_add_f32 v135, v135, v143
    v_cvt_pk_bf16_f32 v16, v132, v133
    v_mfma_f32_16x16x32_bf16 v[36:39], a[68:71], a[224:227], v[36:39]
    v_cvt_pk_bf16_f32 v17, v134, v135
    v_lshlrev_b32 v64, 16, v12
    v_mfma_f32_16x16x32_bf16 v[40:43], a[72:75], a[224:227], v[40:43]
    global_load_dwordx4 v[108:111], v155, s[60:61] offset:3072 sc1
    v_add_u32 v155, 4096, v155
    v_mfma_f32_16x16x32_bf16 v[44:47], a[76:79], a[224:227], v[44:47]
    v_and_b32 v65, s76, v12
    v_lshlrev_b32 v66, 16, v13
    s_waitcnt vmcnt(11)
    v_mfma_f32_16x16x32_bf16 v[32:35], a[80:83], a[228:231], v[32:35]
    v_and_b32 v67, s76, v13
    v_mfma_f32_16x16x32_bf16 v[36:39], a[84:87], a[228:231], v[36:39]
    v_mfma_f32_16x16x32_bf16 v[40:43], a[88:91], a[228:231], v[40:43]
    global_load_dwordx4 v[112:115], v155, s[60:61] offset:0 sc1
    v_mfma_f32_16x16x32_bf16 v[44:47], a[92:95], a[228:231], v[44:47]
    global_load_dwordx4 v[116:119], v155, s[60:61] offset:1024 sc1
    s_waitcnt vmcnt(11)
    v_mfma_f32_16x16x32_bf16 v[32:35], a[96:99], a[232:235], v[32:35]
    global_load_dwordx4 v[120:123], v155, s[60:61] offset:2048 sc1
    v_mfma_f32_16x16x32_bf16 v[36:39], a[100:103], a[232:235], v[36:39]
    v_mfma_f32_16x16x32_bf16 v[40:43], a[104:107], a[232:235], v[40:43]
    v_mfma_f32_16x16x32_bf16 v[44:47], a[108:111], a[232:235], v[44:47]
    s_waitcnt vmcnt(11)
    v_mfma_f32_16x16x32_bf16 v[32:35], a[112:115], a[236:239], v[32:35]
    v_mfma_f32_16x16x32_bf16 v[36:39], a[116:119], a[236:239], v[36:39]
    global_load_dwordx4 a[240:243], v155, s[60:61] offset:3072 sc1
    v_add_u32 v155, 4096, v155
    v_mfma_f32_16x16x32_bf16 v[40:43], a[120:123], a[236:239], v[40:43]
    v_mfma_f32_16x16x32_bf16 v[44:47], a[124:127], a[236:239], v[44:47]
    s_nop 1
    s_waitcnt vmcnt(11)
    v_mfma_f32_16x16x32_bf16 v[48:51], v[160:163], v[80:83], v[48:51]
    v_mfma_f32_16x16x32_bf16 v[52:55], v[164:167], v[80:83], 0
    v_mfma_f32_16x16x32_bf16 v[56:59], v[168:171], v[80:83], 0
    global_load_dwordx4 a[244:247], v155, s[60:61] offset:0 sc1
    v_mfma_f32_16x16x32_bf16 v[60:63], v[172:175], v[80:83], 0
    s_waitcnt vmcnt(11)
    v_mfma_f32_16x16x32_bf16 v[48:51], v[176:179], v[84:87], v[48:51]
    v_mfma_f32_16x16x32_bf16 v[52:55], v[180:183], v[84:87], v[52:55]
    v_mfma_f32_16x16x32_bf16 v[56:59], v[184:187], v[84:87], v[56:59]
    v_mfma_f32_16x16x32_bf16 v[60:63], v[188:191], v[84:87], v[60:63]
    global_load_dwordx4 a[248:251], v155, s[60:61] offset:1024 sc1
    v_add_u32 v155, 1822720, v155
    s_waitcnt vmcnt(11)
    v_mfma_f32_16x16x32_bf16 v[48:51], v[192:195], v[88:91], v[48:51]
    v_cmp_ne_u32 vcc, s30, v128
    s_cbranch_vccnz slow_pok_37
pok_37:
    v_add_u32 v153, 0x20000, v153
    v_mfma_f32_16x16x32_bf16 v[52:55], v[196:199], v[88:91], v[52:55]
    v_cmp_u_f32 vcc, v32, v32
    s_cbranch_vccnz slow_pok_39
pok_39:
    v_mfma_f32_16x16x32_bf16 v[56:59], v[200:203], v[88:91], v[56:59]
    ds_write_b128 v6, v[32:35] offset:17408
    v_mfma_f32_16x16x32_bf16 v[60:63], v[204:207], v[88:91], v[60:63]
    global_load_dwordx4 a[128:131], v155, s[60:61] offset:0 sc1
    s_waitcnt vmcnt(11)
    v_mfma_f32_16x16x32_bf16 v[48:51], v[208:211], v[92:95], v[48:51]
    v_mfma_f32_16x16x32_bf16 v[52:55], v[212:215], v[92:95], v[52:55]
    v_mfma_f32_16x16x32_bf16 v[56:59], v[216:219], v[92:95], v[56:59]
    ds_write_b128 v0, v[36:39] offset:17408
    v_mfma_f32_16x16x32_bf16 v[60:63], v[220:223], v[92:95], v[60:63]
    global_load_dwordx4 a[132:135], v155, s[60:61] offset:1024 sc1
    s_waitcnt vmcnt(11)
    v_mfma_f32_16x16x32_bf16 v[48:51], v[224:227], v[96:99], v[48:51]
    v_mfma_f32_16x16x32_bf16 v[52:55], v[228:231], v[96:99], v[52:55]
    v_mfma_f32_16x16x32_bf16 v[56:59], v[232:235], v[96:99], v[56:59]
    ds_write_b128 v15, v[40:43] offset:17408
    v_mfma_f32_16x16x32_bf16 v[60:63], v[236:239], v[96:99], v[60:63]
    global_load_dwordx4 a[136:139], v155, s[60:61] offset:2048 sc1
    s_waitcnt vmcnt(11)
    v_mfma_f32_16x16x32_bf16 v[48:51], v[240:243], v[100:103], v[48:51]
    v_mfma_f32_16x16x32_bf16 v[52:55], v[244:247], v[100:103], v[52:55]
    v_mfma_f32_16x16x32_bf16 v[56:59], v[248:251], v[100:103], v[56:59]
    ds_write_b128 v156, v[44:47] offset:17408
    v_mfma_f32_16x16x32_bf16 v[60:63], v[252:255], v[100:103], v[60:63]
    global_load_dwordx4 a[140:143], v155, s[60:61] offset:3072 sc1
    v_add_u32 v155, 4096, v155
    s_waitcnt vmcnt(11)
    v_mfma_f32_16x16x32_bf16 v[48:51], a[0:3], v[104:107], v[48:51]
    v_mfma_f32_16x16x32_bf16 v[52:55], a[4:7], v[104:107], v[52:55]
    v_mfma_f32_16x16x32_bf16 v[56:59], a[8:11], v[104:107], v[56:59]
    v_mfma_f32_16x16x32_bf16 v[60:63], a[12:15], v[104:107], v[60:63]
    global_load_dwordx4 a[144:147], v155, s[60:61] offset:0 sc1
    s_waitcnt vmcnt(11)
    v_mfma_f32_16x16x32_bf16 v[48:51], a[16:19], v[108:111], v[48:51]
    s_waitcnt lgkmcnt(0)
    s_barrier
    v_mfma_f32_16x16x32_bf16 v[52:55], a[20:23], v[108:111], v[52:55]
    ds_read_b128 v[132:135], v7 offset:17408
    global_load_dwordx4 a[148:151], v155, s[60:61] offset:1024 sc1
    v_mfma_f32_16x16x32_bf16 v[56:59], a[24:27], v[108:111], v[56:59]
    ds_read_b128 v[136:139], v7 offset:21760
    ds_read_b128 v[140:143], v7 offset:26112
    v_mfma_f32_16x16x32_bf16 v[60:63], a[28:31], v[108:111], v[60:63]
    ds_read_b128 v[144:147], v7 offset:30464
    s_waitcnt vmcnt(11)
    v_mfma_f32_16x16x32_bf16 v[48:51], a[32:35], v[112:115], v[48:51]
    v_mfma_f32_16x16x32_bf16 v[52:55], a[36:39], v[112:115], v[52:55]
    v_mfma_f32_16x16x32_bf16 v[56:59], a[40:43], v[112:115], v[56:59]
    global_load_dwordx4 a[152:155], v155, s[60:61] offset:2048 sc1
    v_mfma_f32_16x16x32_bf16 v[60:63], a[44:47], v[112:115], v[60:63]
    s_waitcnt vmcnt(11)
    v_mfma_f32_16x16x32_bf16 v[48:51], a[48:51], v[116:119], v[48:51]
    v_mfma_f32_16x16x32_bf16 v[52:55], a[52:55], v[116:119], v[52:55]
    s_waitcnt lgkmcnt(2)
    v_add_f32 v132, v132, v136
    v_mfma_f32_16x16x32_bf16 v[56:59], a[56:59], v[116:119], v[56:59]
    v_add_f32 v133, v133, v137
    global_load_dwordx4 a[156:159], v155, s[60:61] offset:3072 sc1
    v_add_u32 v155, 4096, v155
    v_mfma_f32_16x16x32_bf16 v[60:63], a[60:63], v[116:119], v[60:63]
    v_add_f32 v134, v134, v138
    v_add_f32 v135, v135, v139
    s_waitcnt vmcnt(11)
    v_mfma_f32_16x16x32_bf16 v[48:51], a[64:67], v[120:123], v[48:51]
    s_waitcnt lgkmcnt(0)
    v_add_f32 v140, v140, v144
    v_mfma_f32_16x16x32_bf16 v[52:55], a[68:71], v[120:123], v[52:55]
    v_add_f32 v141, v141, v145
    v_add_f32 v142, v142, v146
    v_mfma_f32_16x16x32_bf16 v[56:59], a[72:75], v[120:123], v[56:59]
    global_load_dwordx4 a[160:163], v155, s[60:61] offset:0 sc1
    v_mfma_f32_16x16x32_bf16 v[60:63], a[76:79], v[120:123], v[60:63]
    v_add_f32 v143, v143, v147
    v_add_f32 v132, v132, v140
    s_waitcnt vmcnt(11)
    v_mfma_f32_16x16x32_bf16 v[48:51], a[80:83], a[240:243], v[48:51]
    v_add_f32 v133, v133, v141
    v_add_f32 v134, v134, v142
    v_mfma_f32_16x16x32_bf16 v[52:55], a[84:87], a[240:243], v[52:55]
    v_add_f32 v135, v135, v143
    v_cvt_pk_bf16_f32 v32, v132, v133
    v_mfma_f32_16x16x32_bf16 v[56:59], a[88:91], a[240:243], v[56:59]
    global_load_dwordx4 a[164:167], v155, s[60:61] offset:1024 sc1
    v_mfma_f32_16x16x32_bf16 v[60:63], a[92:95], a[240:243], v[60:63]
    v_cvt_pk_bf16_f32 v33, v134, v135
    s_waitcnt vmcnt(11)
    v_mfma_f32_16x16x32_bf16 v[48:51], a[96:99], a[244:247], v[48:51]
    v_mfma_f32_16x16x32_bf16 v[52:55], a[100:103], a[244:247], v[52:55]
    v_mfma_f32_16x16x32_bf16 v[56:59], a[104:107], a[244:247], v[56:59]
    v_mfma_f32_16x16x32_bf16 v[60:63], a[108:111], a[244:247], v[60:63]
    global_load_dwordx4 a[168:171], v155, s[60:61] offset:2048 sc1
    s_waitcnt vmcnt(11)
    v_mfma_f32_16x16x32_bf16 v[48:51], a[112:115], a[248:251], v[48:51]
    v_mfma_f32_16x16x32_bf16 v[52:55], a[116:119], a[248:251], v[52:55]
    v_mfma_f32_16x16x32_bf16 v[56:59], a[120:123], a[248:251], v[56:59]
    v_mfma_f32_16x16x32_bf16 v[60:63], a[124:127], a[248:251], v[60:63]
    global_load_dwordx4 a[172:175], v155, s[60:61] offset:3072 sc1
    v_add_u32 v155, 4096, v155
    s_nop 1
    s_waitcnt vmcnt(11)
    v_mfma_f32_16x16x32_bf16 v[64:67], v[160:163], a[128:131], v[64:67]
    v_mfma_f32_16x16x32_bf16 v[68:71], v[164:167], a[128:131], 0
    v_mfma_f32_16x16x32_bf16 v[72:75], v[168:171], a[128:131], 0
    v_mfma_f32_16x16x32_bf16 v[76:79], v[172:175], a[128:131], 0
    global_load_dwordx4 a[176:179], v155, s[60:61] offset:0 sc1
    s_waitcnt vmcnt(11)
    v_mfma_f32_16x16x32_bf16 v[64:67], v[176:179], a[132:135], v[64:67]
    v_mfma_f32_16x16x32_bf16 v[68:71], v[180:183], a[132:135], v[68:71]
    v_mfma_f32_16x16x32_bf16 v[72:75], v[184:187], a[132:135], v[72:75]
    v_mfma_f32_16x16x32_bf16 v[76:79], v[188:191], a[132:135], v[76:79]
    global_load_dwordx4 a[180:183], v155, s[60:61] offset:1024 sc1
    v_add_u32 v155, 1822720, v155
    s_waitcnt vmcnt(11)
    v_mfma_f32_16x16x32_bf16 v[64:67], v[192:195], a[136:139], v[64:67]
    s_or_b32 s49, s2, s3
    s_cbranch_scc1 st_41
    v_mov_b32 v14, 0
    s_mov_b64 exec, 1
    global_store_dword v14, v157, s[28:29] sc1
    s_mov_b64 exec, -1
st_41:
    v_mfma_f32_16x16x32_bf16 v[68:71], v[196:199], a[136:139], v[68:71]
    global_store_dwordx2 v8, v[16:17], s[24:25] sc1
    v_mfma_f32_16x16x32_bf16 v[72:75], v[200:203], a[136:139], v[72:75]
    v_add_u32 v8, 0x80000, v8
    global_store_dwordx2 v8, v[32:33], s[24:25] sc1
    v_mfma_f32_16x16x32_bf16 v[76:79], v[204:207], a[136:139], v[76:79]
    v_add_u32 v8, 0x80000, v8
    v_cmp_u_f32 vcc, v48, v48
    s_cbranch_vccnz slow_pok_42
pok_42:
    s_waitcnt vmcnt(12)
    v_mfma_f32_16x16x32_bf16 v[64:67], v[208:211], a[140:143], v[64:67]
    ds_write_b128 v6, v[48:51] offset:0
    v_mfma_f32_16x16x32_bf16 v[68:71], v[212:215], a[140:143], v[68:71]
    v_mfma_f32_16x16x32_bf16 v[72:75], v[216:219], a[140:143], v[72:75]
    v_mfma_f32_16x16x32_bf16 v[76:79], v[220:223], a[140:143], v[76:79]
    s_waitcnt vmcnt(11)
    v_mfma_f32_16x16x32_bf16 v[64:67], v[224:227], a[144:147], v[64:67]
    ds_write_b128 v0, v[52:55] offset:0
    v_mfma_f32_16x16x32_bf16 v[68:71], v[228:231], a[144:147], v[68:71]
    v_mfma_f32_16x16x32_bf16 v[72:75], v[232:235], a[144:147], v[72:75]
    v_mfma_f32_16x16x32_bf16 v[76:79], v[236:239], a[144:147], v[76:79]
    s_waitcnt vmcnt(10)
    v_mfma_f32_16x16x32_bf16 v[64:67], v[240:243], a[148:151], v[64:67]
    ds_write_b128 v15, v[56:59] offset:0
    v_mfma_f32_16x16x32_bf16 v[68:71], v[244:247], a[148:151], v[68:71]
    v_mfma_f32_16x16x32_bf16 v[72:75], v[248:251], a[148:151], v[72:75]
    v_mfma_f32_16x16x32_bf16 v[76:79], v[252:255], a[148:151], v[76:79]
    s_waitcnt vmcnt(9)
    v_mfma_f32_16x16x32_bf16 v[64:67], a[0:3], a[152:155], v[64:67]
    ds_write_b128 v156, v[60:63] offset:0
    v_mfma_f32_16x16x32_bf16 v[68:71], a[4:7], a[152:155], v[68:71]
    v_mfma_f32_16x16x32_bf16 v[72:75], a[8:11], a[152:155], v[72:75]
    v_mfma_f32_16x16x32_bf16 v[76:79], a[12:15], a[152:155], v[76:79]
    s_waitcnt vmcnt(8)
    v_mfma_f32_16x16x32_bf16 v[64:67], a[16:19], a[156:159], v[64:67]
    v_mfma_f32_16x16x32_bf16 v[68:71], a[20:23], a[156:159], v[68:71]
    v_mfma_f32_16x16x32_bf16 v[72:75], a[24:27], a[156:159], v[72:75]
    v_mfma_f32_16x16x32_bf16 v[76:79], a[28:31], a[156:159], v[76:79]
    s_waitcnt lgkmcnt(0)
    s_barrier
    s_waitcnt vmcnt(7)
    v_mfma_f32_16x16x32_bf16 v[64:67], a[32:35], a[160:163], v[64:67]
    ds_read_b128 v[132:135], v7 offset:0
    ds_read_b128 v[136:139], v7 offset:4352
    v_mfma_f32_16x16x32_bf16 v[68:71], a[36:39], a[160:163], v[68:71]
    ds_read_b128 v[140:143], v7 offset:8704
    ds_read_b128 v[144:147], v7 offset:13056
    v_mfma_f32_16x16x32_bf16 v[72:75], a[40:43], a[160:163], v[72:75]
    v_mfma_f32_16x16x32_bf16 v[76:79], a[44:47], a[160:163], v[76:79]
    s_waitcnt vmcnt(6)
    v_mfma_f32_16x16x32_bf16 v[64:67], a[48:51], a[164:167], v[64:67]
    v_mfma_f32_16x16x32_bf16 v[68:71], a[52:55], a[164:167], v[68:71]
    v_mfma_f32_16x16x32_bf16 v[72:75], a[56:59], a[164:167], v[72:75]
    v_mfma_f32_16x16x32_bf16 v[76:79], a[60:63], a[164:167], v[76:79]
    s_waitcnt lgkmcnt(2)
    v_add_f32 v132, v132, v136
    s_waitcnt vmcnt(5)
    v_mfma_f32_16x16x32_bf16 v[64:67], a[64:67], a[168:171], v[64:67]
    v_add_f32 v133, v133, v137
    v_add_f32 v134, v134, v138
    v_add_f32 v135, v135, v139
    s_waitcnt lgkmcnt(0)
    v_add_f32 v140, v140, v144
    v_add_f32 v141, v141, v145
    v_add_f32 v142, v142, v146
    v_add_f32 v143, v143, v147
    v_add_f32 v132, v132, v140
    v_add_f32 v133, v133, v141
    v_add_f32 v134, v134, v142
    v_add_f32 v135, v135, v143
    s_waitcnt vmcnt(4)
    v_mfma_f32_16x16x32_bf16 v[64:67], a[80:83], a[172:175], v[64:67]
    v_cvt_pk_bf16_f32 v48, v132, v133
    v_cvt_pk_bf16_f32 v49, v134, v135
    global_store_dwordx2 v8, v[48:49], s[24:25] sc1
    v_add_u32 v8, 0x80000, v8
    s_waitcnt vmcnt(4)
    v_mfma_f32_16x16x32_bf16 v[64:67], a[96:99], a[176:179], v[64:67]
    s_waitcnt vmcnt(3)
    v_mfma_f32_16x16x32_bf16 v[64:67], a[112:115], a[180:183], v[64:67]
    v_mfma_f32_16x16x32_bf16 v[68:71], a[68:71], a[168:171], v[68:71]
    v_mfma_f32_16x16x32_bf16 v[68:71], a[84:87], a[172:175], v[68:71]
    v_mfma_f32_16x16x32_bf16 v[68:71], a[100:103], a[176:179], v[68:71]
    v_mfma_f32_16x16x32_bf16 v[68:71], a[116:119], a[180:183], v[68:71]
    v_mfma_f32_16x16x32_bf16 v[72:75], a[72:75], a[168:171], v[72:75]
    v_mfma_f32_16x16x32_bf16 v[72:75], a[88:91], a[172:175], v[72:75]
    v_mfma_f32_16x16x32_bf16 v[72:75], a[104:107], a[176:179], v[72:75]
    v_mfma_f32_16x16x32_bf16 v[72:75], a[120:123], a[180:183], v[72:75]
    v_mfma_f32_16x16x32_bf16 v[76:79], a[76:79], a[168:171], v[76:79]
    v_mfma_f32_16x16x32_bf16 v[76:79], a[92:95], a[172:175], v[76:79]
    v_mfma_f32_16x16x32_bf16 v[76:79], a[108:111], a[176:179], v[76:79]
    v_mfma_f32_16x16x32_bf16 v[76:79], a[124:127], a[180:183], v[76:79]
    s_nop 0
    v_cmp_u_f32 vcc, v64, v64
    s_cbranch_vccnz slow_pok_44
pok_44:
    ds_write_b128 v6, v[64:67] offset:17408
    s_nop 0
    ds_write_b128 v0, v[68:71] offset:17408
    s_nop 0
    ds_write_b128 v15, v[72:75] offset:17408
    s_nop 0
    ds_write_b128 v156, v[76:79] offset:17408
    s_waitcnt lgkmcnt(0)
    s_barrier
    ds_read_b128 v[132:135], v7 offset:17408
    ds_read_b128 v[136:139], v7 offset:21760
    ds_read_b128 v[140:143], v7 offset:26112
    ds_read_b128 v[144:147], v7 offset:30464
    s_waitcnt lgkmcnt(2)
    v_add_f32 v132, v132, v136
    v_add_f32 v133, v133, v137
    v_add_f32 v134, v134, v138
    v_add_f32 v135, v135, v139
    s_waitcnt lgkmcnt(0)
    v_add_f32 v140, v140, v144
    v_add_f32 v141, v141, v145
    v_add_f32 v142, v142, v146
    v_add_f32 v143, v143, v147
    v_add_f32 v132, v132, v140
    v_add_f32 v133, v133, v141
    v_add_f32 v134, v134, v142
    v_add_f32 v135, v135, v143
    v_cvt_pk_bf16_f32 v64, v132, v133
    v_cvt_pk_bf16_f32 v65, v134, v135
    global_store_dwordx2 v8, v[64:65], s[24:25] sc1
    v_add_u32 v8, 0x80000, v8
g1done_12:
L_non:
    s_endpgm
L_idle:
    global_load_dword v248, v193, s[22:23]
    global_load_dword v249, v194, s[22:23]
    v_add_u32 v5, 14336, v150
    s_waitcnt vmcnt(9)
    s_barrier
    ds_read_b128 v[160:163], v9 offset:3584
    ds_read_b128 v[164:167], v9 offset:3072
    ds_read_b128 v[168:171], v9 offset:2560
    ds_read_b128 v[172:175], v9 offset:2048
    ds_read_b128 v[176:179], v9 offset:3648
    ds_read_b128 v[180:183], v9 offset:3136
    s_waitcnt lgkmcnt(5)
    v_mfma_f32_16x16x32_bf16 v[184:187], v[16:19], v[160:163], 0
    v_mfma_f32_16x16x32_bf16 v[188:191], v[20:23], v[160:163], 0
    v_mfma_f32_16x16x32_bf16 v[192:195], v[24:27], v[160:163], 0
    v_mfma_f32_16x16x32_bf16 v[196:199], v[28:31], v[160:163], 0
    ds_read_b128 v[160:163], v9 offset:2624
    s_waitcnt lgkmcnt(5)
    v_mfma_f32_16x16x32_bf16 v[188:191], v[16:19], v[164:167], v[188:191]
    v_mfma_f32_16x16x32_bf16 v[192:195], v[20:23], v[164:167], v[192:195]
    v_mfma_f32_16x16x32_bf16 v[196:199], v[24:27], v[164:167], v[196:199]
    ds_read_b128 v[164:167], v9 offset:2112
    s_waitcnt lgkmcnt(4)
    v_mfma_f32_16x16x32_bf16 v[192:195], v[16:19], v[168:171], v[192:195]
    s_waitcnt vmcnt(5)
    s_barrier
    ds_read_b128 v[240:243], v0 offset:0
    v_mfma_f32_16x16x32_bf16 v[196:199], v[20:23], v[168:171], v[196:199]
    ds_read_b128 v[216:219], v6 offset:0
    ds_read_b128 v[220:223], v6 offset:16
    ds_read_b128 v[168:171], v9 offset:3712
    v_mfma_f32_16x16x32_bf16 v[196:199], v[16:19], v[172:175], v[196:199]
    ds_read_b128 v[224:227], v6 offset:32
    ds_read_b128 v[228:231], v6 offset:48
    ds_read_b128 v[172:175], v9 offset:3200
    s_waitcnt lgkmcnt(9)
    v_mfma_f32_16x16x32_bf16 v[184:187], v[48:51], v[176:179], v[184:187]
    v_mfma_f32_16x16x32_bf16 v[188:191], v[52:55], v[176:179], v[188:191]
    v_mfma_f32_16x16x32_bf16 v[192:195], v[56:59], v[176:179], v[192:195]
    v_mfma_f32_16x16x32_bf16 v[196:199], v[60:63], v[176:179], v[196:199]
    s_waitcnt lgkmcnt(1)
    v_lshlrev_b32 v232, 16, v240
    ds_read_b128 v[176:179], v9 offset:2688
    v_mfma_f32_16x16x32_bf16 v[188:191], v[48:51], v[180:183], v[188:191]
    v_sub_f32 v216, v232, v216
    v_mul_f32 v216, v216, v224
    v_mfma_f32_16x16x32_bf16 v[192:195], v[52:55], v[180:183], v[192:195]
    s_cmp_lg_u32 s3, 0
    s_cbranch_scc1 pub_46
    s_lshr_b32 s57, s77, 11
    s_lshl_b32 s57, s57, 7
    s_add_u32 s57, s57, 65536
    v_mov_b32 v158, s57
    v_mov_b32 v159, 1
    s_mov_b64 exec, 1
    global_atomic_add v158, v159, s[28:29] sc1
    s_mov_b64 exec, -1
pub_46:
    v_and_b32 v233, s76, v240
    v_sub_f32 v217, v233, v217
    v_mfma_f32_16x16x32_bf16 v[196:199], v[56:59], v[180:183], v[196:199]
    v_mul_f32 v217, v217, v225
    v_lshlrev_b32 v234, 16, v241
    ds_read_b128 v[180:183], v9 offset:2176
    v_mfma_f32_16x16x32_bf16 v[192:195], v[48:51], v[160:163], v[192:195]
    v_sub_f32 v218, v234, v218
    v_mul_f32 v218, v218, v226
    v_mfma_f32_16x16x32_bf16 v[196:199], v[52:55], v[160:163], v[196:199]
    v_and_b32 v235, s76, v241
    v_sub_f32 v219, v235, v219
    ds_read_b128 v[160:163], v9 offset:3776
    v_mfma_f32_16x16x32_bf16 v[196:199], v[48:51], v[164:167], v[196:199]
    v_mul_f32 v219, v219, v227
    v_lshlrev_b32 v236, 16, v242
    ds_read_b128 v[164:167], v9 offset:3264
    s_waitcnt lgkmcnt(4)
    v_mfma_f32_16x16x32_bf16 v[184:187], v[80:83], v[168:171], v[184:187]
    v_sub_f32 v220, v236, v220
    v_mul_f32 v220, v220, v228
    v_mfma_f32_16x16x32_bf16 v[188:191], v[84:87], v[168:171], v[188:191]
    v_and_b32 v237, s76, v242
    v_sub_f32 v221, v237, v221
    v_mfma_f32_16x16x32_bf16 v[192:195], v[88:91], v[168:171], v[192:195]
    v_mul_f32 v221, v221, v229
    v_lshlrev_b32 v238, 16, v243
    v_mfma_f32_16x16x32_bf16 v[196:199], v[92:95], v[168:171], v[196:199]
    v_sub_f32 v222, v238, v222
    v_mul_f32 v222, v222, v230
    ds_read_b128 v[168:171], v9 offset:2752
    v_mfma_f32_16x16x32_bf16 v[188:191], v[80:83], v[172:175], v[188:191]
    v_and_b32 v239, s76, v243
    v_sub_f32 v223, v239, v223
    v_mfma_f32_16x16x32_bf16 v[192:195], v[84:87], v[172:175], v[192:195]
    v_mul_f32 v223, v223, v231
    v_mfma_f32_16x16x32_bf16 v[196:199], v[88:91], v[172:175], v[196:199]
    ds_read_b128 v[172:175], v9 offset:2240
    s_waitcnt lgkmcnt(4)
    v_mfma_f32_16x16x32_bf16 v[192:195], v[80:83], v[176:179], v[192:195]
    v_mfma_f32_16x16x32_bf16 v[196:199], v[84:87], v[176:179], v[196:199]
    ds_read_b128 v[176:179], v9 offset:3584
    v_mfma_f32_16x16x32_bf16 v[196:199], v[80:83], v[180:183], v[196:199]
    ds_read_b128 v[180:183], v9 offset:3072
    s_waitcnt lgkmcnt(4)
    v_mfma_f32_16x16x32_bf16 v[184:187], v[112:115], v[160:163], v[184:187]
    v_mfma_f32_16x16x32_bf16 v[188:191], v[116:119], v[160:163], v[188:191]
    v_mfma_f32_16x16x32_bf16 v[192:195], v[120:123], v[160:163], v[192:195]
    v_mfma_f32_16x16x32_bf16 v[196:199], v[124:127], v[160:163], v[196:199]
    ds_read_b128 v[160:163], v9 offset:2560
    v_mfma_f32_16x16x32_bf16 v[188:191], v[112:115], v[164:167], v[188:191]
    v_mfma_f32_16x16x32_bf16 v[192:195], v[116:119], v[164:167], v[192:195]
    v_mfma_f32_16x16x32_bf16 v[196:199], v[120:123], v[164:167], v[196:199]
    ds_read_b128 v[164:167], v9 offset:2048
    s_waitcnt lgkmcnt(4)
    v_mfma_f32_16x16x32_bf16 v[192:195], v[112:115], v[168:171], v[192:195]
    v_mfma_f32_16x16x32_bf16 v[196:199], v[116:119], v[168:171], v[196:199]
    ds_read_b128 v[168:171], v9 offset:1536
    v_mfma_f32_16x16x32_bf16 v[196:199], v[112:115], v[172:175], v[196:199]
    ds_read_b128 v[172:175], v9 offset:1024
    s_waitcnt lgkmcnt(4)
    v_mfma_f32_16x16x32_bf16 v[200:203], v[32:35], v[176:179], 0
    v_mfma_f32_16x16x32_bf16 v[204:207], v[36:39], v[176:179], 0
    ds_write_b128 v10, v[184:187] offset:0
    v_mfma_f32_16x16x32_bf16 v[208:211], v[40:43], v[176:179], 0
    v_mfma_f32_16x16x32_bf16 v[212:215], v[44:47], v[176:179], 0
    ds_read_b128 v[176:179], v9 offset:512
    v_mfma_f32_16x16x32_bf16 v[200:203], v[28:31], v[180:183], v[200:203]
    ds_write_b128 v10, v[188:191] offset:1024
    v_mfma_f32_16x16x32_bf16 v[204:207], v[32:35], v[180:183], v[204:207]
    v_mfma_f32_16x16x32_bf16 v[208:211], v[36:39], v[180:183], v[208:211]
    v_mfma_f32_16x16x32_bf16 v[212:215], v[40:43], v[180:183], v[212:215]
    ds_write_b128 v10, v[192:195] offset:2048
    ds_read_b128 v[180:183], v9 offset:0
    s_waitcnt lgkmcnt(7)
    v_mfma_f32_16x16x32_bf16 v[200:203], v[24:27], v[160:163], v[200:203]
    v_mfma_f32_16x16x32_bf16 v[204:207], v[28:31], v[160:163], v[204:207]
    v_mfma_f32_16x16x32_bf16 v[208:211], v[32:35], v[160:163], v[208:211]
    ds_write_b128 v10, v[196:199] offset:3072
    v_mfma_f32_16x16x32_bf16 v[212:215], v[36:39], v[160:163], v[212:215]
    ds_read_b128 v[160:163], v9 offset:3648
    v_mfma_f32_16x16x32_bf16 v[200:203], v[20:23], v[164:167], v[200:203]
    v_mfma_f32_16x16x32_bf16 v[204:207], v[24:27], v[164:167], v[204:207]
    v_mfma_f32_16x16x32_bf16 v[208:211], v[28:31], v[164:167], v[208:211]
    v_mfma_f32_16x16x32_bf16 v[212:215], v[32:35], v[164:167], v[212:215]
    ds_read_b128 v[164:167], v9 offset:3136
    s_waitcnt lgkmcnt(8)
    v_mfma_f32_16x16x32_bf16 v[200:203], v[16:19], v[168:171], v[200:203]
    v_mfma_f32_16x16x32_bf16 v[204:207], v[20:23], v[168:171], v[204:207]
    s_waitcnt lgkmcnt(2)
    s_waitcnt vmcnt(2)
    s_barrier
    ds_read_b128 v[184:187], v11 offset:0
    ds_read_b128 v[188:191], v11 offset:4096
    ds_read_b128 v[192:195], v14 offset:0
    v_mfma_f32_16x16x32_bf16 v[208:211], v[24:27], v[168:171], v[208:211]
    ds_read_b128 v[196:199], v14 offset:4096
    v_mfma_f32_16x16x32_bf16 v[212:215], v[28:31], v[168:171], v[212:215]
    ds_read_b128 v[168:171], v9 offset:2624
    v_mfma_f32_16x16x32_bf16 v[204:207], v[16:19], v[172:175], v[204:207]
    v_mfma_f32_16x16x32_bf16 v[208:211], v[20:23], v[172:175], v[208:211]
    s_waitcnt lgkmcnt(3)
    v_add_f32 v184, v184, v188
    v_add_f32 v185, v185, v189
    v_mfma_f32_16x16x32_bf16 v[212:215], v[24:27], v[172:175], v[212:215]
    v_add_f32 v186, v186, v190
    v_add_f32 v187, v187, v191
    v_fmac_f32 v232, v216, v184
    v_fmac_f32 v233, v217, v185
    ds_read_b128 v[172:175], v9 offset:2112
    v_mfma_f32_16x16x32_bf16 v[208:211], v[16:19], v[176:179], v[208:211]
    v_fmac_f32 v234, v218, v186
    v_fmac_f32 v235, v219, v187
    v_cvt_pk_bf16_f32 v244, v232, v233
    v_cvt_pk_bf16_f32 v245, v234, v235
    v_mfma_f32_16x16x32_bf16 v[212:215], v[20:23], v[176:179], v[212:215]
    s_waitcnt lgkmcnt(2)
    v_add_f32 v192, v192, v196
    v_add_f32 v193, v193, v197
    v_add_f32 v194, v194, v198
    ds_read_b128 v[176:179], v9 offset:1600
    v_mfma_f32_16x16x32_bf16 v[212:215], v[16:19], v[180:183], v[212:215]
    v_add_f32 v195, v195, v199
    v_fmac_f32 v236, v220, v192
    v_fmac_f32 v237, v221, v193
    v_fmac_f32 v238, v222, v194
    ds_read_b128 v[180:183], v9 offset:1088
    v_mfma_f32_16x16x32_bf16 v[200:203], v[64:67], v[160:163], v[200:203]
    v_fmac_f32 v239, v223, v195
    v_cvt_pk_bf16_f32 v246, v236, v237
    v_cvt_pk_bf16_f32 v247, v238, v239
    global_store_dwordx4 v12, v[244:247], s[58:59] sc1
    v_mfma_f32_16x16x32_bf16 v[204:207], v[68:71], v[160:163], v[204:207]
    v_add_u32 v12, 0x100000, v12
    v_mfma_f32_16x16x32_bf16 v[208:211], v[72:75], v[160:163], v[208:211]
    ds_read_b128 v[240:243], v0 offset:2048
    v_mfma_f32_16x16x32_bf16 v[212:215], v[76:79], v[160:163], v[212:215]
    ds_read_b128 v[216:219], v6 offset:8192
    ds_read_b128 v[160:163], v9 offset:576
    v_mfma_f32_16x16x32_bf16 v[200:203], v[60:63], v[164:167], v[200:203]
    ds_read_b128 v[220:223], v6 offset:8208
    v_mfma_f32_16x16x32_bf16 v[204:207], v[64:67], v[164:167], v[204:207]
    ds_read_b128 v[224:227], v6 offset:8224
    v_mfma_f32_16x16x32_bf16 v[208:211], v[68:71], v[164:167], v[208:211]
    ds_read_b128 v[228:231], v6 offset:8240
    v_mfma_f32_16x16x32_bf16 v[212:215], v[72:75], v[164:167], v[212:215]
    ds_read_b128 v[164:167], v9 offset:64
    s_waitcnt lgkmcnt(9)
    v_mfma_f32_16x16x32_bf16 v[200:203], v[56:59], v[168:171], v[200:203]
    v_mfma_f32_16x16x32_bf16 v[204:207], v[60:63], v[168:171], v[204:207]
    v_mfma_f32_16x16x32_bf16 v[208:211], v[64:67], v[168:171], v[208:211]
    s_waitcnt lgkmcnt(1)
    v_mfma_f32_16x16x32_bf16 v[212:215], v[68:71], v[168:171], v[212:215]
    s_barrier
    ds_read_b128 v[168:171], v9 offset:3712
    v_mfma_f32_16x16x32_bf16 v[200:203], v[52:55], v[172:175], v[200:203]
    v_lshlrev_b32 v232, 16, v240
    v_sub_f32 v216, v232, v216
    v_mfma_f32_16x16x32_bf16 v[204:207], v[56:59], v[172:175], v[204:207]
    v_mul_f32 v216, v216, v224
    v_and_b32 v233, s76, v240
    v_mfma_f32_16x16x32_bf16 v[208:211], v[60:63], v[172:175], v[208:211]
    v_sub_f32 v217, v233, v217
    v_mul_f32 v217, v217, v225
    v_mfma_f32_16x16x32_bf16 v[212:215], v[64:67], v[172:175], v[212:215]
    v_lshlrev_b32 v234, 16, v241
    ds_read_b128 v[172:175], v9 offset:3200
    v_mfma_f32_16x16x32_bf16 v[200:203], v[48:51], v[176:179], v[200:203]
    v_sub_f32 v218, v234, v218
    v_mul_f32 v218, v218, v226
    v_mfma_f32_16x16x32_bf16 v[204:207], v[52:55], v[176:179], v[204:207]
    v_and_b32 v235, s76, v241
    v_sub_f32 v219, v235, v219
    v_mfma_f32_16x16x32_bf16 v[208:211], v[56:59], v[176:179], v[208:211]
    v_mul_f32 v219, v219, v227
    v_lshlrev_b32 v236, 16, v242
    v_mfma_f32_16x16x32_bf16 v[212:215], v[60:63], v[176:179], v[212:215]
    v_sub_f32 v220, v236, v220
    ds_read_b128 v[176:179], v9 offset:2688
    v_mfma_f32_16x16x32_bf16 v[204:207], v[48:51], v[180:183], v[204:207]
    v_mul_f32 v220, v220, v228
    v_and_b32 v237, s76, v242
    v_mfma_f32_16x16x32_bf16 v[208:211], v[52:55], v[180:183], v[208:211]
    v_sub_f32 v221, v237, v221
    v_mul_f32 v221, v221, v229
    v_mfma_f32_16x16x32_bf16 v[212:215], v[56:59], v[180:183], v[212:215]
    v_lshlrev_b32 v238, 16, v243
    ds_read_b128 v[180:183], v9 offset:2176
    s_waitcnt lgkmcnt(4)
    v_mfma_f32_16x16x32_bf16 v[208:211], v[48:51], v[160:163], v[208:211]
    global_load_dword v15, v13, s[28:29] sc1
    v_mfma_f32_16x16x32_bf16 v[212:215], v[52:55], v[160:163], v[212:215]
    v_sub_f32 v222, v238, v222
    ds_read_b128 v[160:163], v9 offset:1664
    v_mfma_f32_16x16x32_bf16 v[212:215], v[48:51], v[164:167], v[212:215]
    v_mul_f32 v222, v222, v230
    ds_read_b128 v[164:167], v9 offset:1152
    s_waitcnt lgkmcnt(4)
    v_mfma_f32_16x16x32_bf16 v[200:203], v[96:99], v[168:171], v[200:203]
    v_and_b32 v239, s76, v243
    v_sub_f32 v223, v239, v223
    v_mfma_f32_16x16x32_bf16 v[204:207], v[100:103], v[168:171], v[204:207]
    v_mul_f32 v223, v223, v231
    v_mfma_f32_16x16x32_bf16 v[208:211], v[104:107], v[168:171], v[208:211]
    v_mfma_f32_16x16x32_bf16 v[212:215], v[108:111], v[168:171], v[212:215]
    ds_read_b128 v[168:171], v9 offset:640
    v_mfma_f32_16x16x32_bf16 v[200:203], v[92:95], v[172:175], v[200:203]
    v_mfma_f32_16x16x32_bf16 v[204:207], v[96:99], v[172:175], v[204:207]
    v_mfma_f32_16x16x32_bf16 v[208:211], v[100:103], v[172:175], v[208:211]
    v_mfma_f32_16x16x32_bf16 v[212:215], v[104:107], v[172:175], v[212:215]
    ds_read_b128 v[172:175], v9 offset:128
    s_waitcnt lgkmcnt(4)
    v_mfma_f32_16x16x32_bf16 v[200:203], v[88:91], v[176:179], v[200:203]
    v_mfma_f32_16x16x32_bf16 v[204:207], v[92:95], v[176:179], v[204:207]
    v_mfma_f32_16x16x32_bf16 v[208:211], v[96:99], v[176:179], v[208:211]
    v_mfma_f32_16x16x32_bf16 v[212:215], v[100:103], v[176:179], v[212:215]
    ds_read_b128 v[176:179], v9 offset:3776
    v_mfma_f32_16x16x32_bf16 v[200:203], v[84:87], v[180:183], v[200:203]
    v_mfma_f32_16x16x32_bf16 v[204:207], v[88:91], v[180:183], v[204:207]
    v_mfma_f32_16x16x32_bf16 v[208:211], v[92:95], v[180:183], v[208:211]
    v_mfma_f32_16x16x32_bf16 v[212:215], v[96:99], v[180:183], v[212:215]
    ds_read_b128 v[180:183], v9 offset:3264
    s_waitcnt lgkmcnt(4)
    v_mfma_f32_16x16x32_bf16 v[200:203], v[80:83], v[160:163], v[200:203]
    v_mfma_f32_16x16x32_bf16 v[204:207], v[84:87], v[160:163], v[204:207]
    v_mfma_f32_16x16x32_bf16 v[208:211], v[88:91], v[160:163], v[208:211]
    v_mfma_f32_16x16x32_bf16 v[212:215], v[92:95], v[160:163], v[212:215]
    ds_read_b128 v[160:163], v9 offset:2752
    v_mfma_f32_16x16x32_bf16 v[204:207], v[80:83], v[164:167], v[204:207]
    v_mfma_f32_16x16x32_bf16 v[208:211], v[84:87], v[164:167], v[208:211]
    v_mfma_f32_16x16x32_bf16 v[212:215], v[88:91], v[164:167], v[212:215]
    ds_read_b128 v[164:167], v9 offset:2240
    s_waitcnt lgkmcnt(4)
    v_mfma_f32_16x16x32_bf16 v[208:211], v[80:83], v[168:171], v[208:211]
    v_mfma_f32_16x16x32_bf16 v[212:215], v[84:87], v[168:171], v[212:215]
    ds_read_b128 v[168:171], v9 offset:1728
    v_mfma_f32_16x16x32_bf16 v[212:215], v[80:83], v[172:175], v[212:215]
    ds_read_b128 v[172:175], v9 offset:1216
    s_waitcnt lgkmcnt(4)
    v_mfma_f32_16x16x32_bf16 v[200:203], v[128:131], v[176:179], v[200:203]
    v_mfma_f32_16x16x32_bf16 v[204:207], v[132:135], v[176:179], v[204:207]
    v_mfma_f32_16x16x32_bf16 v[208:211], v[136:139], v[176:179], v[208:211]
    v_mfma_f32_16x16x32_bf16 v[212:215], v[140:143], v[176:179], v[212:215]
    ds_read_b128 v[176:179], v9 offset:704
    v_mfma_f32_16x16x32_bf16 v[200:203], v[124:127], v[180:183], v[200:203]
    v_mfma_f32_16x16x32_bf16 v[204:207], v[128:131], v[180:183], v[204:207]
    v_mfma_f32_16x16x32_bf16 v[208:211], v[132:135], v[180:183], v[208:211]
    v_mfma_f32_16x16x32_bf16 v[212:215], v[136:139], v[180:183], v[212:215]
    ds_read_b128 v[180:183], v9 offset:192
    s_waitcnt lgkmcnt(4)
    v_mfma_f32_16x16x32_bf16 v[200:203], v[120:123], v[160:163], v[200:203]
    v_mfma_f32_16x16x32_bf16 v[204:207], v[124:127], v[160:163], v[204:207]
    v_mfma_f32_16x16x32_bf16 v[208:211], v[128:131], v[160:163], v[208:211]
    v_mfma_f32_16x16x32_bf16 v[212:215], v[132:135], v[160:163], v[212:215]
    s_waitcnt vmcnt(0)
    v_cmp_ne_u32 vcc, 16, v15
    s_cbranch_vccnz slow_pok_47
pok_47:
    v_mfma_f32_16x16x32_bf16 v[200:203], v[116:119], v[164:167], v[200:203]
    s_add_u32 m0, s73, 0
    s_nop 0
    buffer_load_dwordx4 v149, s[32:35], s66 offen offset:0 sc1 lds
    v_mfma_f32_16x16x32_bf16 v[204:207], v[120:123], v[164:167], v[204:207]
    v_mfma_f32_16x16x32_bf16 v[208:211], v[124:127], v[164:167], v[208:211]
    v_mfma_f32_16x16x32_bf16 v[212:215], v[128:131], v[164:167], v[212:215]
    buffer_load_dwordx4 v149, s[32:35], s66 offen offset:1024 sc1 lds
    s_waitcnt lgkmcnt(2)
    v_mfma_f32_16x16x32_bf16 v[200:203], v[112:115], v[168:171], v[200:203]
    v_mfma_f32_16x16x32_bf16 v[204:207], v[116:119], v[168:171], v[204:207]
    v_mfma_f32_16x16x32_bf16 v[208:211], v[120:123], v[168:171], v[208:211]
    buffer_load_dwordx4 v149, s[32:35], s67 offen offset:2048 sc1 lds
    v_mfma_f32_16x16x32_bf16 v[212:215], v[124:127], v[168:171], v[212:215]
    v_mfma_f32_16x16x32_bf16 v[204:207], v[112:115], v[172:175], v[204:207]
    v_mfma_f32_16x16x32_bf16 v[208:211], v[116:119], v[172:175], v[208:211]
    buffer_load_dwordx4 v149, s[32:35], s67 offen offset:3072 sc1 lds
    v_mfma_f32_16x16x32_bf16 v[212:215], v[120:123], v[172:175], v[212:215]
    s_waitcnt lgkmcnt(0)
    v_mfma_f32_16x16x32_bf16 v[208:211], v[112:115], v[176:179], v[208:211]
    v_mfma_f32_16x16x32_bf16 v[212:215], v[116:119], v[176:179], v[212:215]
    s_add_u32 m0, s73, 4096
    s_nop 0
    buffer_load_dwordx4 v149, s[32:35], s68 offen offset:0 sc1 lds
    v_mfma_f32_16x16x32_bf16 v[212:215], v[112:115], v[180:183], v[212:215]
    s_nop 7
    s_nop 3
    ds_write_b128 v10, v[200:203] offset:43008
    ds_write_b128 v10, v[204:207] offset:44032
    ds_write_b128 v10, v[208:211] offset:45056
    ds_write_b128 v10, v[212:215] offset:46080
    s_waitcnt lgkmcnt(0)
    s_barrier
    ds_read_b128 v[200:203], v11 offset:43008
    ds_read_b128 v[204:207], v11 offset:47104
    ds_read_b128 v[208:211], v14 offset:43008
    ds_read_b128 v[212:215], v14 offset:47104
    buffer_load_dwordx4 v149, s[32:35], s68 offen offset:1024 sc1 lds
    s_waitcnt lgkmcnt(2)
    buffer_load_dwordx4 v149, s[32:35], s69 offen offset:2048 sc1 lds
    v_add_f32 v200, v200, v204
    v_add_f32 v201, v201, v205
    v_add_f32 v202, v202, v206
    v_add_f32 v203, v203, v207
    v_fmac_f32 v232, v216, v200
    v_fmac_f32 v233, v217, v201
    v_fmac_f32 v234, v218, v202
    v_fmac_f32 v235, v219, v203
    v_cvt_pk_bf16_f32 v244, v232, v233
    v_cvt_pk_bf16_f32 v245, v234, v235
    buffer_load_dwordx4 v149, s[32:35], s69 offen offset:3072 sc1 lds
    v_add_u32 v149, s8, v149
    s_waitcnt lgkmcnt(0)
    v_add_f32 v208, v208, v212
    v_add_f32 v209, v209, v213
    v_add_f32 v210, v210, v214
    v_add_f32 v211, v211, v215
    v_fmac_f32 v236, v220, v208
    v_fmac_f32 v237, v221, v209
    v_fmac_f32 v238, v222, v210
    v_fmac_f32 v239, v223, v211
    v_cvt_pk_bf16_f32 v246, v236, v237
    v_cvt_pk_bf16_f32 v247, v238, v239
    global_store_dwordx4 v12, v[244:247], s[58:59] sc1
    v_add_u32 v12, 0x100000, v12
    v_add_u32 v13, 0x8000, v13
    v_add_u32 v129, 14336, v150
    s_lshl_b32 s49, s78, 12
    v_add_u32 v152, s49, v152
    v_add_u32 v16, s73, v1
    s_lshl_b32 s49, s3, 9
    s_add_u32 s49, s49, 147456
    v_lshl_add_u32 v17, v2, 3, s49
    v_and_b32 v18, 31, v2
    v_lshlrev_b32 v18, 3, v18
    v_add_u32 v18, 147456, v18
    v_mov_b32 v20, 0
    v_mov_b32 v21, 0
    s_waitcnt vmcnt(7)
    ds_read_b64_tr_b16 v[24:25], v16 offset:0
    ds_read_b64_tr_b16 v[26:27], v16 offset:256
    ds_read_b64_tr_b16 v[28:29], v16 offset:1024
    ds_read_b64_tr_b16 v[30:31], v16 offset:1280
    s_waitcnt vmcnt(5)
    ds_read_b64_tr_b16 v[32:33], v16 offset:2048
    ds_read_b64_tr_b16 v[34:35], v16 offset:2304
    ds_read_b64_tr_b16 v[36:37], v16 offset:3072
    ds_read_b64_tr_b16 v[38:39], v16 offset:3328
    s_waitcnt lgkmcnt(6)
    v_dot2c_f32_bf16 v20, s48, v24
    v_dot2c_f32_bf16 v21, v24, v24
    v_dot2c_f32_bf16 v20, s48, v25
    v_dot2c_f32_bf16 v21, v25, v25
    v_dot2c_f32_bf16 v20, s48, v26
    v_dot2c_f32_bf16 v21, v26, v26
    v_dot2c_f32_bf16 v20, s48, v27
    v_dot2c_f32_bf16 v21, v27, v27
    s_waitcnt lgkmcnt(4)
    v_dot2c_f32_bf16 v20, s48, v28
    v_dot2c_f32_bf16 v21, v28, v28
    v_dot2c_f32_bf16 v20, s48, v29
    v_dot2c_f32_bf16 v21, v29, v29
    v_dot2c_f32_bf16 v20, s48, v30
    v_dot2c_f32_bf16 v21, v30, v30
    v_dot2c_f32_bf16 v20, s48, v31
    v_dot2c_f32_bf16 v21, v31, v31
    s_waitcnt vmcnt(3)
    ds_read_b64_tr_b16 v[40:41], v16 offset:4096
    ds_read_b64_tr_b16 v[42:43], v16 offset:4352
    ds_read_b64_tr_b16 v[44:45], v16 offset:5120
    ds_read_b64_tr_b16 v[46:47], v16 offset:5376
    s_waitcnt lgkmcnt(6)
    v_dot2c_f32_bf16 v20, s48, v32
    v_dot2c_f32_bf16 v21, v32, v32
    v_dot2c_f32_bf16 v20, s48, v33
    v_dot2c_f32_bf16 v21, v33, v33
    v_dot2c_f32_bf16 v20, s48, v34
    v_dot2c_f32_bf16 v21, v34, v34
    v_dot2c_f32_bf16 v20, s48, v35
    v_dot2c_f32_bf16 v21, v35, v35
    s_waitcnt lgkmcnt(4)
    v_dot2c_f32_bf16 v20, s48, v36
    v_dot2c_f32_bf16 v21, v36, v36
    v_dot2c_f32_bf16 v20, s48, v37
    v_dot2c_f32_bf16 v21, v37, v37
    v_dot2c_f32_bf16 v20, s48, v38
    v_dot2c_f32_bf16 v21, v38, v38
    v_dot2c_f32_bf16 v20, s48, v39
    v_dot2c_f32_bf16 v21, v39, v39
    s_waitcnt vmcnt(1)
    ds_read_b64_tr_b16 v[48:49], v16 offset:6144
    ds_read_b64_tr_b16 v[50:51], v16 offset:6400
    ds_read_b64_tr_b16 v[52:53], v16 offset:7168
    ds_read_b64_tr_b16 v[54:55], v16 offset:7424
    s_waitcnt lgkmcnt(6)
    v_dot2c_f32_bf16 v20, s48, v40
    v_dot2c_f32_bf16 v21, v40, v40
    v_dot2c_f32_bf16 v20, s48, v41
    v_dot2c_f32_bf16 v21, v41, v41
    v_dot2c_f32_bf16 v20, s48, v42
    v_dot2c_f32_bf16 v21, v42, v42
    v_dot2c_f32_bf16 v20, s48, v43
    v_dot2c_f32_bf16 v21, v43, v43
    s_waitcnt lgkmcnt(4)
    v_dot2c_f32_bf16 v20, s48, v44
    v_dot2c_f32_bf16 v21, v44, v44
    v_dot2c_f32_bf16 v20, s48, v45
    v_dot2c_f32_bf16 v21, v45, v45
    v_dot2c_f32_bf16 v20, s48, v46
    v_dot2c_f32_bf16 v21, v46, v46
    v_dot2c_f32_bf16 v20, s48, v47
    v_dot2c_f32_bf16 v21, v47, v47
    s_waitcnt lgkmcnt(2)
    v_dot2c_f32_bf16 v20, s48, v48
    v_dot2c_f32_bf16 v21, v48, v48
    v_dot2c_f32_bf16 v20, s48, v49
    v_dot2c_f32_bf16 v21, v49, v49
    v_dot2c_f32_bf16 v20, s48, v50
    v_dot2c_f32_bf16 v21, v50, v50
    v_dot2c_f32_bf16 v20, s48, v51
    v_dot2c_f32_bf16 v21, v51, v51
    s_waitcnt lgkmcnt(0)
    v_dot2c_f32_bf16 v20, s48, v52
    v_dot2c_f32_bf16 v21, v52, v52
    v_dot2c_f32_bf16 v20, s48, v53
    v_dot2c_f32_bf16 v21, v53, v53
    v_dot2c_f32_bf16 v20, s48, v54
    v_dot2c_f32_bf16 v21, v54, v54
    v_dot2c_f32_bf16 v20, s48, v55
    v_dot2c_f32_bf16 v21, v55, v55
    s_nop 2
    v_cmp_u_f32 vcc, v21, v21
    s_cbranch_vccnz slow_pok_49
pok_49:
    s_nop 2
    ds_write_b64 v17, v[20:21] offset:0
    s_waitcnt vmcnt(0)
    s_waitcnt lgkmcnt(0)
    s_barrier
    ds_read_b64 v[56:57], v18 offset:0
    ds_read_b64 v[58:59], v18 offset:256
    ds_read_b64 v[60:61], v18 offset:512
    ds_read_b64 v[62:63], v18 offset:768
    ds_read_b64 v[64:65], v18 offset:1024
    ds_read_b64 v[66:67], v18 offset:1280
    ds_read_b64 v[68:69], v18 offset:1536
    ds_read_b64 v[70:71], v18 offset:1792
    s_cmp_lg_u32 s3, 0
    s_cbranch_scc1 pub_51
    s_lshr_b32 s57, s77, 11
    s_lshl_b32 s57, s57, 7
    s_add_u32 s57, s57, 98304
    v_mov_b32 v158, s57
    v_mov_b32 v159, 1
    s_mov_b64 exec, 1
    global_atomic_add v158, v159, s[28:29] sc1
    s_mov_b64 exec, -1
pub_51:
    s_waitcnt lgkmcnt(0)
    v_add_f32 v56, v56, v58
    v_add_f32 v57, v57, v59
    v_add_f32 v60, v60, v62
    v_add_f32 v61, v61, v63
    v_add_f32 v64, v64, v66
    v_add_f32 v65, v65, v67
    v_add_f32 v68, v68, v70
    v_add_f32 v69, v69, v71
    v_add_f32 v56, v56, v60
    v_add_f32 v57, v57, v61
    v_add_f32 v64, v64, v68
    v_add_f32 v65, v65, v69
    v_add_f32 v56, v56, v64
    v_add_f32 v57, v57, v65
    v_mul_f32 v56, 0x3b000000, v56
    v_mul_f32 v57, 0x3b000000, v57
    v_fma_f32 v57, -v56, v56, v57
    v_max_f32 v57, 0, v57
    v_cvt_pk_bf16_f32 v57, v57, v57
    v_lshlrev_b32 v57, 16, v57
    v_add_f32 v57, 0x3727c5ac, v57
    v_cvt_pk_bf16_f32 v57, v57, v57
    v_lshlrev_b32 v57, 16, v57
    v_sqrt_f32 v57, v57
    s_nop 0
    v_cvt_pk_bf16_f32 v59, -v56, v57
    v_mov_b32 v58, s30
    s_cmp_lg_u32 s3, 0
    s_cbranch_scc1 hs_52
    s_mov_b32 exec_hi, 0
    global_store_dwordx2 v152, v[58:59], s[28:29] sc1
    s_mov_b64 exec, -1
hs_52:
    v_add_u32 v152, 8192, v152
    s_add_u32 m0, s56, 8192
    s_xor_b32 s9, s10, 0
    buffer_load_dwordx4 v150, s[4:7], s9 offen offset:0 lds
    buffer_load_dwordx4 v150, s[12:15], s9 offen offset:1024 lds
    buffer_load_dwordx4 v129, s[4:7], s9 offen offset:2048 lds
    buffer_load_dwordx4 v129, s[12:15], s9 offen offset:3072 lds
    s_add_u32 m0, s56, 16384
    s_xor_b32 s9, s10, 32768
    buffer_load_dwordx4 v150, s[4:7], s9 offen offset:0 lds
    buffer_load_dwordx4 v150, s[12:15], s9 offen offset:1024 lds
    buffer_load_dwordx4 v129, s[4:7], s9 offen offset:2048 lds
    buffer_load_dwordx4 v129, s[12:15], s9 offen offset:3072 lds
    s_add_u32 m0, s56, 24576
    s_xor_b32 s9, s10, 65536
    buffer_load_dwordx4 v150, s[4:7], s9 offen offset:0 lds
    buffer_load_dwordx4 v150, s[12:15], s9 offen offset:1024 lds
    buffer_load_dwordx4 v129, s[4:7], s9 offen offset:2048 lds
    buffer_load_dwordx4 v129, s[12:15], s9 offen offset:3072 lds
    s_add_u32 m0, s56, 32768
    s_xor_b32 s9, s10, 98304
    buffer_load_dwordx4 v150, s[4:7], s9 offen offset:0 lds
    buffer_load_dwordx4 v150, s[12:15], s9 offen offset:1024 lds
    buffer_load_dwordx4 v129, s[4:7], s9 offen offset:2048 lds
    buffer_load_dwordx4 v129, s[12:15], s9 offen offset:3072 lds
    s_lshl_b32 s49, s70, 15
    s_lshl_b32 s50, s74, 12
    s_add_u32 s49, s49, s50
    s_lshl_b32 s50, s3, 10
    s_add_u32 s49, s49, s50
    v_lshl_add_u32 v5, v2, 4, s49
    s_lshl_b32 s46, s3, 12
    v_mul_u32_u24 v7, 272, v4
    v_lshl_add_u32 v7, v3, 4, v7
    s_mul_i32 s50, s3, 1088
    v_add_u32 v7, s50, v7
    v_mul_u32_u24 v14, 272, v3
    v_lshl_add_u32 v14, v4, 4, v14
    s_mul_i32 s50, s3, 4352
    v_add_u32 v14, s50, v14
    s_lshl_b32 s50, s3, 6
    v_add_u32 v6, s50, v14
    s_xor_b32 s49, s50, 64
    v_add_u32 v0, s49, v14
    s_xor_b32 s49, s50, 128
    v_add_u32 v15, s49, v14
    s_xor_b32 s49, s50, 192
    v_add_u32 v156, s49, v14
    v_lshlrev_b32 v9, 8, v4
    v_lshrrev_b32 v14, 2, v3
    v_lshl_add_u32 v9, v14, 6, v9
    v_and_b32 v14, 3, v3
    v_lshl_add_u32 v9, v14, 3, v9
    s_lshl_b32 s50, s71, 5
    s_add_u32 s50, s50, s46
    s_add_u32 s50, s50, 147456
    v_add_u32 v9, s50, v9
    v_lshlrev_b32 v8, 10, v4
    v_lshl_add_u32 v8, v3, 3, v8
    s_lshl_b32 s49, s70, 15
    s_lshl_b32 s50, s71, 14
    s_add_u32 s49, s49, s50
    s_lshl_b32 s50, s74, 7
    s_add_u32 s49, s49, s50
    s_add_u32 s49, s49, s46
    v_add_u32 v8, s49, v8
    s_sub_u32 s49, s73, s56
    v_add_u32 v4, s49, v151
    global_load_dword v128, v13, s[28:29] sc1
    s_waitcnt vmcnt(0)
    v_cmp_ne_u32 vcc, 16, v128
    s_cbranch_vccnz slow_pok_53
pok_53:
    s_add_u32 m0, s73, 32768
    s_nop 0
    buffer_load_dwordx4 v149, s[32:35], s66 offen offset:0 sc1 lds
    buffer_load_dwordx4 v149, s[32:35], s66 offen offset:1024 sc1 lds
    buffer_load_dwordx4 v149, s[32:35], s67 offen offset:2048 sc1 lds
    buffer_load_dwordx4 v149, s[32:35], s67 offen offset:3072 sc1 lds
    s_add_u32 m0, s73, 36864
    s_nop 0
    buffer_load_dwordx4 v149, s[32:35], s68 offen offset:0 sc1 lds
    buffer_load_dwordx4 v149, s[32:35], s68 offen offset:1024 sc1 lds
    buffer_load_dwordx4 v149, s[32:35], s69 offen offset:2048 sc1 lds
    buffer_load_dwordx4 v149, s[32:35], s69 offen offset:3072 sc1 lds
    v_add_u32 v149, s8, v149
    v_mov_b32 v20, 0
    v_mov_b32 v21, 0
    s_waitcnt vmcnt(6)
    ds_read_b64_tr_b16 v[24:25], v16 offset:32768
    ds_read_b64_tr_b16 v[26:27], v16 offset:33024
    ds_read_b64_tr_b16 v[28:29], v16 offset:33792
    ds_read_b64_tr_b16 v[30:31], v16 offset:34048
    s_waitcnt vmcnt(4)
    ds_read_b64_tr_b16 v[32:33], v16 offset:34816
    ds_read_b64_tr_b16 v[34:35], v16 offset:35072
    ds_read_b64_tr_b16 v[36:37], v16 offset:35840
    ds_read_b64_tr_b16 v[38:39], v16 offset:36096
    s_waitcnt lgkmcnt(6)
    v_dot2c_f32_bf16 v20, s48, v24
    v_dot2c_f32_bf16 v21, v24, v24
    v_dot2c_f32_bf16 v20, s48, v25
    v_dot2c_f32_bf16 v21, v25, v25
    v_dot2c_f32_bf16 v20, s48, v26
    v_dot2c_f32_bf16 v21, v26, v26
    v_dot2c_f32_bf16 v20, s48, v27
    v_dot2c_f32_bf16 v21, v27, v27
    s_waitcnt lgkmcnt(4)
    v_dot2c_f32_bf16 v20, s48, v28
    v_dot2c_f32_bf16 v21, v28, v28
    v_dot2c_f32_bf16 v20, s48, v29
    v_dot2c_f32_bf16 v21, v29, v29
    v_dot2c_f32_bf16 v20, s48, v30
    v_dot2c_f32_bf16 v21, v30, v30
    v_dot2c_f32_bf16 v20, s48, v31
    v_dot2c_f32_bf16 v21, v31, v31
    s_waitcnt vmcnt(2)
    ds_read_b64_tr_b16 v[40:41], v16 offset:36864
    ds_read_b64_tr_b16 v[42:43], v16 offset:37120
    ds_read_b64_tr_b16 v[44:45], v16 offset:37888
    ds_read_b64_tr_b16 v[46:47], v16 offset:38144
    s_waitcnt lgkmcnt(6)
    v_dot2c_f32_bf16 v20, s48, v32
    v_dot2c_f32_bf16 v21, v32, v32
    v_dot2c_f32_bf16 v20, s48, v33
    v_dot2c_f32_bf16 v21, v33, v33
    v_dot2c_f32_bf16 v20, s48, v34
    v_dot2c_f32_bf16 v21, v34, v34
    v_dot2c_f32_bf16 v20, s48, v35
    v_dot2c_f32_bf16 v21, v35, v35
    s_waitcnt lgkmcnt(4)
    v_dot2c_f32_bf16 v20, s48, v36
    v_dot2c_f32_bf16 v21, v36, v36
    v_dot2c_f32_bf16 v20, s48, v37
    v_dot2c_f32_bf16 v21, v37, v37
    v_dot2c_f32_bf16 v20, s48, v38
    v_dot2c_f32_bf16 v21, v38, v38
    v_dot2c_f32_bf16 v20, s48, v39
    v_dot2c_f32_bf16 v21, v39, v39
    s_waitcnt vmcnt(0)
    ds_read_b64_tr_b16 v[48:49], v16 offset:38912
    ds_read_b64_tr_b16 v[50:51], v16 offset:39168
    ds_read_b64_tr_b16 v[52:53], v16 offset:39936
    ds_read_b64_tr_b16 v[54:55], v16 offset:40192
    s_waitcnt lgkmcnt(6)
    v_dot2c_f32_bf16 v20, s48, v40
    v_dot2c_f32_bf16 v21, v40, v40
    v_dot2c_f32_bf16 v20, s48, v41
    v_dot2c_f32_bf16 v21, v41, v41
    v_dot2c_f32_bf16 v20, s48, v42
    v_dot2c_f32_bf16 v21, v42, v42
    v_dot2c_f32_bf16 v20, s48, v43
    v_dot2c_f32_bf16 v21, v43, v43
    s_waitcnt lgkmcnt(4)
    v_dot2c_f32_bf16 v20, s48, v44
    v_dot2c_f32_bf16 v21, v44, v44
    v_dot2c_f32_bf16 v20, s48, v45
    v_dot2c_f32_bf16 v21, v45, v45
    v_dot2c_f32_bf16 v20, s48, v46
    v_dot2c_f32_bf16 v21, v46, v46
    v_dot2c_f32_bf16 v20, s48, v47
    v_dot2c_f32_bf16 v21, v47, v47
    s_waitcnt lgkmcnt(2)
    v_dot2c_f32_bf16 v20, s48, v48
    v_dot2c_f32_bf16 v21, v48, v48
    v_dot2c_f32_bf16 v20, s48, v49
    v_dot2c_f32_bf16 v21, v49, v49
    v_dot2c_f32_bf16 v20, s48, v50
    v_dot2c_f32_bf16 v21, v50, v50
    v_dot2c_f32_bf16 v20, s48, v51
    v_dot2c_f32_bf16 v21, v51, v51
    s_waitcnt lgkmcnt(0)
    v_dot2c_f32_bf16 v20, s48, v52
    v_dot2c_f32_bf16 v21, v52, v52
    v_dot2c_f32_bf16 v20, s48, v53
    v_dot2c_f32_bf16 v21, v53, v53
    v_dot2c_f32_bf16 v20, s48, v54
    v_dot2c_f32_bf16 v21, v54, v54
    v_dot2c_f32_bf16 v20, s48, v55
    v_dot2c_f32_bf16 v21, v55, v55
    s_nop 2
    ds_write_b64 v17, v[20:21] offset:2048
    s_waitcnt lgkmcnt(0)
    s_barrier
    ds_read_b64 v[56:57], v18 offset:2048
    ds_read_b64 v[58:59], v18 offset:2304
    ds_read_b64 v[60:61], v18 offset:2560
    ds_read_b64 v[62:63], v18 offset:2816
    ds_read_b64 v[64:65], v18 offset:3072
    ds_read_b64 v[66:67], v18 offset:3328
    ds_read_b64 v[68:69], v18 offset:3584
    ds_read_b64 v[70:71], v18 offset:3840
    s_waitcnt lgkmcnt(0)
    v_add_f32 v56, v56, v58
    v_add_f32 v57, v57, v59
    v_add_f32 v60, v60, v62
    v_add_f32 v61, v61, v63
    v_add_f32 v64, v64, v66
    v_add_f32 v65, v65, v67
    v_add_f32 v68, v68, v70
    v_add_f32 v69, v69, v71
    v_add_f32 v56, v56, v60
    v_add_f32 v57, v57, v61
    v_add_f32 v64, v64, v68
    v_add_f32 v65, v65, v69
    v_add_f32 v56, v56, v64
    v_add_f32 v57, v57, v65
    v_mul_f32 v56, 0x3b000000, v56
    v_mul_f32 v57, 0x3b000000, v57
    v_fma_f32 v57, -v56, v56, v57
    v_max_f32 v57, 0, v57
    v_cvt_pk_bf16_f32 v57, v57, v57
    v_lshlrev_b32 v57, 16, v57
    v_add_f32 v57, 0x3727c5ac, v57
    v_cvt_pk_bf16_f32 v57, v57, v57
    v_lshlrev_b32 v57, 16, v57
    v_sqrt_f32 v57, v57
    s_nop 0
    v_cvt_pk_bf16_f32 v59, -v56, v57
    v_mov_b32 v58, s30
    s_cmp_lg_u32 s3, 0
    s_cbranch_scc1 hs_55
    s_mov_b32 exec_hi, 0
    global_store_dwordx2 v152, v[58:59], s[28:29] sc1
    s_mov_b64 exec, -1
hs_55:
    v_add_u32 v152, 8192, v152
    s_barrier
    s_add_u32 m0, s46, 147456
    s_nop 0
    global_load_lds_dwordx4 v5, s[58:59] offset:0 sc1
    v_add_u32 v5, 523264, v5
    global_load_lds_dwordx4 v5, s[58:59] offset:1024 sc1
    v_add_u32 v5, 523264, v5
    global_load_lds_dwordx4 v5, s[58:59] offset:2048 sc1
    v_add_u32 v5, 523264, v5
    global_load_lds_dwordx4 v5, s[58:59] offset:3072 sc1
    v_mov_b32 v149, v155
    s_add_u32 m0, s56, 0
    s_xor_b32 s9, s10, 131072
    buffer_load_dwordx4 v150, s[4:7], s9 offen offset:0 lds
    buffer_load_dwordx4 v150, s[12:15], s9 offen offset:1024 lds
    buffer_load_dwordx4 v129, s[4:7], s9 offen offset:2048 lds
    buffer_load_dwordx4 v129, s[12:15], s9 offen offset:3072 lds
    ds_read_b64_tr_b16 v[160:161], v151 offset:8192
    ds_read_b64_tr_b16 v[162:163], v151 offset:9216
    ds_read_b64_tr_b16 v[164:165], v151 offset:8224
    ds_read_b64_tr_b16 v[166:167], v151 offset:9248
    ds_read_b64_tr_b16 v[168:169], v151 offset:8704
    ds_read_b64_tr_b16 v[170:171], v151 offset:9728
    ds_read_b64_tr_b16 v[172:173], v151 offset:8736
    ds_read_b64_tr_b16 v[174:175], v151 offset:9760
    s_waitcnt lgkmcnt(0)
    s_add_u32 m0, s56, 8192
    s_xor_b32 s9, s10, 163840
    buffer_load_dwordx4 v150, s[4:7], s9 offen offset:0 lds
    buffer_load_dwordx4 v150, s[12:15], s9 offen offset:1024 lds
    buffer_load_dwordx4 v129, s[4:7], s9 offen offset:2048 lds
    buffer_load_dwordx4 v129, s[12:15], s9 offen offset:3072 lds
    ds_read_b64_tr_b16 v[176:177], v151 offset:16384
    ds_read_b64_tr_b16 v[178:179], v151 offset:17408
    ds_read_b64_tr_b16 v[180:181], v151 offset:16416
    ds_read_b64_tr_b16 v[182:183], v151 offset:17440
    ds_read_b64_tr_b16 v[184:185], v151 offset:16896
    ds_read_b64_tr_b16 v[186:187], v151 offset:17920
    ds_read_b64_tr_b16 v[188:189], v151 offset:16928
    ds_read_b64_tr_b16 v[190:191], v151 offset:17952
    s_waitcnt lgkmcnt(0)
    s_add_u32 m0, s56, 16384
    s_xor_b32 s9, s10, 196608
    buffer_load_dwordx4 v150, s[4:7], s9 offen offset:0 lds
    buffer_load_dwordx4 v150, s[12:15], s9 offen offset:1024 lds
    buffer_load_dwordx4 v129, s[4:7], s9 offen offset:2048 lds
    buffer_load_dwordx4 v129, s[12:15], s9 offen offset:3072 lds
    ds_read_b64_tr_b16 v[192:193], v151 offset:24576
    ds_read_b64_tr_b16 v[194:195], v151 offset:25600
    ds_read_b64_tr_b16 v[196:197], v151 offset:24608
    ds_read_b64_tr_b16 v[198:199], v151 offset:25632
    ds_read_b64_tr_b16 v[200:201], v151 offset:25088
    ds_read_b64_tr_b16 v[202:203], v151 offset:26112
    ds_read_b64_tr_b16 v[204:205], v151 offset:25120
    ds_read_b64_tr_b16 v[206:207], v151 offset:26144
    s_waitcnt lgkmcnt(0)
    s_add_u32 m0, s56, 24576
    s_xor_b32 s9, s10, 229376
    buffer_load_dwordx4 v150, s[4:7], s9 offen offset:0 lds
    buffer_load_dwordx4 v150, s[12:15], s9 offen offset:1024 lds
    buffer_load_dwordx4 v129, s[4:7], s9 offen offset:2048 lds
    buffer_load_dwordx4 v129, s[12:15], s9 offen offset:3072 lds
    ds_read_b64_tr_b16 v[208:209], v151 offset:32768
    ds_read_b64_tr_b16 v[210:211], v151 offset:33792
    ds_read_b64_tr_b16 v[212:213], v151 offset:32800
    ds_read_b64_tr_b16 v[214:215], v151 offset:33824
    ds_read_b64_tr_b16 v[216:217], v151 offset:33280
    ds_read_b64_tr_b16 v[218:219], v151 offset:34304
    ds_read_b64_tr_b16 v[220:221], v151 offset:33312
    ds_read_b64_tr_b16 v[222:223], v151 offset:34336
    s_waitcnt lgkmcnt(0)
    s_add_u32 m0, s56, 32768
    s_xor_b32 s9, s10, 262144
    buffer_load_dwordx4 v150, s[4:7], s9 offen offset:0 lds
    buffer_load_dwordx4 v150, s[12:15], s9 offen offset:1024 lds
    buffer_load_dwordx4 v129, s[4:7], s9 offen offset:2048 lds
    buffer_load_dwordx4 v129, s[12:15], s9 offen offset:3072 lds
    s_waitcnt vmcnt(16)
    ds_read_b64_tr_b16 v[224:225], v151 offset:0
    ds_read_b64_tr_b16 v[226:227], v151 offset:1024
    ds_read_b64_tr_b16 v[228:229], v151 offset:32
    ds_read_b64_tr_b16 v[230:231], v151 offset:1056
    ds_read_b64_tr_b16 v[232:233], v151 offset:512
    ds_read_b64_tr_b16 v[234:235], v151 offset:1536
    ds_read_b64_tr_b16 v[236:237], v151 offset:544
    ds_read_b64_tr_b16 v[238:239], v151 offset:1568
    s_waitcnt lgkmcnt(0)
    s_add_u32 m0, s56, 0
    s_xor_b32 s9, s10, 294912
    buffer_load_dwordx4 v150, s[4:7], s9 offen offset:0 lds
    buffer_load_dwordx4 v150, s[12:15], s9 offen offset:1024 lds
    buffer_load_dwordx4 v129, s[4:7], s9 offen offset:2048 lds
    buffer_load_dwordx4 v129, s[12:15], s9 offen offset:3072 lds
    s_waitcnt vmcnt(16)
    ds_read_b64_tr_b16 v[240:241], v151 offset:8192
    ds_read_b64_tr_b16 v[242:243], v151 offset:9216
    ds_read_b64_tr_b16 v[244:245], v151 offset:8224
    ds_read_b64_tr_b16 v[246:247], v151 offset:9248
    ds_read_b64_tr_b16 v[248:249], v151 offset:8704
    ds_read_b64_tr_b16 v[250:251], v151 offset:9728
    ds_read_b64_tr_b16 v[252:253], v151 offset:8736
    ds_read_b64_tr_b16 v[254:255], v151 offset:9760
    s_waitcnt lgkmcnt(0)
    s_add_u32 m0, s56, 8192
    s_xor_b32 s9, s10, 327680
    buffer_load_dwordx4 v150, s[4:7], s9 offen offset:0 lds
    buffer_load_dwordx4 v150, s[12:15], s9 offen offset:1024 lds
    buffer_load_dwordx4 v129, s[4:7], s9 offen offset:2048 lds
    buffer_load_dwordx4 v129, s[12:15], s9 offen offset:3072 lds
    global_load_dword v128, v153, s[28:29] sc1
    s_waitcnt vmcnt(17)
    ds_read_b64_tr_b16 a[0:1], v151 offset:16384
    ds_read_b64_tr_b16 a[2:3], v151 offset:17408
    ds_read_b64_tr_b16 a[4:5], v151 offset:16416
    ds_read_b64_tr_b16 a[6:7], v151 offset:17440
    ds_read_b64_tr_b16 a[8:9], v151 offset:16896
    ds_read_b64_tr_b16 a[10:11], v151 offset:17920
    ds_read_b64_tr_b16 a[12:13], v151 offset:16928
    ds_read_b64_tr_b16 a[14:15], v151 offset:17952
    s_waitcnt lgkmcnt(0)
    s_add_u32 m0, s56, 16384
    s_xor_b32 s9, s10, 360448
    buffer_load_dwordx4 v150, s[4:7], s9 offen offset:0 lds
    buffer_load_dwordx4 v150, s[12:15], s9 offen offset:1024 lds
    buffer_load_dwordx4 v129, s[4:7], s9 offen offset:2048 lds
    buffer_load_dwordx4 v129, s[12:15], s9 offen offset:3072 lds
    s_waitcnt vmcnt(17)
    ds_read_b64_tr_b16 a[16:17], v151 offset:24576
    ds_read_b64_tr_b16 a[18:19], v151 offset:25600
    ds_read_b64_tr_b16 a[20:21], v151 offset:24608
    ds_read_b64_tr_b16 a[22:23], v151 offset:25632
    ds_read_b64_tr_b16 a[24:25], v151 offset:25088
    ds_read_b64_tr_b16 a[26:27], v151 offset:26112
    ds_read_b64_tr_b16 a[28:29], v151 offset:25120
    ds_read_b64_tr_b16 a[30:31], v151 offset:26144
    s_waitcnt lgkmcnt(0)
    s_add_u32 m0, s56, 24576
    s_xor_b32 s9, s11, 393216
    buffer_load_dwordx4 v150, s[4:7], s9 offen offset:0 lds
    buffer_load_dwordx4 v150, s[12:15], s9 offen offset:1024 lds
    buffer_load_dwordx4 v129, s[4:7], s9 offen offset:2048 lds
    buffer_load_dwordx4 v129, s[12:15], s9 offen offset:3072 lds
    s_waitcnt vmcnt(17)
    ds_read_b64_tr_b16 a[32:33], v151 offset:32768
    ds_read_b64_tr_b16 a[34:35], v151 offset:33792
    ds_read_b64_tr_b16 a[36:37], v151 offset:32800
    ds_read_b64_tr_b16 a[38:39], v151 offset:33824
    ds_read_b64_tr_b16 a[40:41], v151 offset:33280
    ds_read_b64_tr_b16 a[42:43], v151 offset:34304
    ds_read_b64_tr_b16 a[44:45], v151 offset:33312
    ds_read_b64_tr_b16 a[46:47], v151 offset:34336
    s_waitcnt lgkmcnt(0)
    s_add_u32 m0, s56, 32768
    s_xor_b32 s9, s11, 425984
    buffer_load_dwordx4 v150, s[4:7], s9 offen offset:0 lds
    buffer_load_dwordx4 v150, s[12:15], s9 offen offset:1024 lds
    buffer_load_dwordx4 v129, s[4:7], s9 offen offset:2048 lds
    buffer_load_dwordx4 v129, s[12:15], s9 offen offset:3072 lds
    s_waitcnt vmcnt(17)
    ds_read_b64_tr_b16 a[48:49], v151 offset:0
    ds_read_b64_tr_b16 a[50:51], v151 offset:1024
    ds_read_b64_tr_b16 a[52:53], v151 offset:32
    ds_read_b64_tr_b16 a[54:55], v151 offset:1056
    ds_read_b64_tr_b16 a[56:57], v151 offset:512
    ds_read_b64_tr_b16 a[58:59], v151 offset:1536
    ds_read_b64_tr_b16 a[60:61], v151 offset:544
    ds_read_b64_tr_b16 a[62:63], v151 offset:1568
    s_waitcnt vmcnt(13)
    ds_read_b64_tr_b16 a[64:65], v151 offset:8192
    ds_read_b64_tr_b16 a[66:67], v151 offset:9216
    ds_read_b64_tr_b16 a[68:69], v151 offset:8224
    ds_read_b64_tr_b16 a[70:71], v151 offset:9248
    ds_read_b64_tr_b16 a[72:73], v151 offset:8704
    ds_read_b64_tr_b16 a[74:75], v151 offset:9728
    ds_read_b64_tr_b16 a[76:77], v151 offset:8736
    ds_read_b64_tr_b16 a[78:79], v151 offset:9760
    s_waitcnt vmcnt(12)
    v_cmp_ne_u32 vcc, s30, v128
    s_cbranch_vccnz slow_pok_56
pok_56:
    v_add_u32 v153, 0x20000, v153
    global_load_dwordx4 a[128:131], v155, s[60:61] offset:0 sc1
    s_waitcnt vmcnt(9)
    ds_read_b64_tr_b16 a[80:81], v151 offset:16384
    ds_read_b64_tr_b16 a[82:83], v151 offset:17408
    ds_read_b64_tr_b16 a[84:85], v151 offset:16416
    ds_read_b64_tr_b16 a[86:87], v151 offset:17440
    ds_read_b64_tr_b16 a[88:89], v151 offset:16896
    ds_read_b64_tr_b16 a[90:91], v151 offset:17920
    ds_read_b64_tr_b16 a[92:93], v151 offset:16928
    ds_read_b64_tr_b16 a[94:95], v151 offset:17952
    global_load_dwordx4 a[132:135], v155, s[60:61] offset:1024 sc1
    global_load_dword v128, v153, s[28:29] sc1
    global_load_dwordx4 a[136:139], v155, s[60:61] offset:2048 sc1
    global_load_dwordx4 a[140:143], v155, s[60:61] offset:3072 sc1
    v_add_u32 v155, 4096, v155
    s_waitcnt vmcnt(9)
    ds_read_b64_tr_b16 a[96:97], v151 offset:24576
    ds_read_b64_tr_b16 a[98:99], v151 offset:25600
    ds_read_b64_tr_b16 a[100:101], v151 offset:24608
    ds_read_b64_tr_b16 a[102:103], v151 offset:25632
    ds_read_b64_tr_b16 a[104:105], v151 offset:25088
    ds_read_b64_tr_b16 a[106:107], v151 offset:26112
    ds_read_b64_tr_b16 a[108:109], v151 offset:25120
    ds_read_b64_tr_b16 a[110:111], v151 offset:26144
    global_load_dwordx4 a[144:147], v155, s[60:61] offset:0 sc1
    global_load_dwordx4 a[148:151], v155, s[60:61] offset:1024 sc1
    global_load_dwordx4 a[152:155], v155, s[60:61] offset:2048 sc1
    global_load_dwordx4 a[156:159], v155, s[60:61] offset:3072 sc1
    v_add_u32 v155, 4096, v155
    s_waitcnt vmcnt(9)
    ds_read_b64_tr_b16 a[112:113], v151 offset:32768
    ds_read_b64_tr_b16 a[114:115], v151 offset:33792
    ds_read_b64_tr_b16 a[116:117], v151 offset:32800
    ds_read_b64_tr_b16 a[118:119], v151 offset:33824
    ds_read_b64_tr_b16 a[120:121], v151 offset:33280
    ds_read_b64_tr_b16 a[122:123], v151 offset:34304
    ds_read_b64_tr_b16 a[124:125], v151 offset:33312
    ds_read_b64_tr_b16 a[126:127], v151 offset:34336
    global_load_dwordx4 a[160:163], v155, s[60:61] offset:0 sc1
    global_load_dwordx4 a[164:167], v155, s[60:61] offset:1024 sc1
    global_load_dwordx4 a[168:171], v155, s[60:61] offset:2048 sc1
    global_load_dwordx4 a[172:175], v155, s[60:61] offset:3072 sc1
    v_add_u32 v155, 4096, v155
    ds_read_b64_tr_b16 v[158:159], v9 offset:0
    ds_read_b64_tr_b16 v[130:131], v9 offset:1024
    ds_read_b64_tr_b16 v[10:11], v9 offset:2048
    ds_read_b64_tr_b16 v[12:13], v9 offset:3072
    s_waitcnt lgkmcnt(0)
    v_lshlrev_b32 v16, 16, v158
    v_and_b32 v17, s76, v158
    v_lshlrev_b32 v18, 16, v159
    v_and_b32 v19, s76, v159
    s_nop 1
    s_nop 1
    s_waitcnt vmcnt(12)
    v_mfma_f32_16x16x32_bf16 v[16:19], v[160:163], a[128:131], v[16:19]
    v_lshlrev_b32 v32, 16, v130
    v_and_b32 v33, s76, v130
    v_mfma_f32_16x16x32_bf16 v[20:23], v[164:167], a[128:131], 0
    global_load_dwordx4 a[176:179], v155, s[60:61] offset:0 sc1
    v_mfma_f32_16x16x32_bf16 v[24:27], v[168:171], a[128:131], 0
    v_lshlrev_b32 v34, 16, v131
    v_and_b32 v35, s76, v131
    v_mfma_f32_16x16x32_bf16 v[28:31], v[172:175], a[128:131], 0
    v_lshlrev_b32 v48, 16, v10
    v_and_b32 v49, s76, v10
    s_waitcnt vmcnt(12)
    v_mfma_f32_16x16x32_bf16 v[16:19], v[176:179], a[132:135], v[16:19]
    v_lshlrev_b32 v50, 16, v11
    v_and_b32 v51, s76, v11
    v_mfma_f32_16x16x32_bf16 v[20:23], v[180:183], a[132:135], v[20:23]
    global_load_dwordx4 a[180:183], v155, s[60:61] offset:1024 sc1
    v_add_u32 v155, 1822720, v155
    v_mfma_f32_16x16x32_bf16 v[24:27], v[184:187], a[132:135], v[24:27]
    s_waitcnt vmcnt(12)
    v_cmp_ne_u32 vcc, s30, v128
    s_cbranch_vccnz slow_pok_58
pok_58:
    v_add_u32 v153, 0x20000, v153
    v_mfma_f32_16x16x32_bf16 v[28:31], v[188:191], a[132:135], v[28:31]
    s_waitcnt vmcnt(11)
    v_mfma_f32_16x16x32_bf16 v[16:19], v[192:195], a[136:139], v[16:19]
    v_mfma_f32_16x16x32_bf16 v[20:23], v[196:199], a[136:139], v[20:23]
    global_load_dwordx4 a[184:187], v155, s[60:61] offset:0 sc1
    v_mfma_f32_16x16x32_bf16 v[24:27], v[200:203], a[136:139], v[24:27]
    v_mfma_f32_16x16x32_bf16 v[28:31], v[204:207], a[136:139], v[28:31]
    s_waitcnt vmcnt(11)
    v_mfma_f32_16x16x32_bf16 v[16:19], v[208:211], a[140:143], v[16:19]
    v_mfma_f32_16x16x32_bf16 v[20:23], v[212:215], a[140:143], v[20:23]
    v_mfma_f32_16x16x32_bf16 v[24:27], v[216:219], a[140:143], v[24:27]
    global_load_dwordx4 a[188:191], v155, s[60:61] offset:1024 sc1
    v_mfma_f32_16x16x32_bf16 v[28:31], v[220:223], a[140:143], v[28:31]
    s_waitcnt vmcnt(11)
    v_mfma_f32_16x16x32_bf16 v[16:19], v[224:227], a[144:147], v[16:19]
    v_mfma_f32_16x16x32_bf16 v[20:23], v[228:231], a[144:147], v[20:23]
    v_mfma_f32_16x16x32_bf16 v[24:27], v[232:235], a[144:147], v[24:27]
    global_load_dword v128, v153, s[28:29] sc1
    v_mfma_f32_16x16x32_bf16 v[28:31], v[236:239], a[144:147], v[28:31]
    s_waitcnt vmcnt(11)
    v_mfma_f32_16x16x32_bf16 v[16:19], v[240:243], a[148:151], v[16:19]
    v_mfma_f32_16x16x32_bf16 v[20:23], v[244:247], a[148:151], v[20:23]
    v_mfma_f32_16x16x32_bf16 v[24:27], v[248:251], a[148:151], v[24:27]
    v_mfma_f32_16x16x32_bf16 v[28:31], v[252:255], a[148:151], v[28:31]
    global_load_dwordx4 a[192:195], v155, s[60:61] offset:2048 sc1
    s_waitcnt vmcnt(11)
    v_mfma_f32_16x16x32_bf16 v[16:19], a[0:3], a[152:155], v[16:19]
    v_mfma_f32_16x16x32_bf16 v[20:23], a[4:7], a[152:155], v[20:23]
    v_mfma_f32_16x16x32_bf16 v[24:27], a[8:11], a[152:155], v[24:27]
    v_mfma_f32_16x16x32_bf16 v[28:31], a[12:15], a[152:155], v[28:31]
    global_load_dwordx4 a[196:199], v155, s[60:61] offset:3072 sc1
    v_add_u32 v155, 4096, v155
    s_waitcnt vmcnt(11)
    v_mfma_f32_16x16x32_bf16 v[16:19], a[16:19], a[156:159], v[16:19]
    v_mfma_f32_16x16x32_bf16 v[20:23], a[20:23], a[156:159], v[20:23]
    v_mfma_f32_16x16x32_bf16 v[24:27], a[24:27], a[156:159], v[24:27]
    v_mfma_f32_16x16x32_bf16 v[28:31], a[28:31], a[156:159], v[28:31]
    global_load_dwordx4 a[200:203], v155, s[60:61] offset:0 sc1
    s_waitcnt vmcnt(11)
    v_mfma_f32_16x16x32_bf16 v[16:19], a[32:35], a[160:163], v[16:19]
    global_load_dwordx4 a[204:207], v155, s[60:61] offset:1024 sc1
    v_mfma_f32_16x16x32_bf16 v[20:23], a[36:39], a[160:163], v[20:23]
    v_mfma_f32_16x16x32_bf16 v[24:27], a[40:43], a[160:163], v[24:27]
    v_mfma_f32_16x16x32_bf16 v[28:31], a[44:47], a[160:163], v[28:31]
    s_waitcnt vmcnt(11)
    v_mfma_f32_16x16x32_bf16 v[16:19], a[48:51], a[164:167], v[16:19]
    v_mfma_f32_16x16x32_bf16 v[20:23], a[52:55], a[164:167], v[20:23]
    global_load_dwordx4 a[208:211], v155, s[60:61] offset:2048 sc1
    v_mfma_f32_16x16x32_bf16 v[24:27], a[56:59], a[164:167], v[24:27]
    v_mfma_f32_16x16x32_bf16 v[28:31], a[60:63], a[164:167], v[28:31]
    s_waitcnt vmcnt(11)
    v_mfma_f32_16x16x32_bf16 v[16:19], a[64:67], a[168:171], v[16:19]
    v_mfma_f32_16x16x32_bf16 v[20:23], a[68:71], a[168:171], v[20:23]
    v_mfma_f32_16x16x32_bf16 v[24:27], a[72:75], a[168:171], v[24:27]
    global_load_dwordx4 a[212:215], v155, s[60:61] offset:3072 sc1
    v_add_u32 v155, 4096, v155
    v_mfma_f32_16x16x32_bf16 v[28:31], a[76:79], a[168:171], v[28:31]
    s_waitcnt vmcnt(11)
    v_mfma_f32_16x16x32_bf16 v[16:19], a[80:83], a[172:175], v[16:19]
    v_mfma_f32_16x16x32_bf16 v[20:23], a[84:87], a[172:175], v[20:23]
    v_mfma_f32_16x16x32_bf16 v[24:27], a[88:91], a[172:175], v[24:27]
    v_mfma_f32_16x16x32_bf16 v[28:31], a[92:95], a[172:175], v[28:31]
    global_load_dwordx4 a[216:219], v155, s[60:61] offset:0 sc1
    s_waitcnt vmcnt(11)
    v_mfma_f32_16x16x32_bf16 v[16:19], a[96:99], a[176:179], v[16:19]
    v_mfma_f32_16x16x32_bf16 v[20:23], a[100:103], a[176:179], v[20:23]
    v_mfma_f32_16x16x32_bf16 v[24:27], a[104:107], a[176:179], v[24:27]
    v_mfma_f32_16x16x32_bf16 v[28:31], a[108:111], a[176:179], v[28:31]
    global_load_dwordx4 a[220:223], v155, s[60:61] offset:1024 sc1
    s_waitcnt vmcnt(11)
    v_mfma_f32_16x16x32_bf16 v[16:19], a[112:115], a[180:183], v[16:19]
    v_mfma_f32_16x16x32_bf16 v[20:23], a[116:119], a[180:183], v[20:23]
    v_mfma_f32_16x16x32_bf16 v[24:27], a[120:123], a[180:183], v[24:27]
    v_mfma_f32_16x16x32_bf16 v[28:31], a[124:127], a[180:183], v[28:31]
    global_load_dwordx4 a[224:227], v155, s[60:61] offset:2048 sc1
    s_nop 1
    s_waitcnt vmcnt(11)
    v_mfma_f32_16x16x32_bf16 v[32:35], v[160:163], a[184:187], v[32:35]
    v_mfma_f32_16x16x32_bf16 v[36:39], v[164:167], a[184:187], 0
    v_mfma_f32_16x16x32_bf16 v[40:43], v[168:171], a[184:187], 0
    v_mfma_f32_16x16x32_bf16 v[44:47], v[172:175], a[184:187], 0
    global_load_dwordx4 a[228:231], v155, s[60:61] offset:3072 sc1
    v_add_u32 v155, 4096, v155
    s_waitcnt vmcnt(11)
    v_mfma_f32_16x16x32_bf16 v[32:35], v[176:179], a[188:191], v[32:35]
    v_mfma_f32_16x16x32_bf16 v[36:39], v[180:183], a[188:191], v[36:39]
    v_mfma_f32_16x16x32_bf16 v[40:43], v[184:187], a[188:191], v[40:43]
    v_mfma_f32_16x16x32_bf16 v[44:47], v[188:191], a[188:191], v[44:47]
    global_load_dwordx4 a[232:235], v155, s[60:61] offset:0 sc1
    v_cmp_u_f32 vcc, v16, v16
    s_cbranch_vccnz slow_pok_60
pok_60:
    ds_write_b128 v6, v[16:19] offset:0
    global_load_dwordx4 a[236:239], v155, s[60:61] offset:1024 sc1
    v_add_u32 v155, 1822720, v155
    s_waitcnt vmcnt(12)
    v_cmp_ne_u32 vcc, s30, v128
    s_cbranch_vccnz slow_pok_62
pok_62:
    v_add_u32 v153, 0x20000, v153
    s_waitcnt vmcnt(11)
    v_mfma_f32_16x16x32_bf16 v[32:35], v[192:195], a[192:195], v[32:35]
    v_mfma_f32_16x16x32_bf16 v[36:39], v[196:199], a[192:195], v[36:39]
    ds_write_b128 v0, v[20:23] offset:0
    v_mfma_f32_16x16x32_bf16 v[40:43], v[200:203], a[192:195], v[40:43]
    global_load_dwordx4 v[80:83], v155, s[60:61] offset:0 sc1
    v_mfma_f32_16x16x32_bf16 v[44:47], v[204:207], a[192:195], v[44:47]
    s_waitcnt vmcnt(11)
    v_mfma_f32_16x16x32_bf16 v[32:35], v[208:211], a[196:199], v[32:35]
    v_mfma_f32_16x16x32_bf16 v[36:39], v[212:215], a[196:199], v[36:39]
    ds_write_b128 v15, v[24:27] offset:0
    v_mfma_f32_16x16x32_bf16 v[40:43], v[216:219], a[196:199], v[40:43]
    global_load_dwordx4 v[84:87], v155, s[60:61] offset:1024 sc1
    v_mfma_f32_16x16x32_bf16 v[44:47], v[220:223], a[196:199], v[44:47]
    s_waitcnt vmcnt(11)
    v_mfma_f32_16x16x32_bf16 v[32:35], v[224:227], a[200:203], v[32:35]
    ds_write_b128 v156, v[28:31] offset:0
    v_mfma_f32_16x16x32_bf16 v[36:39], v[228:231], a[200:203], v[36:39]
    v_mfma_f32_16x16x32_bf16 v[40:43], v[232:235], a[200:203], v[40:43]
    global_load_dword v128, v153, s[28:29] sc1
    v_mfma_f32_16x16x32_bf16 v[44:47], v[236:239], a[200:203], v[44:47]
    s_waitcnt vmcnt(11)
    v_mfma_f32_16x16x32_bf16 v[32:35], v[240:243], a[204:207], v[32:35]
    v_mfma_f32_16x16x32_bf16 v[36:39], v[244:247], a[204:207], v[36:39]
    v_mfma_f32_16x16x32_bf16 v[40:43], v[248:251], a[204:207], v[40:43]
    global_load_dwordx4 v[88:91], v155, s[60:61] offset:2048 sc1
    v_mfma_f32_16x16x32_bf16 v[44:47], v[252:255], a[204:207], v[44:47]
    s_waitcnt lgkmcnt(0)
    s_barrier
    s_waitcnt vmcnt(11)
    v_mfma_f32_16x16x32_bf16 v[32:35], a[0:3], a[208:211], v[32:35]
    ds_read_b128 v[132:135], v7 offset:0
    ds_read_b128 v[136:139], v7 offset:4352
    v_mfma_f32_16x16x32_bf16 v[36:39], a[4:7], a[208:211], v[36:39]
    global_load_dwordx4 v[92:95], v155, s[60:61] offset:3072 sc1
    v_add_u32 v155, 4096, v155
    v_mfma_f32_16x16x32_bf16 v[40:43], a[8:11], a[208:211], v[40:43]
    ds_read_b128 v[140:143], v7 offset:8704
    ds_read_b128 v[144:147], v7 offset:13056
    v_mfma_f32_16x16x32_bf16 v[44:47], a[12:15], a[208:211], v[44:47]
    s_waitcnt vmcnt(11)
    v_mfma_f32_16x16x32_bf16 v[32:35], a[16:19], a[212:215], v[32:35]
    v_mfma_f32_16x16x32_bf16 v[36:39], a[20:23], a[212:215], v[36:39]
    v_mfma_f32_16x16x32_bf16 v[40:43], a[24:27], a[212:215], v[40:43]
    global_load_dwordx4 v[96:99], v155, s[60:61] offset:0 sc1
    v_mfma_f32_16x16x32_bf16 v[44:47], a[28:31], a[212:215], v[44:47]
    s_waitcnt lgkmcnt(2)
    v_add_f32 v132, v132, v136
    v_add_f32 v133, v133, v137
    v_add_f32 v134, v134, v138
    v_add_f32 v135, v135, v139
    s_waitcnt lgkmcnt(0)
    s_waitcnt vmcnt(11)
    v_mfma_f32_16x16x32_bf16 v[32:35], a[32:35], a[216:219], v[32:35]
    v_add_f32 v140, v140, v144
    global_load_dwordx4 v[100:103], v155, s[60:61] offset:1024 sc1
    v_mfma_f32_16x16x32_bf16 v[36:39], a[36:39], a[216:219], v[36:39]
    v_add_f32 v141, v141, v145
    v_add_f32 v142, v142, v146
    v_mfma_f32_16x16x32_bf16 v[40:43], a[40:43], a[216:219], v[40:43]
    v_add_f32 v143, v143, v147
    v_add_f32 v132, v132, v140
    v_mfma_f32_16x16x32_bf16 v[44:47], a[44:47], a[216:219], v[44:47]
    v_add_f32 v133, v133, v141
    v_add_f32 v134, v134, v142
    s_waitcnt vmcnt(11)
    v_mfma_f32_16x16x32_bf16 v[32:35], a[48:51], a[220:223], v[32:35]
    global_load_dwordx4 v[104:107], v155, s[60:61] offset:2048 sc1
    v_mfma_f32_16x16x32_bf16 v[36:39], a[52:55], a[220:223], v[36:39]
    v_add_f32 v135, v135, v143
    v_cvt_pk_bf16_f32 v16, v132, v133
    v_mfma_f32_16x16x32_bf16 v[40:43], a[56:59], a[220:223], v[40:43]
    v_cvt_pk_bf16_f32 v17, v134, v135
    v_lshlrev_b32 v64, 16, v12
    v_mfma_f32_16x16x32_bf16 v[44:47], a[60:63], a[220:223], v[44:47]
    v_and_b32 v65, s76, v12
    v_lshlrev_b32 v66, 16, v13
    s_waitcnt vmcnt(11)
    v_mfma_f32_16x16x32_bf16 v[32:35], a[64:67], a[224:227], v[32:35]
    global_load_dwordx4 v[108:111], v155, s[60:61] offset:3072 sc1
    v_add_u32 v155, 4096, v155
    v_mfma_f32_16x16x32_bf16 v[36:39], a[68:71], a[224:227], v[36:39]
    v_and_b32 v67, s76, v13
    v_mfma_f32_16x16x32_bf16 v[40:43], a[72:75], a[224:227], v[40:43]
    v_mfma_f32_16x16x32_bf16 v[44:47], a[76:79], a[224:227], v[44:47]
    s_waitcnt vmcnt(11)
    v_mfma_f32_16x16x32_bf16 v[32:35], a[80:83], a[228:231], v[32:35]
    v_mfma_f32_16x16x32_bf16 v[36:39], a[84:87], a[228:231], v[36:39]
    global_load_dwordx4 v[112:115], v155, s[60:61] offset:0 sc1
    v_mfma_f32_16x16x32_bf16 v[40:43], a[88:91], a[228:231], v[40:43]
    v_mfma_f32_16x16x32_bf16 v[44:47], a[92:95], a[228:231], v[44:47]
    s_waitcnt vmcnt(11)
    v_mfma_f32_16x16x32_bf16 v[32:35], a[96:99], a[232:235], v[32:35]
    v_mfma_f32_16x16x32_bf16 v[36:39], a[100:103], a[232:235], v[36:39]
    v_mfma_f32_16x16x32_bf16 v[40:43], a[104:107], a[232:235], v[40:43]
    global_load_dwordx4 v[116:119], v155, s[60:61] offset:1024 sc1
    v_mfma_f32_16x16x32_bf16 v[44:47], a[108:111], a[232:235], v[44:47]
    s_waitcnt vmcnt(11)
    v_mfma_f32_16x16x32_bf16 v[32:35], a[112:115], a[236:239], v[32:35]
    v_mfma_f32_16x16x32_bf16 v[36:39], a[116:119], a[236:239], v[36:39]
    v_mfma_f32_16x16x32_bf16 v[40:43], a[120:123], a[236:239], v[40:43]
    v_mfma_f32_16x16x32_bf16 v[44:47], a[124:127], a[236:239], v[44:47]
    global_load_dwordx4 v[120:123], v155, s[60:61] offset:2048 sc1
    s_nop 1
    s_waitcnt vmcnt(11)
    v_mfma_f32_16x16x32_bf16 v[48:51], v[160:163], v[80:83], v[48:51]
    v_mfma_f32_16x16x32_bf16 v[52:55], v[164:167], v[80:83], 0
    v_mfma_f32_16x16x32_bf16 v[56:59], v[168:171], v[80:83], 0
    v_mfma_f32_16x16x32_bf16 v[60:63], v[172:175], v[80:83], 0
    global_load_dwordx4 a[240:243], v155, s[60:61] offset:3072 sc1
    v_add_u32 v155, 4096, v155
    s_waitcnt vmcnt(11)
    v_mfma_f32_16x16x32_bf16 v[48:51], v[176:179], v[84:87], v[48:51]
    v_mfma_f32_16x16x32_bf16 v[52:55], v[180:183], v[84:87], v[52:55]
    v_mfma_f32_16x16x32_bf16 v[56:59], v[184:187], v[84:87], v[56:59]
    v_mfma_f32_16x16x32_bf16 v[60:63], v[188:191], v[84:87], v[60:63]
    global_load_dwordx4 a[244:247], v155, s[60:61] offset:0 sc1
    v_cmp_u_f32 vcc, v32, v32
    s_cbranch_vccnz slow_pok_64
pok_64:
    ds_write_b128 v6, v[32:35] offset:17408
    global_load_dwordx4 a[248:251], v155, s[60:61] offset:1024 sc1
    v_add_u32 v155, 1822720, v155
    s_waitcnt vmcnt(12)
    v_cmp_ne_u32 vcc, s30, v128
    s_cbranch_vccnz slow_pok_66
pok_66:
    v_add_u32 v153, 0x20000, v153
    s_waitcnt vmcnt(11)
    v_mfma_f32_16x16x32_bf16 v[48:51], v[192:195], v[88:91], v[48:51]
    v_mfma_f32_16x16x32_bf16 v[52:55], v[196:199], v[88:91], v[52:55]
    ds_write_b128 v0, v[36:39] offset:17408
    v_mfma_f32_16x16x32_bf16 v[56:59], v[200:203], v[88:91], v[56:59]
    global_load_dwordx4 a[128:131], v155, s[60:61] offset:0 sc1
    v_mfma_f32_16x16x32_bf16 v[60:63], v[204:207], v[88:91], v[60:63]
    s_waitcnt vmcnt(11)
    v_mfma_f32_16x16x32_bf16 v[48:51], v[208:211], v[92:95], v[48:51]
    v_mfma_f32_16x16x32_bf16 v[52:55], v[212:215], v[92:95], v[52:55]
    ds_write_b128 v15, v[40:43] offset:17408
    v_mfma_f32_16x16x32_bf16 v[56:59], v[216:219], v[92:95], v[56:59]
    v_mfma_f32_16x16x32_bf16 v[60:63], v[220:223], v[92:95], v[60:63]
    global_load_dwordx4 a[132:135], v155, s[60:61] offset:1024 sc1
    s_waitcnt vmcnt(11)
    v_mfma_f32_16x16x32_bf16 v[48:51], v[224:227], v[96:99], v[48:51]
    ds_write_b128 v156, v[44:47] offset:17408
    v_mfma_f32_16x16x32_bf16 v[52:55], v[228:231], v[96:99], v[52:55]
    v_mfma_f32_16x16x32_bf16 v[56:59], v[232:235], v[96:99], v[56:59]
    v_mfma_f32_16x16x32_bf16 v[60:63], v[236:239], v[96:99], v[60:63]
    global_load_dwordx4 a[136:139], v155, s[60:61] offset:2048 sc1
    s_waitcnt vmcnt(11)
    v_mfma_f32_16x16x32_bf16 v[48:51], v[240:243], v[100:103], v[48:51]
    v_mfma_f32_16x16x32_bf16 v[52:55], v[244:247], v[100:103], v[52:55]
    v_mfma_f32_16x16x32_bf16 v[56:59], v[248:251], v[100:103], v[56:59]
    v_mfma_f32_16x16x32_bf16 v[60:63], v[252:255], v[100:103], v[60:63]
    global_load_dwordx4 a[140:143], v155, s[60:61] offset:3072 sc1
    v_add_u32 v155, 4096, v155
    s_waitcnt vmcnt(11)
    v_mfma_f32_16x16x32_bf16 v[48:51], a[0:3], v[104:107], v[48:51]
    s_waitcnt lgkmcnt(0)
    s_barrier
    v_mfma_f32_16x16x32_bf16 v[52:55], a[4:7], v[104:107], v[52:55]
    ds_read_b128 v[132:135], v7 offset:17408
    ds_read_b128 v[136:139], v7 offset:21760
    v_mfma_f32_16x16x32_bf16 v[56:59], a[8:11], v[104:107], v[56:59]
    global_load_dwordx4 a[144:147], v155, s[60:61] offset:0 sc1
    v_mfma_f32_16x16x32_bf16 v[60:63], a[12:15], v[104:107], v[60:63]
    ds_read_b128 v[140:143], v7 offset:26112
    ds_read_b128 v[144:147], v7 offset:30464
    s_waitcnt vmcnt(11)
    v_mfma_f32_16x16x32_bf16 v[48:51], a[16:19], v[108:111], v[48:51]
    v_mfma_f32_16x16x32_bf16 v[52:55], a[20:23], v[108:111], v[52:55]
    v_mfma_f32_16x16x32_bf16 v[56:59], a[24:27], v[108:111], v[56:59]
    global_load_dwordx4 a[148:151], v155, s[60:61] offset:1024 sc1
    v_mfma_f32_16x16x32_bf16 v[60:63], a[28:31], v[108:111], v[60:63]
    s_waitcnt vmcnt(11)
    v_mfma_f32_16x16x32_bf16 v[48:51], a[32:35], v[112:115], v[48:51]
    s_waitcnt lgkmcnt(2)
    v_add_f32 v132, v132, v136
    v_mfma_f32_16x16x32_bf16 v[52:55], a[36:39], v[112:115], v[52:55]
    v_add_f32 v133, v133, v137
    v_add_f32 v134, v134, v138
    v_mfma_f32_16x16x32_bf16 v[56:59], a[40:43], v[112:115], v[56:59]
    v_add_f32 v135, v135, v139
    global_load_dwordx4 a[152:155], v155, s[60:61] offset:2048 sc1
    v_mfma_f32_16x16x32_bf16 v[60:63], a[44:47], v[112:115], v[60:63]
    s_waitcnt lgkmcnt(0)
    v_add_f32 v140, v140, v144
    s_waitcnt vmcnt(11)
    v_mfma_f32_16x16x32_bf16 v[48:51], a[48:51], v[116:119], v[48:51]
    v_add_f32 v141, v141, v145
    v_add_f32 v142, v142, v146
    v_mfma_f32_16x16x32_bf16 v[52:55], a[52:55], v[116:119], v[52:55]
    v_add_f32 v143, v143, v147
    v_add_f32 v132, v132, v140
    v_mfma_f32_16x16x32_bf16 v[56:59], a[56:59], v[116:119], v[56:59]
    global_load_dwordx4 a[156:159], v155, s[60:61] offset:3072 sc1
    v_add_u32 v155, 4096, v155
    v_mfma_f32_16x16x32_bf16 v[60:63], a[60:63], v[116:119], v[60:63]
    v_add_f32 v133, v133, v141
    v_add_f32 v134, v134, v142
    v_add_f32 v135, v135, v143
    v_cvt_pk_bf16_f32 v32, v132, v133
    s_waitcnt vmcnt(11)
    v_mfma_f32_16x16x32_bf16 v[48:51], a[64:67], v[120:123], v[48:51]
    v_cvt_pk_bf16_f32 v33, v134, v135
    v_mfma_f32_16x16x32_bf16 v[52:55], a[68:71], v[120:123], v[52:55]
    v_mfma_f32_16x16x32_bf16 v[56:59], a[72:75], v[120:123], v[56:59]
    global_load_dwordx4 a[160:163], v155, s[60:61] offset:0 sc1
    v_mfma_f32_16x16x32_bf16 v[60:63], a[76:79], v[120:123], v[60:63]
    s_waitcnt vmcnt(11)
    v_mfma_f32_16x16x32_bf16 v[48:51], a[80:83], a[240:243], v[48:51]
    v_mfma_f32_16x16x32_bf16 v[52:55], a[84:87], a[240:243], v[52:55]
    v_mfma_f32_16x16x32_bf16 v[56:59], a[88:91], a[240:243], v[56:59]
    v_mfma_f32_16x16x32_bf16 v[60:63], a[92:95], a[240:243], v[60:63]
    global_load_dwordx4 a[164:167], v155, s[60:61] offset:1024 sc1
    s_waitcnt vmcnt(11)
    v_mfma_f32_16x16x32_bf16 v[48:51], a[96:99], a[244:247], v[48:51]
    v_mfma_f32_16x16x32_bf16 v[52:55], a[100:103], a[244:247], v[52:55]
    v_mfma_f32_16x16x32_bf16 v[56:59], a[104:107], a[244:247], v[56:59]
    v_mfma_f32_16x16x32_bf16 v[60:63], a[108:111], a[244:247], v[60:63]
    global_load_dwordx4 a[168:171], v155, s[60:61] offset:2048 sc1
    s_waitcnt vmcnt(11)
    v_mfma_f32_16x16x32_bf16 v[48:51], a[112:115], a[248:251], v[48:51]
    v_mfma_f32_16x16x32_bf16 v[52:55], a[116:119], a[248:251], v[52:55]
    v_mfma_f32_16x16x32_bf16 v[56:59], a[120:123], a[248:251], v[56:59]
    v_mfma_f32_16x16x32_bf16 v[60:63], a[124:127], a[248:251], v[60:63]
    global_load_dwordx4 a[172:175], v155, s[60:61] offset:3072 sc1
    v_add_u32 v155, 4096, v155
    s_nop 1
    s_waitcnt vmcnt(11)
    v_mfma_f32_16x16x32_bf16 v[64:67], v[160:163], a[128:131], v[64:67]
    v_mfma_f32_16x16x32_bf16 v[68:71], v[164:167], a[128:131], 0
    v_mfma_f32_16x16x32_bf16 v[72:75], v[168:171], a[128:131], 0
    v_mfma_f32_16x16x32_bf16 v[76:79], v[172:175], a[128:131], 0
    global_load_dwordx4 a[176:179], v155, s[60:61] offset:0 sc1
    s_waitcnt vmcnt(11)
    v_mfma_f32_16x16x32_bf16 v[64:67], v[176:179], a[132:135], v[64:67]
    v_mfma_f32_16x16x32_bf16 v[68:71], v[180:183], a[132:135], v[68:71]
    v_mfma_f32_16x16x32_bf16 v[72:75], v[184:187], a[132:135], v[72:75]
    v_mfma_f32_16x16x32_bf16 v[76:79], v[188:191], a[132:135], v[76:79]
    global_load_dwordx4 a[180:183], v155, s[60:61] offset:1024 sc1
    v_add_u32 v155, 1822720, v155
    s_waitcnt vmcnt(11)
    v_mfma_f32_16x16x32_bf16 v[64:67], v[192:195], a[136:139], v[64:67]
    global_store_dwordx2 v8, v[16:17], s[24:25] sc1
    v_mfma_f32_16x16x32_bf16 v[68:71], v[196:199], a[136:139], v[68:71]
    v_add_u32 v8, 0x80000, v8
    global_store_dwordx2 v8, v[32:33], s[24:25] sc1
    v_mfma_f32_16x16x32_bf16 v[72:75], v[200:203], a[136:139], v[72:75]
    v_add_u32 v8, 0x80000, v8
    v_cmp_u_f32 vcc, v48, v48
    s_cbranch_vccnz slow_pok_68
pok_68:
    v_mfma_f32_16x16x32_bf16 v[76:79], v[204:207], a[136:139], v[76:79]
    ds_write_b128 v6, v[48:51] offset:0
    s_waitcnt vmcnt(12)
    v_mfma_f32_16x16x32_bf16 v[64:67], v[208:211], a[140:143], v[64:67]
    v_mfma_f32_16x16x32_bf16 v[68:71], v[212:215], a[140:143], v[68:71]
    v_mfma_f32_16x16x32_bf16 v[72:75], v[216:219], a[140:143], v[72:75]
    v_mfma_f32_16x16x32_bf16 v[76:79], v[220:223], a[140:143], v[76:79]
    ds_write_b128 v0, v[52:55] offset:0
    s_waitcnt vmcnt(11)
    v_mfma_f32_16x16x32_bf16 v[64:67], v[224:227], a[144:147], v[64:67]
    v_mfma_f32_16x16x32_bf16 v[68:71], v[228:231], a[144:147], v[68:71]
    v_mfma_f32_16x16x32_bf16 v[72:75], v[232:235], a[144:147], v[72:75]
    v_mfma_f32_16x16x32_bf16 v[76:79], v[236:239], a[144:147], v[76:79]
    ds_write_b128 v15, v[56:59] offset:0
    s_waitcnt vmcnt(10)
    v_mfma_f32_16x16x32_bf16 v[64:67], v[240:243], a[148:151], v[64:67]
    v_mfma_f32_16x16x32_bf16 v[68:71], v[244:247], a[148:151], v[68:71]
    v_mfma_f32_16x16x32_bf16 v[72:75], v[248:251], a[148:151], v[72:75]
    v_mfma_f32_16x16x32_bf16 v[76:79], v[252:255], a[148:151], v[76:79]
    ds_write_b128 v156, v[60:63] offset:0
    s_waitcnt vmcnt(9)
    v_mfma_f32_16x16x32_bf16 v[64:67], a[0:3], a[152:155], v[64:67]
    v_mfma_f32_16x16x32_bf16 v[68:71], a[4:7], a[152:155], v[68:71]
    v_mfma_f32_16x16x32_bf16 v[72:75], a[8:11], a[152:155], v[72:75]
    v_mfma_f32_16x16x32_bf16 v[76:79], a[12:15], a[152:155], v[76:79]
    s_waitcnt vmcnt(8)
    v_mfma_f32_16x16x32_bf16 v[64:67], a[16:19], a[156:159], v[64:67]
    v_mfma_f32_16x16x32_bf16 v[68:71], a[20:23], a[156:159], v[68:71]
    v_mfma_f32_16x16x32_bf16 v[72:75], a[24:27], a[156:159], v[72:75]
    s_waitcnt lgkmcnt(0)
    s_barrier
    v_mfma_f32_16x16x32_bf16 v[76:79], a[28:31], a[156:159], v[76:79]
    ds_read_b128 v[132:135], v7 offset:0
    ds_read_b128 v[136:139], v7 offset:4352
    s_waitcnt vmcnt(7)
    v_mfma_f32_16x16x32_bf16 v[64:67], a[32:35], a[160:163], v[64:67]
    ds_read_b128 v[140:143], v7 offset:8704
    ds_read_b128 v[144:147], v7 offset:13056
    v_mfma_f32_16x16x32_bf16 v[68:71], a[36:39], a[160:163], v[68:71]
    v_mfma_f32_16x16x32_bf16 v[72:75], a[40:43], a[160:163], v[72:75]
    v_mfma_f32_16x16x32_bf16 v[76:79], a[44:47], a[160:163], v[76:79]
    s_waitcnt vmcnt(6)
    v_mfma_f32_16x16x32_bf16 v[64:67], a[48:51], a[164:167], v[64:67]
    v_mfma_f32_16x16x32_bf16 v[68:71], a[52:55], a[164:167], v[68:71]
    v_mfma_f32_16x16x32_bf16 v[72:75], a[56:59], a[164:167], v[72:75]
    s_waitcnt lgkmcnt(2)
    v_add_f32 v132, v132, v136
    v_mfma_f32_16x16x32_bf16 v[76:79], a[60:63], a[164:167], v[76:79]
    v_add_f32 v133, v133, v137
    v_add_f32 v134, v134, v138
    s_waitcnt vmcnt(5)
    v_mfma_f32_16x16x32_bf16 v[64:67], a[64:67], a[168:171], v[64:67]
    v_add_f32 v135, v135, v139
    s_waitcnt lgkmcnt(0)
    v_add_f32 v140, v140, v144
    v_add_f32 v141, v141, v145
    v_add_f32 v142, v142, v146
    v_add_f32 v143, v143, v147
    v_add_f32 v132, v132, v140
    v_add_f32 v133, v133, v141
    v_add_f32 v134, v134, v142
    v_add_f32 v135, v135, v143
    v_cvt_pk_bf16_f32 v48, v132, v133
    v_cvt_pk_bf16_f32 v49, v134, v135
    global_store_dwordx2 v8, v[48:49], s[24:25] sc1
    s_waitcnt vmcnt(5)
    v_mfma_f32_16x16x32_bf16 v[64:67], a[80:83], a[172:175], v[64:67]
    v_add_u32 v8, 0x80000, v8
    s_waitcnt vmcnt(4)
    v_mfma_f32_16x16x32_bf16 v[64:67], a[96:99], a[176:179], v[64:67]
    s_waitcnt vmcnt(3)
    v_mfma_f32_16x16x32_bf16 v[64:67], a[112:115], a[180:183], v[64:67]
    v_mfma_f32_16x16x32_bf16 v[68:71], a[68:71], a[168:171], v[68:71]
    v_mfma_f32_16x16x32_bf16 v[68:71], a[84:87], a[172:175], v[68:71]
    v_mfma_f32_16x16x32_bf16 v[68:71], a[100:103], a[176:179], v[68:71]
    v_mfma_f32_16x16x32_bf16 v[68:71], a[116:119], a[180:183], v[68:71]
    v_mfma_f32_16x16x32_bf16 v[72:75], a[72:75], a[168:171], v[72:75]
    v_mfma_f32_16x16x32_bf16 v[72:75], a[88:91], a[172:175], v[72:75]
    v_mfma_f32_16x16x32_bf16 v[72:75], a[104:107], a[176:179], v[72:75]
    v_mfma_f32_16x16x32_bf16 v[72:75], a[120:123], a[180:183], v[72:75]
    v_mfma_f32_16x16x32_bf16 v[76:79], a[76:79], a[168:171], v[76:79]
    v_mfma_f32_16x16x32_bf16 v[76:79], a[92:95], a[172:175], v[76:79]
    v_mfma_f32_16x16x32_bf16 v[76:79], a[108:111], a[176:179], v[76:79]
    v_mfma_f32_16x16x32_bf16 v[76:79], a[124:127], a[180:183], v[76:79]
    s_nop 0
    v_cmp_u_f32 vcc, v64, v64
    s_cbranch_vccnz slow_pok_70
pok_70:
    ds_write_b128 v6, v[64:67] offset:17408
    s_nop 0
    ds_write_b128 v0, v[68:71] offset:17408
    s_nop 0
    ds_write_b128 v15, v[72:75] offset:17408
    s_nop 0
    ds_write_b128 v156, v[76:79] offset:17408
    s_waitcnt lgkmcnt(0)
    s_barrier
    ds_read_b128 v[132:135], v7 offset:17408
    ds_read_b128 v[136:139], v7 offset:21760
    ds_read_b128 v[140:143], v7 offset:26112
    ds_read_b128 v[144:147], v7 offset:30464
    s_waitcnt lgkmcnt(2)
    v_add_f32 v132, v132, v136
    v_add_f32 v133, v133, v137
    v_add_f32 v134, v134, v138
    v_add_f32 v135, v135, v139
    s_waitcnt lgkmcnt(0)
    v_add_f32 v140, v140, v144
    v_add_f32 v141, v141, v145
    v_add_f32 v142, v142, v146
    v_add_f32 v143, v143, v147
    v_add_f32 v132, v132, v140
    v_add_f32 v133, v133, v141
    v_add_f32 v134, v134, v142
    v_add_f32 v135, v135, v143
    v_cvt_pk_bf16_f32 v64, v132, v133
    v_cvt_pk_bf16_f32 v65, v134, v135
    global_store_dwordx2 v8, v[64:65], s[24:25] sc1
    v_add_u32 v8, 0x80000, v8
    s_branch g1done_12
L_end0:
    s_endpgm
slow_pok_4:
    s_mov_b32 s57, 0
plp_5:
    s_mov_b64 exec, vcc
    global_load_dword v15, v13, s[28:29] sc1
    s_mov_b64 exec, -1
    s_add_u32 s57, s57, 1
    s_waitcnt vmcnt(0)
    v_cmp_ne_u32 vcc, s30, v15
    s_cmp_ge_u32 s57, 400000
    s_cbranch_scc1 pok_4
    s_cbranch_vccnz plp_5
    s_branch pok_4
slow_pok_7:
    s_mov_b32 s57, 0
plp_8:
    s_sleep 4
    s_mov_b64 exec, vcc
    global_load_dword v15, v13, s[28:29] sc1
    s_mov_b64 exec, -1
    s_add_u32 s57, s57, 1
    s_waitcnt vmcnt(0)
    v_cmp_ne_u32 vcc, 16, v15
    s_cmp_ge_u32 s57, 400000
    s_cbranch_scc1 pok_7
    s_cbranch_vccnz plp_8
    s_branch pok_7
slow_pok_9:
    s_mov_b32 s57, 0
    v_subrev_u32 v14, s8, v149
plp_10:
    s_add_u32 m0, s73, 0
    s_nop 0
    buffer_load_dwordx4 v14, s[32:35], s66 offen offset:0 sc1 lds
    buffer_load_dwordx4 v14, s[32:35], s66 offen offset:1024 sc1 lds
    buffer_load_dwordx4 v14, s[32:35], s67 offen offset:2048 sc1 lds
    buffer_load_dwordx4 v14, s[32:35], s67 offen offset:3072 sc1 lds
    s_add_u32 m0, s73, 4096
    s_nop 0
    buffer_load_dwordx4 v14, s[32:35], s68 offen offset:0 sc1 lds
    buffer_load_dwordx4 v14, s[32:35], s68 offen offset:1024 sc1 lds
    buffer_load_dwordx4 v14, s[32:35], s69 offen offset:2048 sc1 lds
    buffer_load_dwordx4 v14, s[32:35], s69 offen offset:3072 sc1 lds
    s_waitcnt vmcnt(0)
    ds_read_b128 v[48:51], v156 offset:0
    ds_read_b128 v[52:55], v156 offset:1024
    ds_read_b128 v[56:59], v156 offset:2048
    ds_read_b128 v[60:63], v156 offset:3072
    ds_read_b128 v[64:67], v156 offset:4096
    ds_read_b128 v[68:71], v156 offset:5120
    ds_read_b128 v[72:75], v156 offset:6144
    ds_read_b128 v[76:79], v156 offset:7168
    s_waitcnt lgkmcnt(0)
    v_max_u32 v48, v48, v49
    v_max3_u32 v48, v48, v50, v51
    v_max3_u32 v48, v48, v52, v53
    v_max3_u32 v48, v48, v54, v55
    v_max3_u32 v48, v48, v56, v57
    v_max3_u32 v48, v48, v58, v59
    v_max3_u32 v48, v48, v60, v61
    v_max3_u32 v48, v48, v62, v63
    s_waitcnt lgkmcnt(0)
    v_max3_u32 v48, v48, v64, v65
    v_max3_u32 v48, v48, v66, v67
    v_max3_u32 v48, v48, v68, v69
    v_max3_u32 v48, v48, v70, v71
    v_max3_u32 v48, v48, v72, v73
    v_max3_u32 v48, v48, v74, v75
    v_max3_u32 v48, v48, v76, v77
    v_max3_u32 v48, v48, v78, v79
    s_add_u32 s57, s57, 1
    v_cmp_eq_u32 vcc, -1, v48
    s_cmp_ge_u32 s57, 3000
    s_cbranch_scc1 ex_11
    s_cbranch_vccnz plp_10
ex_11:
    s_branch pok_9
slow_pok_14:
    s_mov_b32 s57, 0
    v_subrev_u32 v14, s8, v149
plp_15:
    s_add_u32 m0, s73, 32768
    s_nop 0
    buffer_load_dwordx4 v14, s[32:35], s66 offen offset:0 sc1 lds
    buffer_load_dwordx4 v14, s[32:35], s66 offen offset:1024 sc1 lds
    buffer_load_dwordx4 v14, s[32:35], s67 offen offset:2048 sc1 lds
    buffer_load_dwordx4 v14, s[32:35], s67 offen offset:3072 sc1 lds
    s_add_u32 m0, s73, 36864
    s_nop 0
    buffer_load_dwordx4 v14, s[32:35], s68 offen offset:0 sc1 lds
    buffer_load_dwordx4 v14, s[32:35], s68 offen offset:1024 sc1 lds
    buffer_load_dwordx4 v14, s[32:35], s69 offen offset:2048 sc1 lds
    buffer_load_dwordx4 v14, s[32:35], s69 offen offset:3072 sc1 lds
    s_waitcnt vmcnt(0)
    ds_read_b128 v[48:51], v156 offset:32768
    ds_read_b128 v[52:55], v156 offset:33792
    ds_read_b128 v[56:59], v156 offset:34816
    ds_read_b128 v[60:63], v156 offset:35840
    ds_read_b128 v[64:67], v156 offset:36864
    ds_read_b128 v[68:71], v156 offset:37888
    ds_read_b128 v[72:75], v156 offset:38912
    ds_read_b128 v[76:79], v156 offset:39936
    s_waitcnt lgkmcnt(0)
    v_max_u32 v48, v48, v49
    v_max3_u32 v48, v48, v50, v51
    v_max3_u32 v48, v48, v52, v53
    v_max3_u32 v48, v48, v54, v55
    v_max3_u32 v48, v48, v56, v57
    v_max3_u32 v48, v48, v58, v59
    v_max3_u32 v48, v48, v60, v61
    v_max3_u32 v48, v48, v62, v63
    s_waitcnt lgkmcnt(0)
    v_max3_u32 v48, v48, v64, v65
    v_max3_u32 v48, v48, v66, v67
    v_max3_u32 v48, v48, v68, v69
    v_max3_u32 v48, v48, v70, v71
    v_max3_u32 v48, v48, v72, v73
    v_max3_u32 v48, v48, v74, v75
    v_max3_u32 v48, v48, v76, v77
    v_max3_u32 v48, v48, v78, v79
    s_add_u32 s57, s57, 1
    v_cmp_eq_u32 vcc, -1, v48
    s_cmp_ge_u32 s57, 3000
    s_cbranch_scc1 ex_16
    s_cbranch_vccnz plp_15
ex_16:
    s_branch pok_14
slow_pok_17:
    s_mov_b32 s57, 0
plp_18:
    s_sleep 4
    s_mov_b64 exec, vcc
    global_load_dword v128, v13, s[28:29] sc1
    s_mov_b64 exec, -1
    s_add_u32 s57, s57, 1
    s_waitcnt vmcnt(0)
    v_cmp_ne_u32 vcc, 16, v128
    s_cmp_ge_u32 s57, 400000
    s_cbranch_scc1 pok_17
    s_cbranch_vccnz plp_18
    s_branch pok_17
slow_pok_21:
    s_mov_b32 s57, 0
plp_22:
    s_mov_b64 exec, vcc
    global_load_dwordx2 v[126:127], v152, s[28:29] sc1
    s_mov_b64 exec, -1
    s_add_u32 s57, s57, 1
    s_waitcnt vmcnt(0)
    v_cmp_ne_u32 vcc, s30, v126
    s_cmp_ge_u32 s57, 400000
    s_cbranch_scc1 pok_21
    s_cbranch_vccnz plp_22
    s_branch pok_21
slow_pok_25:
    s_mov_b32 s57, 0
plp_26:
    s_mov_b64 exec, vcc
    global_load_dwordx2 v[126:127], v152, s[28:29] sc1
    s_mov_b64 exec, -1
    s_add_u32 s57, s57, 1
    s_waitcnt vmcnt(0)
    v_cmp_ne_u32 vcc, s30, v126
    s_cmp_ge_u32 s57, 400000
    s_cbranch_scc1 pok_25
    s_cbranch_vccnz plp_26
    s_branch pok_25
slow_pok_27:
    s_mov_b32 s57, 0
plp_28:
    s_mov_b64 exec, vcc
    global_load_dwordx2 v[126:127], v152, s[28:29] sc1
    s_mov_b64 exec, -1
    s_add_u32 s57, s57, 1
    s_waitcnt vmcnt(0)
    v_cmp_ne_u32 vcc, s30, v126
    s_cmp_ge_u32 s57, 400000
    s_cbranch_scc1 pok_27
    s_cbranch_vccnz plp_28
    s_branch pok_27
slow_pok_29:
    s_mov_b32 s57, 0
plp_30:
    s_mov_b64 exec, vcc
    global_load_dword v128, v153, s[28:29] sc1
    s_mov_b64 exec, -1
    s_add_u32 s57, s57, 1
    s_waitcnt vmcnt(0)
    v_cmp_ne_u32 vcc, s30, v128
    s_cmp_ge_u32 s57, 400000
    s_cbranch_scc1 pok_29
    s_cbranch_vccnz plp_30
    s_branch pok_29
slow_pok_31:
    s_mov_b32 s57, 0
plp_32:
    s_mov_b64 exec, vcc
    global_load_dwordx2 v[126:127], v152, s[28:29] sc1
    s_mov_b64 exec, -1
    s_add_u32 s57, s57, 1
    s_waitcnt vmcnt(0)
    v_cmp_ne_u32 vcc, s30, v126
    s_cmp_ge_u32 s57, 400000
    s_cbranch_scc1 pok_31
    s_cbranch_vccnz plp_32
    s_branch pok_31
slow_pok_33:
    s_mov_b32 s57, 0
plp_34:
    s_sleep 3
    s_mov_b64 exec, vcc
    global_load_dword v128, v153, s[28:29] sc1
    s_mov_b64 exec, -1
    s_add_u32 s57, s57, 1
    s_waitcnt vmcnt(0)
    v_cmp_ne_u32 vcc, s30, v128
    s_cmp_ge_u32 s57, 400000
    s_cbranch_scc1 pok_33
    s_cbranch_vccnz plp_34
    s_sleep 8
    s_branch pok_33
slow_pok_35:
    s_mov_b32 s57, 0
plp_36:
    v_add_u32 v14, 0, v149
    v_lshlrev_b32 v16, 16, v158
    v_and_b32 v17, s76, v158
    v_lshlrev_b32 v18, 16, v159
    v_and_b32 v19, s76, v159
    global_load_dwordx4 a[128:131], v14, s[60:61] offset:0 sc1
    global_load_dwordx4 a[132:135], v14, s[60:61] offset:1024 sc1
    global_load_dwordx4 a[136:139], v14, s[60:61] offset:2048 sc1
    global_load_dwordx4 a[140:143], v14, s[60:61] offset:3072 sc1
    v_add_u32 v14, 4096, v14
    global_load_dwordx4 a[144:147], v14, s[60:61] offset:0 sc1
    global_load_dwordx4 a[148:151], v14, s[60:61] offset:1024 sc1
    global_load_dwordx4 a[152:155], v14, s[60:61] offset:2048 sc1
    global_load_dwordx4 a[156:159], v14, s[60:61] offset:3072 sc1
    v_add_u32 v14, 4096, v14
    global_load_dwordx4 a[160:163], v14, s[60:61] offset:0 sc1
    global_load_dwordx4 a[164:167], v14, s[60:61] offset:1024 sc1
    global_load_dwordx4 a[168:171], v14, s[60:61] offset:2048 sc1
    global_load_dwordx4 a[172:175], v14, s[60:61] offset:3072 sc1
    v_add_u32 v14, 4096, v14
    global_load_dwordx4 a[176:179], v14, s[60:61] offset:0 sc1
    global_load_dwordx4 a[180:183], v14, s[60:61] offset:1024 sc1
    v_add_u32 v14, 1822720, v14
    s_waitcnt vmcnt(0)
    v_mfma_f32_16x16x32_bf16 v[16:19], v[160:163], a[128:131], v[16:19]
    v_mfma_f32_16x16x32_bf16 v[20:23], v[164:167], a[128:131], 0
    v_mfma_f32_16x16x32_bf16 v[24:27], v[168:171], a[128:131], 0
    v_mfma_f32_16x16x32_bf16 v[28:31], v[172:175], a[128:131], 0
    v_mfma_f32_16x16x32_bf16 v[16:19], v[176:179], a[132:135], v[16:19]
    v_mfma_f32_16x16x32_bf16 v[20:23], v[180:183], a[132:135], v[20:23]
    v_mfma_f32_16x16x32_bf16 v[24:27], v[184:187], a[132:135], v[24:27]
    v_mfma_f32_16x16x32_bf16 v[28:31], v[188:191], a[132:135], v[28:31]
    v_mfma_f32_16x16x32_bf16 v[16:19], v[192:195], a[136:139], v[16:19]
    v_mfma_f32_16x16x32_bf16 v[20:23], v[196:199], a[136:139], v[20:23]
    v_mfma_f32_16x16x32_bf16 v[24:27], v[200:203], a[136:139], v[24:27]
    v_mfma_f32_16x16x32_bf16 v[28:31], v[204:207], a[136:139], v[28:31]
    v_mfma_f32_16x16x32_bf16 v[16:19], v[208:211], a[140:143], v[16:19]
    v_mfma_f32_16x16x32_bf16 v[20:23], v[212:215], a[140:143], v[20:23]
    v_mfma_f32_16x16x32_bf16 v[24:27], v[216:219], a[140:143], v[24:27]
    v_mfma_f32_16x16x32_bf16 v[28:31], v[220:223], a[140:143], v[28:31]
    v_mfma_f32_16x16x32_bf16 v[16:19], v[224:227], a[144:147], v[16:19]
    v_mfma_f32_16x16x32_bf16 v[20:23], v[228:231], a[144:147], v[20:23]
    v_mfma_f32_16x16x32_bf16 v[24:27], v[232:235], a[144:147], v[24:27]
    v_mfma_f32_16x16x32_bf16 v[28:31], v[236:239], a[144:147], v[28:31]
    v_mfma_f32_16x16x32_bf16 v[16:19], v[240:243], a[148:151], v[16:19]
    v_mfma_f32_16x16x32_bf16 v[20:23], v[244:247], a[148:151], v[20:23]
    v_mfma_f32_16x16x32_bf16 v[24:27], v[248:251], a[148:151], v[24:27]
    v_mfma_f32_16x16x32_bf16 v[28:31], v[252:255], a[148:151], v[28:31]
    v_mfma_f32_16x16x32_bf16 v[16:19], a[0:3], a[152:155], v[16:19]
    v_mfma_f32_16x16x32_bf16 v[20:23], a[4:7], a[152:155], v[20:23]
    v_mfma_f32_16x16x32_bf16 v[24:27], a[8:11], a[152:155], v[24:27]
    v_mfma_f32_16x16x32_bf16 v[28:31], a[12:15], a[152:155], v[28:31]
    v_mfma_f32_16x16x32_bf16 v[16:19], a[16:19], a[156:159], v[16:19]
    v_mfma_f32_16x16x32_bf16 v[20:23], a[20:23], a[156:159], v[20:23]
    v_mfma_f32_16x16x32_bf16 v[24:27], a[24:27], a[156:159], v[24:27]
    v_mfma_f32_16x16x32_bf16 v[28:31], a[28:31], a[156:159], v[28:31]
    v_mfma_f32_16x16x32_bf16 v[16:19], a[32:35], a[160:163], v[16:19]
    v_mfma_f32_16x16x32_bf16 v[20:23], a[36:39], a[160:163], v[20:23]
    v_mfma_f32_16x16x32_bf16 v[24:27], a[40:43], a[160:163], v[24:27]
    v_mfma_f32_16x16x32_bf16 v[28:31], a[44:47], a[160:163], v[28:31]
    v_mfma_f32_16x16x32_bf16 v[16:19], a[48:51], a[164:167], v[16:19]
    v_mfma_f32_16x16x32_bf16 v[20:23], a[52:55], a[164:167], v[20:23]
    v_mfma_f32_16x16x32_bf16 v[24:27], a[56:59], a[164:167], v[24:27]
    v_mfma_f32_16x16x32_bf16 v[28:31], a[60:63], a[164:167], v[28:31]
    v_mfma_f32_16x16x32_bf16 v[16:19], a[64:67], a[168:171], v[16:19]
    v_mfma_f32_16x16x32_bf16 v[20:23], a[68:71], a[168:171], v[20:23]
    v_mfma_f32_16x16x32_bf16 v[24:27], a[72:75], a[168:171], v[24:27]
    v_mfma_f32_16x16x32_bf16 v[28:31], a[76:79], a[168:171], v[28:31]
    v_mfma_f32_16x16x32_bf16 v[16:19], a[80:83], a[172:175], v[16:19]
    v_mfma_f32_16x16x32_bf16 v[20:23], a[84:87], a[172:175], v[20:23]
    v_mfma_f32_16x16x32_bf16 v[24:27], a[88:91], a[172:175], v[24:27]
    v_mfma_f32_16x16x32_bf16 v[28:31], a[92:95], a[172:175], v[28:31]
    v_mfma_f32_16x16x32_bf16 v[16:19], a[96:99], a[176:179], v[16:19]
    v_mfma_f32_16x16x32_bf16 v[20:23], a[100:103], a[176:179], v[20:23]
    v_mfma_f32_16x16x32_bf16 v[24:27], a[104:107], a[176:179], v[24:27]
    v_mfma_f32_16x16x32_bf16 v[28:31], a[108:111], a[176:179], v[28:31]
    v_mfma_f32_16x16x32_bf16 v[16:19], a[112:115], a[180:183], v[16:19]
    v_mfma_f32_16x16x32_bf16 v[20:23], a[116:119], a[180:183], v[20:23]
    v_mfma_f32_16x16x32_bf16 v[24:27], a[120:123], a[180:183], v[24:27]
    v_mfma_f32_16x16x32_bf16 v[28:31], a[124:127], a[180:183], v[28:31]
    s_nop 7
    s_add_u32 s57, s57, 1
    v_cmp_u_f32 vcc, v16, v16
    s_cmp_ge_u32 s57, 3000
    s_cbranch_scc1 pok_35
    s_cbranch_vccnz plp_36
    s_branch pok_35
slow_pok_37:
    s_mov_b32 s57, 0
plp_38:
    s_sleep 3
    s_mov_b64 exec, vcc
    global_load_dword v128, v153, s[28:29] sc1
    s_mov_b64 exec, -1
    s_add_u32 s57, s57, 1
    s_waitcnt vmcnt(0)
    v_cmp_ne_u32 vcc, s30, v128
    s_cmp_ge_u32 s57, 400000
    s_cbranch_scc1 pok_37
    s_cbranch_vccnz plp_38
    s_sleep 8
    s_branch pok_37
slow_pok_39:
    s_mov_b32 s57, 0
plp_40:
    v_add_u32 v14, 1835008, v149
    v_lshlrev_b32 v32, 16, v130
    v_and_b32 v33, s76, v130
    v_lshlrev_b32 v34, 16, v131
    v_and_b32 v35, s76, v131
    global_load_dwordx4 a[184:187], v14, s[60:61] offset:0 sc1
    global_load_dwordx4 a[188:191], v14, s[60:61] offset:1024 sc1
    global_load_dwordx4 a[192:195], v14, s[60:61] offset:2048 sc1
    global_load_dwordx4 a[196:199], v14, s[60:61] offset:3072 sc1
    v_add_u32 v14, 4096, v14
    global_load_dwordx4 a[200:203], v14, s[60:61] offset:0 sc1
    global_load_dwordx4 a[204:207], v14, s[60:61] offset:1024 sc1
    global_load_dwordx4 a[208:211], v14, s[60:61] offset:2048 sc1
    global_load_dwordx4 a[212:215], v14, s[60:61] offset:3072 sc1
    v_add_u32 v14, 4096, v14
    global_load_dwordx4 a[216:219], v14, s[60:61] offset:0 sc1
    global_load_dwordx4 a[220:223], v14, s[60:61] offset:1024 sc1
    global_load_dwordx4 a[224:227], v14, s[60:61] offset:2048 sc1
    global_load_dwordx4 a[228:231], v14, s[60:61] offset:3072 sc1
    v_add_u32 v14, 4096, v14
    global_load_dwordx4 a[232:235], v14, s[60:61] offset:0 sc1
    global_load_dwordx4 a[236:239], v14, s[60:61] offset:1024 sc1
    v_add_u32 v14, 1822720, v14
    s_waitcnt vmcnt(0)
    v_mfma_f32_16x16x32_bf16 v[32:35], v[160:163], a[184:187], v[32:35]
    v_mfma_f32_16x16x32_bf16 v[36:39], v[164:167], a[184:187], 0
    v_mfma_f32_16x16x32_bf16 v[40:43], v[168:171], a[184:187], 0
    v_mfma_f32_16x16x32_bf16 v[44:47], v[172:175], a[184:187], 0
    v_mfma_f32_16x16x32_bf16 v[32:35], v[176:179], a[188:191], v[32:35]
    v_mfma_f32_16x16x32_bf16 v[36:39], v[180:183], a[188:191], v[36:39]
    v_mfma_f32_16x16x32_bf16 v[40:43], v[184:187], a[188:191], v[40:43]
    v_mfma_f32_16x16x32_bf16 v[44:47], v[188:191], a[188:191], v[44:47]
    v_mfma_f32_16x16x32_bf16 v[32:35], v[192:195], a[192:195], v[32:35]
    v_mfma_f32_16x16x32_bf16 v[36:39], v[196:199], a[192:195], v[36:39]
    v_mfma_f32_16x16x32_bf16 v[40:43], v[200:203], a[192:195], v[40:43]
    v_mfma_f32_16x16x32_bf16 v[44:47], v[204:207], a[192:195], v[44:47]
    v_mfma_f32_16x16x32_bf16 v[32:35], v[208:211], a[196:199], v[32:35]
    v_mfma_f32_16x16x32_bf16 v[36:39], v[212:215], a[196:199], v[36:39]
    v_mfma_f32_16x16x32_bf16 v[40:43], v[216:219], a[196:199], v[40:43]
    v_mfma_f32_16x16x32_bf16 v[44:47], v[220:223], a[196:199], v[44:47]
    v_mfma_f32_16x16x32_bf16 v[32:35], v[224:227], a[200:203], v[32:35]
    v_mfma_f32_16x16x32_bf16 v[36:39], v[228:231], a[200:203], v[36:39]
    v_mfma_f32_16x16x32_bf16 v[40:43], v[232:235], a[200:203], v[40:43]
    v_mfma_f32_16x16x32_bf16 v[44:47], v[236:239], a[200:203], v[44:47]
    v_mfma_f32_16x16x32_bf16 v[32:35], v[240:243], a[204:207], v[32:35]
    v_mfma_f32_16x16x32_bf16 v[36:39], v[244:247], a[204:207], v[36:39]
    v_mfma_f32_16x16x32_bf16 v[40:43], v[248:251], a[204:207], v[40:43]
    v_mfma_f32_16x16x32_bf16 v[44:47], v[252:255], a[204:207], v[44:47]
    v_mfma_f32_16x16x32_bf16 v[32:35], a[0:3], a[208:211], v[32:35]
    v_mfma_f32_16x16x32_bf16 v[36:39], a[4:7], a[208:211], v[36:39]
    v_mfma_f32_16x16x32_bf16 v[40:43], a[8:11], a[208:211], v[40:43]
    v_mfma_f32_16x16x32_bf16 v[44:47], a[12:15], a[208:211], v[44:47]
    v_mfma_f32_16x16x32_bf16 v[32:35], a[16:19], a[212:215], v[32:35]
    v_mfma_f32_16x16x32_bf16 v[36:39], a[20:23], a[212:215], v[36:39]
    v_mfma_f32_16x16x32_bf16 v[40:43], a[24:27], a[212:215], v[40:43]
    v_mfma_f32_16x16x32_bf16 v[44:47], a[28:31], a[212:215], v[44:47]
    v_mfma_f32_16x16x32_bf16 v[32:35], a[32:35], a[216:219], v[32:35]
    v_mfma_f32_16x16x32_bf16 v[36:39], a[36:39], a[216:219], v[36:39]
    v_mfma_f32_16x16x32_bf16 v[40:43], a[40:43], a[216:219], v[40:43]
    v_mfma_f32_16x16x32_bf16 v[44:47], a[44:47], a[216:219], v[44:47]
    v_mfma_f32_16x16x32_bf16 v[32:35], a[48:51], a[220:223], v[32:35]
    v_mfma_f32_16x16x32_bf16 v[36:39], a[52:55], a[220:223], v[36:39]
    v_mfma_f32_16x16x32_bf16 v[40:43], a[56:59], a[220:223], v[40:43]
    v_mfma_f32_16x16x32_bf16 v[44:47], a[60:63], a[220:223], v[44:47]
    v_mfma_f32_16x16x32_bf16 v[32:35], a[64:67], a[224:227], v[32:35]
    v_mfma_f32_16x16x32_bf16 v[36:39], a[68:71], a[224:227], v[36:39]
    v_mfma_f32_16x16x32_bf16 v[40:43], a[72:75], a[224:227], v[40:43]
    v_mfma_f32_16x16x32_bf16 v[44:47], a[76:79], a[224:227], v[44:47]
    v_mfma_f32_16x16x32_bf16 v[32:35], a[80:83], a[228:231], v[32:35]
    v_mfma_f32_16x16x32_bf16 v[36:39], a[84:87], a[228:231], v[36:39]
    v_mfma_f32_16x16x32_bf16 v[40:43], a[88:91], a[228:231], v[40:43]
    v_mfma_f32_16x16x32_bf16 v[44:47], a[92:95], a[228:231], v[44:47]
    v_mfma_f32_16x16x32_bf16 v[32:35], a[96:99], a[232:235], v[32:35]
    v_mfma_f32_16x16x32_bf16 v[36:39], a[100:103], a[232:235], v[36:39]
    v_mfma_f32_16x16x32_bf16 v[40:43], a[104:107], a[232:235], v[40:43]
    v_mfma_f32_16x16x32_bf16 v[44:47], a[108:111], a[232:235], v[44:47]
    v_mfma_f32_16x16x32_bf16 v[32:35], a[112:115], a[236:239], v[32:35]
    v_mfma_f32_16x16x32_bf16 v[36:39], a[116:119], a[236:239], v[36:39]
    v_mfma_f32_16x16x32_bf16 v[40:43], a[120:123], a[236:239], v[40:43]
    v_mfma_f32_16x16x32_bf16 v[44:47], a[124:127], a[236:239], v[44:47]
    s_nop 7
    s_add_u32 s57, s57, 1
    v_cmp_u_f32 vcc, v32, v32
    s_cmp_ge_u32 s57, 3000
    s_cbranch_scc1 pok_39
    s_cbranch_vccnz plp_40
    s_branch pok_39
slow_pok_42:
    s_mov_b32 s57, 0
plp_43:
    v_add_u32 v14, 3670016, v149
    v_lshlrev_b32 v48, 16, v10
    v_and_b32 v49, s76, v10
    v_lshlrev_b32 v50, 16, v11
    v_and_b32 v51, s76, v11
    global_load_dwordx4 v[80:83], v14, s[60:61] offset:0 sc1
    global_load_dwordx4 v[84:87], v14, s[60:61] offset:1024 sc1
    global_load_dwordx4 v[88:91], v14, s[60:61] offset:2048 sc1
    global_load_dwordx4 v[92:95], v14, s[60:61] offset:3072 sc1
    v_add_u32 v14, 4096, v14
    global_load_dwordx4 v[96:99], v14, s[60:61] offset:0 sc1
    global_load_dwordx4 v[100:103], v14, s[60:61] offset:1024 sc1
    global_load_dwordx4 v[104:107], v14, s[60:61] offset:2048 sc1
    global_load_dwordx4 v[108:111], v14, s[60:61] offset:3072 sc1
    v_add_u32 v14, 4096, v14
    global_load_dwordx4 v[112:115], v14, s[60:61] offset:0 sc1
    global_load_dwordx4 v[116:119], v14, s[60:61] offset:1024 sc1
    global_load_dwordx4 v[120:123], v14, s[60:61] offset:2048 sc1
    global_load_dwordx4 a[240:243], v14, s[60:61] offset:3072 sc1
    v_add_u32 v14, 4096, v14
    global_load_dwordx4 a[244:247], v14, s[60:61] offset:0 sc1
    global_load_dwordx4 a[248:251], v14, s[60:61] offset:1024 sc1
    v_add_u32 v14, 1822720, v14
    s_waitcnt vmcnt(0)
    v_mfma_f32_16x16x32_bf16 v[48:51], v[160:163], v[80:83], v[48:51]
    v_mfma_f32_16x16x32_bf16 v[52:55], v[164:167], v[80:83], 0
    v_mfma_f32_16x16x32_bf16 v[56:59], v[168:171], v[80:83], 0
    v_mfma_f32_16x16x32_bf16 v[60:63], v[172:175], v[80:83], 0
    v_mfma_f32_16x16x32_bf16 v[48:51], v[176:179], v[84:87], v[48:51]
    v_mfma_f32_16x16x32_bf16 v[52:55], v[180:183], v[84:87], v[52:55]
    v_mfma_f32_16x16x32_bf16 v[56:59], v[184:187], v[84:87], v[56:59]
    v_mfma_f32_16x16x32_bf16 v[60:63], v[188:191], v[84:87], v[60:63]
    v_mfma_f32_16x16x32_bf16 v[48:51], v[192:195], v[88:91], v[48:51]
    v_mfma_f32_16x16x32_bf16 v[52:55], v[196:199], v[88:91], v[52:55]
    v_mfma_f32_16x16x32_bf16 v[56:59], v[200:203], v[88:91], v[56:59]
    v_mfma_f32_16x16x32_bf16 v[60:63], v[204:207], v[88:91], v[60:63]
    v_mfma_f32_16x16x32_bf16 v[48:51], v[208:211], v[92:95], v[48:51]
    v_mfma_f32_16x16x32_bf16 v[52:55], v[212:215], v[92:95], v[52:55]
    v_mfma_f32_16x16x32_bf16 v[56:59], v[216:219], v[92:95], v[56:59]
    v_mfma_f32_16x16x32_bf16 v[60:63], v[220:223], v[92:95], v[60:63]
    v_mfma_f32_16x16x32_bf16 v[48:51], v[224:227], v[96:99], v[48:51]
    v_mfma_f32_16x16x32_bf16 v[52:55], v[228:231], v[96:99], v[52:55]
    v_mfma_f32_16x16x32_bf16 v[56:59], v[232:235], v[96:99], v[56:59]
    v_mfma_f32_16x16x32_bf16 v[60:63], v[236:239], v[96:99], v[60:63]
    v_mfma_f32_16x16x32_bf16 v[48:51], v[240:243], v[100:103], v[48:51]
    v_mfma_f32_16x16x32_bf16 v[52:55], v[244:247], v[100:103], v[52:55]
    v_mfma_f32_16x16x32_bf16 v[56:59], v[248:251], v[100:103], v[56:59]
    v_mfma_f32_16x16x32_bf16 v[60:63], v[252:255], v[100:103], v[60:63]
    v_mfma_f32_16x16x32_bf16 v[48:51], a[0:3], v[104:107], v[48:51]
    v_mfma_f32_16x16x32_bf16 v[52:55], a[4:7], v[104:107], v[52:55]
    v_mfma_f32_16x16x32_bf16 v[56:59], a[8:11], v[104:107], v[56:59]
    v_mfma_f32_16x16x32_bf16 v[60:63], a[12:15], v[104:107], v[60:63]
    v_mfma_f32_16x16x32_bf16 v[48:51], a[16:19], v[108:111], v[48:51]
    v_mfma_f32_16x16x32_bf16 v[52:55], a[20:23], v[108:111], v[52:55]
    v_mfma_f32_16x16x32_bf16 v[56:59], a[24:27], v[108:111], v[56:59]
    v_mfma_f32_16x16x32_bf16 v[60:63], a[28:31], v[108:111], v[60:63]
    v_mfma_f32_16x16x32_bf16 v[48:51], a[32:35], v[112:115], v[48:51]
    v_mfma_f32_16x16x32_bf16 v[52:55], a[36:39], v[112:115], v[52:55]
    v_mfma_f32_16x16x32_bf16 v[56:59], a[40:43], v[112:115], v[56:59]
    v_mfma_f32_16x16x32_bf16 v[60:63], a[44:47], v[112:115], v[60:63]
    v_mfma_f32_16x16x32_bf16 v[48:51], a[48:51], v[116:119], v[48:51]
    v_mfma_f32_16x16x32_bf16 v[52:55], a[52:55], v[116:119], v[52:55]
    v_mfma_f32_16x16x32_bf16 v[56:59], a[56:59], v[116:119], v[56:59]
    v_mfma_f32_16x16x32_bf16 v[60:63], a[60:63], v[116:119], v[60:63]
    v_mfma_f32_16x16x32_bf16 v[48:51], a[64:67], v[120:123], v[48:51]
    v_mfma_f32_16x16x32_bf16 v[52:55], a[68:71], v[120:123], v[52:55]
    v_mfma_f32_16x16x32_bf16 v[56:59], a[72:75], v[120:123], v[56:59]
    v_mfma_f32_16x16x32_bf16 v[60:63], a[76:79], v[120:123], v[60:63]
    v_mfma_f32_16x16x32_bf16 v[48:51], a[80:83], a[240:243], v[48:51]
    v_mfma_f32_16x16x32_bf16 v[52:55], a[84:87], a[240:243], v[52:55]
    v_mfma_f32_16x16x32_bf16 v[56:59], a[88:91], a[240:243], v[56:59]
    v_mfma_f32_16x16x32_bf16 v[60:63], a[92:95], a[240:243], v[60:63]
    v_mfma_f32_16x16x32_bf16 v[48:51], a[96:99], a[244:247], v[48:51]
    v_mfma_f32_16x16x32_bf16 v[52:55], a[100:103], a[244:247], v[52:55]
    v_mfma_f32_16x16x32_bf16 v[56:59], a[104:107], a[244:247], v[56:59]
    v_mfma_f32_16x16x32_bf16 v[60:63], a[108:111], a[244:247], v[60:63]
    v_mfma_f32_16x16x32_bf16 v[48:51], a[112:115], a[248:251], v[48:51]
    v_mfma_f32_16x16x32_bf16 v[52:55], a[116:119], a[248:251], v[52:55]
    v_mfma_f32_16x16x32_bf16 v[56:59], a[120:123], a[248:251], v[56:59]
    v_mfma_f32_16x16x32_bf16 v[60:63], a[124:127], a[248:251], v[60:63]
    s_nop 7
    s_add_u32 s57, s57, 1
    v_cmp_u_f32 vcc, v48, v48
    s_cmp_ge_u32 s57, 3000
    s_cbranch_scc1 pok_42
    s_cbranch_vccnz plp_43
    s_branch pok_42
slow_pok_44:
    s_mov_b32 s57, 0
plp_45:
    v_add_u32 v14, 5505024, v149
    v_lshlrev_b32 v64, 16, v12
    v_and_b32 v65, s76, v12
    v_lshlrev_b32 v66, 16, v13
    v_and_b32 v67, s76, v13
    global_load_dwordx4 a[128:131], v14, s[60:61] offset:0 sc1
    global_load_dwordx4 a[132:135], v14, s[60:61] offset:1024 sc1
    global_load_dwordx4 a[136:139], v14, s[60:61] offset:2048 sc1
    global_load_dwordx4 a[140:143], v14, s[60:61] offset:3072 sc1
    v_add_u32 v14, 4096, v14
    global_load_dwordx4 a[144:147], v14, s[60:61] offset:0 sc1
    global_load_dwordx4 a[148:151], v14, s[60:61] offset:1024 sc1
    global_load_dwordx4 a[152:155], v14, s[60:61] offset:2048 sc1
    global_load_dwordx4 a[156:159], v14, s[60:61] offset:3072 sc1
    v_add_u32 v14, 4096, v14
    global_load_dwordx4 a[160:163], v14, s[60:61] offset:0 sc1
    global_load_dwordx4 a[164:167], v14, s[60:61] offset:1024 sc1
    global_load_dwordx4 a[168:171], v14, s[60:61] offset:2048 sc1
    global_load_dwordx4 a[172:175], v14, s[60:61] offset:3072 sc1
    v_add_u32 v14, 4096, v14
    global_load_dwordx4 a[176:179], v14, s[60:61] offset:0 sc1
    global_load_dwordx4 a[180:183], v14, s[60:61] offset:1024 sc1
    v_add_u32 v14, 1822720, v14
    s_waitcnt vmcnt(0)
    v_mfma_f32_16x16x32_bf16 v[64:67], v[160:163], a[128:131], v[64:67]
    v_mfma_f32_16x16x32_bf16 v[68:71], v[164:167], a[128:131], 0
    v_mfma_f32_16x16x32_bf16 v[72:75], v[168:171], a[128:131], 0
    v_mfma_f32_16x16x32_bf16 v[76:79], v[172:175], a[128:131], 0
    v_mfma_f32_16x16x32_bf16 v[64:67], v[176:179], a[132:135], v[64:67]
    v_mfma_f32_16x16x32_bf16 v[68:71], v[180:183], a[132:135], v[68:71]
    v_mfma_f32_16x16x32_bf16 v[72:75], v[184:187], a[132:135], v[72:75]
    v_mfma_f32_16x16x32_bf16 v[76:79], v[188:191], a[132:135], v[76:79]
    v_mfma_f32_16x16x32_bf16 v[64:67], v[192:195], a[136:139], v[64:67]
    v_mfma_f32_16x16x32_bf16 v[68:71], v[196:199], a[136:139], v[68:71]
    v_mfma_f32_16x16x32_bf16 v[72:75], v[200:203], a[136:139], v[72:75]
    v_mfma_f32_16x16x32_bf16 v[76:79], v[204:207], a[136:139], v[76:79]
    v_mfma_f32_16x16x32_bf16 v[64:67], v[208:211], a[140:143], v[64:67]
    v_mfma_f32_16x16x32_bf16 v[68:71], v[212:215], a[140:143], v[68:71]
    v_mfma_f32_16x16x32_bf16 v[72:75], v[216:219], a[140:143], v[72:75]
    v_mfma_f32_16x16x32_bf16 v[76:79], v[220:223], a[140:143], v[76:79]
    v_mfma_f32_16x16x32_bf16 v[64:67], v[224:227], a[144:147], v[64:67]
    v_mfma_f32_16x16x32_bf16 v[68:71], v[228:231], a[144:147], v[68:71]
    v_mfma_f32_16x16x32_bf16 v[72:75], v[232:235], a[144:147], v[72:75]
    v_mfma_f32_16x16x32_bf16 v[76:79], v[236:239], a[144:147], v[76:79]
    v_mfma_f32_16x16x32_bf16 v[64:67], v[240:243], a[148:151], v[64:67]
    v_mfma_f32_16x16x32_bf16 v[68:71], v[244:247], a[148:151], v[68:71]
    v_mfma_f32_16x16x32_bf16 v[72:75], v[248:251], a[148:151], v[72:75]
    v_mfma_f32_16x16x32_bf16 v[76:79], v[252:255], a[148:151], v[76:79]
    v_mfma_f32_16x16x32_bf16 v[64:67], a[0:3], a[152:155], v[64:67]
    v_mfma_f32_16x16x32_bf16 v[68:71], a[4:7], a[152:155], v[68:71]
    v_mfma_f32_16x16x32_bf16 v[72:75], a[8:11], a[152:155], v[72:75]
    v_mfma_f32_16x16x32_bf16 v[76:79], a[12:15], a[152:155], v[76:79]
    v_mfma_f32_16x16x32_bf16 v[64:67], a[16:19], a[156:159], v[64:67]
    v_mfma_f32_16x16x32_bf16 v[68:71], a[20:23], a[156:159], v[68:71]
    v_mfma_f32_16x16x32_bf16 v[72:75], a[24:27], a[156:159], v[72:75]
    v_mfma_f32_16x16x32_bf16 v[76:79], a[28:31], a[156:159], v[76:79]
    v_mfma_f32_16x16x32_bf16 v[64:67], a[32:35], a[160:163], v[64:67]
    v_mfma_f32_16x16x32_bf16 v[68:71], a[36:39], a[160:163], v[68:71]
    v_mfma_f32_16x16x32_bf16 v[72:75], a[40:43], a[160:163], v[72:75]
    v_mfma_f32_16x16x32_bf16 v[76:79], a[44:47], a[160:163], v[76:79]
    v_mfma_f32_16x16x32_bf16 v[64:67], a[48:51], a[164:167], v[64:67]
    v_mfma_f32_16x16x32_bf16 v[68:71], a[52:55], a[164:167], v[68:71]
    v_mfma_f32_16x16x32_bf16 v[72:75], a[56:59], a[164:167], v[72:75]
    v_mfma_f32_16x16x32_bf16 v[76:79], a[60:63], a[164:167], v[76:79]
    v_mfma_f32_16x16x32_bf16 v[64:67], a[64:67], a[168:171], v[64:67]
    v_mfma_f32_16x16x32_bf16 v[68:71], a[68:71], a[168:171], v[68:71]
    v_mfma_f32_16x16x32_bf16 v[72:75], a[72:75], a[168:171], v[72:75]
    v_mfma_f32_16x16x32_bf16 v[76:79], a[76:79], a[168:171], v[76:79]
    v_mfma_f32_16x16x32_bf16 v[64:67], a[80:83], a[172:175], v[64:67]
    v_mfma_f32_16x16x32_bf16 v[68:71], a[84:87], a[172:175], v[68:71]
    v_mfma_f32_16x16x32_bf16 v[72:75], a[88:91], a[172:175], v[72:75]
    v_mfma_f32_16x16x32_bf16 v[76:79], a[92:95], a[172:175], v[76:79]
    v_mfma_f32_16x16x32_bf16 v[64:67], a[96:99], a[176:179], v[64:67]
    v_mfma_f32_16x16x32_bf16 v[68:71], a[100:103], a[176:179], v[68:71]
    v_mfma_f32_16x16x32_bf16 v[72:75], a[104:107], a[176:179], v[72:75]
    v_mfma_f32_16x16x32_bf16 v[76:79], a[108:111], a[176:179], v[76:79]
    v_mfma_f32_16x16x32_bf16 v[64:67], a[112:115], a[180:183], v[64:67]
    v_mfma_f32_16x16x32_bf16 v[68:71], a[116:119], a[180:183], v[68:71]
    v_mfma_f32_16x16x32_bf16 v[72:75], a[120:123], a[180:183], v[72:75]
    v_mfma_f32_16x16x32_bf16 v[76:79], a[124:127], a[180:183], v[76:79]
    s_nop 7
    s_add_u32 s57, s57, 1
    v_cmp_u_f32 vcc, v64, v64
    s_cmp_ge_u32 s57, 3000
    s_cbranch_scc1 pok_44
    s_cbranch_vccnz plp_45
    s_branch pok_44
slow_pok_47:
    s_mov_b32 s57, 0
plp_48:
    s_sleep 4
    s_mov_b64 exec, vcc
    global_load_dword v15, v13, s[28:29] sc1
    s_mov_b64 exec, -1
    s_add_u32 s57, s57, 1
    s_waitcnt vmcnt(0)
    v_cmp_ne_u32 vcc, 16, v15
    s_cmp_ge_u32 s57, 400000
    s_cbranch_scc1 pok_47
    s_cbranch_vccnz plp_48
    s_branch pok_47
slow_pok_49:
    s_mov_b32 s57, 0
    v_subrev_u32 v14, s8, v149
plp_50:
    s_add_u32 m0, s73, 0
    s_nop 0
    buffer_load_dwordx4 v14, s[32:35], s66 offen offset:0 sc1 lds
    buffer_load_dwordx4 v14, s[32:35], s66 offen offset:1024 sc1 lds
    buffer_load_dwordx4 v14, s[32:35], s67 offen offset:2048 sc1 lds
    buffer_load_dwordx4 v14, s[32:35], s67 offen offset:3072 sc1 lds
    s_add_u32 m0, s73, 4096
    s_nop 0
    buffer_load_dwordx4 v14, s[32:35], s68 offen offset:0 sc1 lds
    buffer_load_dwordx4 v14, s[32:35], s68 offen offset:1024 sc1 lds
    buffer_load_dwordx4 v14, s[32:35], s69 offen offset:2048 sc1 lds
    buffer_load_dwordx4 v14, s[32:35], s69 offen offset:3072 sc1 lds
    s_waitcnt vmcnt(0)
    ds_read_b64_tr_b16 v[24:25], v16 offset:0
    ds_read_b64_tr_b16 v[26:27], v16 offset:256
    ds_read_b64_tr_b16 v[28:29], v16 offset:1024
    ds_read_b64_tr_b16 v[30:31], v16 offset:1280
    ds_read_b64_tr_b16 v[32:33], v16 offset:2048
    ds_read_b64_tr_b16 v[34:35], v16 offset:2304
    ds_read_b64_tr_b16 v[36:37], v16 offset:3072
    ds_read_b64_tr_b16 v[38:39], v16 offset:3328
    ds_read_b64_tr_b16 v[40:41], v16 offset:4096
    ds_read_b64_tr_b16 v[42:43], v16 offset:4352
    ds_read_b64_tr_b16 v[44:45], v16 offset:5120
    ds_read_b64_tr_b16 v[46:47], v16 offset:5376
    ds_read_b64_tr_b16 v[48:49], v16 offset:6144
    ds_read_b64_tr_b16 v[50:51], v16 offset:6400
    ds_read_b64_tr_b16 v[52:53], v16 offset:7168
    ds_read_b64_tr_b16 v[54:55], v16 offset:7424
    v_mov_b32 v20, 0
    v_mov_b32 v21, 0
    s_waitcnt lgkmcnt(0)
    v_dot2c_f32_bf16 v20, s48, v24
    v_dot2c_f32_bf16 v21, v24, v24
    v_dot2c_f32_bf16 v20, s48, v25
    v_dot2c_f32_bf16 v21, v25, v25
    v_dot2c_f32_bf16 v20, s48, v26
    v_dot2c_f32_bf16 v21, v26, v26
    v_dot2c_f32_bf16 v20, s48, v27
    v_dot2c_f32_bf16 v21, v27, v27
    v_dot2c_f32_bf16 v20, s48, v28
    v_dot2c_f32_bf16 v21, v28, v28
    v_dot2c_f32_bf16 v20, s48, v29
    v_dot2c_f32_bf16 v21, v29, v29
    v_dot2c_f32_bf16 v20, s48, v30
    v_dot2c_f32_bf16 v21, v30, v30
    v_dot2c_f32_bf16 v20, s48, v31
    v_dot2c_f32_bf16 v21, v31, v31
    v_dot2c_f32_bf16 v20, s48, v32
    v_dot2c_f32_bf16 v21, v32, v32
    v_dot2c_f32_bf16 v20, s48, v33
    v_dot2c_f32_bf16 v21, v33, v33
    v_dot2c_f32_bf16 v20, s48, v34
    v_dot2c_f32_bf16 v21, v34, v34
    v_dot2c_f32_bf16 v20, s48, v35
    v_dot2c_f32_bf16 v21, v35, v35
    v_dot2c_f32_bf16 v20, s48, v36
    v_dot2c_f32_bf16 v21, v36, v36
    v_dot2c_f32_bf16 v20, s48, v37
    v_dot2c_f32_bf16 v21, v37, v37
    v_dot2c_f32_bf16 v20, s48, v38
    v_dot2c_f32_bf16 v21, v38, v38
    v_dot2c_f32_bf16 v20, s48, v39
    v_dot2c_f32_bf16 v21, v39, v39
    v_dot2c_f32_bf16 v20, s48, v40
    v_dot2c_f32_bf16 v21, v40, v40
    v_dot2c_f32_bf16 v20, s48, v41
    v_dot2c_f32_bf16 v21, v41, v41
    v_dot2c_f32_bf16 v20, s48, v42
    v_dot2c_f32_bf16 v21, v42, v42
    v_dot2c_f32_bf16 v20, s48, v43
    v_dot2c_f32_bf16 v21, v43, v43
    v_dot2c_f32_bf16 v20, s48, v44
    v_dot2c_f32_bf16 v21, v44, v44
    v_dot2c_f32_bf16 v20, s48, v45
    v_dot2c_f32_bf16 v21, v45, v45
    v_dot2c_f32_bf16 v20, s48, v46
    v_dot2c_f32_bf16 v21, v46, v46
    v_dot2c_f32_bf16 v20, s48, v47
    v_dot2c_f32_bf16 v21, v47, v47
    v_dot2c_f32_bf16 v20, s48, v48
    v_dot2c_f32_bf16 v21, v48, v48
    v_dot2c_f32_bf16 v20, s48, v49
    v_dot2c_f32_bf16 v21, v49, v49
    v_dot2c_f32_bf16 v20, s48, v50
    v_dot2c_f32_bf16 v21, v50, v50
    v_dot2c_f32_bf16 v20, s48, v51
    v_dot2c_f32_bf16 v21, v51, v51
    v_dot2c_f32_bf16 v20, s48, v52
    v_dot2c_f32_bf16 v21, v52, v52
    v_dot2c_f32_bf16 v20, s48, v53
    v_dot2c_f32_bf16 v21, v53, v53
    v_dot2c_f32_bf16 v20, s48, v54
    v_dot2c_f32_bf16 v21, v54, v54
    v_dot2c_f32_bf16 v20, s48, v55
    v_dot2c_f32_bf16 v21, v55, v55
    s_add_u32 s57, s57, 1
    s_nop 1
    v_cmp_u_f32 vcc, v21, v21
    s_cmp_ge_u32 s57, 3000
    s_cbranch_scc1 pok_49
    s_cbranch_vccnz plp_50
    s_branch pok_49
slow_pok_53:
    s_mov_b32 s57, 0
plp_54:
    s_sleep 4
    s_mov_b64 exec, vcc
    global_load_dword v128, v13, s[28:29] sc1
    s_mov_b64 exec, -1
    s_add_u32 s57, s57, 1
    s_waitcnt vmcnt(0)
    v_cmp_ne_u32 vcc, 16, v128
    s_cmp_ge_u32 s57, 400000
    s_cbranch_scc1 pok_53
    s_cbranch_vccnz plp_54
    s_branch pok_53
slow_pok_56:
    s_mov_b32 s57, 0
plp_57:
    s_sleep 14
    s_mov_b64 exec, vcc
    global_load_dword v128, v153, s[28:29] sc1
    s_mov_b64 exec, -1
    s_add_u32 s57, s57, 1
    s_waitcnt vmcnt(0)
    v_cmp_ne_u32 vcc, s30, v128
    s_cmp_ge_u32 s57, 400000
    s_cbranch_scc1 pok_56
    s_cbranch_vccnz plp_57
    s_sleep 6
    s_branch pok_56
slow_pok_58:
    s_mov_b32 s57, 0
plp_59:
    s_sleep 14
    s_mov_b64 exec, vcc
    global_load_dword v128, v153, s[28:29] sc1
    s_mov_b64 exec, -1
    s_add_u32 s57, s57, 1
    s_waitcnt vmcnt(0)
    v_cmp_ne_u32 vcc, s30, v128
    s_cmp_ge_u32 s57, 400000
    s_cbranch_scc1 pok_58
    s_cbranch_vccnz plp_59
    s_sleep 6
    s_branch pok_58
slow_pok_60:
    s_mov_b32 s57, 0
plp_61:
    v_add_u32 v14, 0, v149
    v_lshlrev_b32 v16, 16, v158
    v_and_b32 v17, s76, v158
    v_lshlrev_b32 v18, 16, v159
    v_and_b32 v19, s76, v159
    global_load_dwordx4 a[128:131], v14, s[60:61] offset:0 sc1
    global_load_dwordx4 a[132:135], v14, s[60:61] offset:1024 sc1
    global_load_dwordx4 a[136:139], v14, s[60:61] offset:2048 sc1
    global_load_dwordx4 a[140:143], v14, s[60:61] offset:3072 sc1
    v_add_u32 v14, 4096, v14
    global_load_dwordx4 a[144:147], v14, s[60:61] offset:0 sc1
    global_load_dwordx4 a[148:151], v14, s[60:61] offset:1024 sc1
    global_load_dwordx4 a[152:155], v14, s[60:61] offset:2048 sc1
    global_load_dwordx4 a[156:159], v14, s[60:61] offset:3072 sc1
    v_add_u32 v14, 4096, v14
    global_load_dwordx4 a[160:163], v14, s[60:61] offset:0 sc1
    global_load_dwordx4 a[164:167], v14, s[60:61] offset:1024 sc1
    global_load_dwordx4 a[168:171], v14, s[60:61] offset:2048 sc1
    global_load_dwordx4 a[172:175], v14, s[60:61] offset:3072 sc1
    v_add_u32 v14, 4096, v14
    global_load_dwordx4 a[176:179], v14, s[60:61] offset:0 sc1
    global_load_dwordx4 a[180:183], v14, s[60:61] offset:1024 sc1
    v_add_u32 v14, 1822720, v14
    s_waitcnt vmcnt(0)
    v_mfma_f32_16x16x32_bf16 v[16:19], v[160:163], a[128:131], v[16:19]
    v_mfma_f32_16x16x32_bf16 v[20:23], v[164:167], a[128:131], 0
    v_mfma_f32_16x16x32_bf16 v[24:27], v[168:171], a[128:131], 0
    v_mfma_f32_16x16x32_bf16 v[28:31], v[172:175], a[128:131], 0
    v_mfma_f32_16x16x32_bf16 v[16:19], v[176:179], a[132:135], v[16:19]
    v_mfma_f32_16x16x32_bf16 v[20:23], v[180:183], a[132:135], v[20:23]
    v_mfma_f32_16x16x32_bf16 v[24:27], v[184:187], a[132:135], v[24:27]
    v_mfma_f32_16x16x32_bf16 v[28:31], v[188:191], a[132:135], v[28:31]
    v_mfma_f32_16x16x32_bf16 v[16:19], v[192:195], a[136:139], v[16:19]
    v_mfma_f32_16x16x32_bf16 v[20:23], v[196:199], a[136:139], v[20:23]
    v_mfma_f32_16x16x32_bf16 v[24:27], v[200:203], a[136:139], v[24:27]
    v_mfma_f32_16x16x32_bf16 v[28:31], v[204:207], a[136:139], v[28:31]
    v_mfma_f32_16x16x32_bf16 v[16:19], v[208:211], a[140:143], v[16:19]
    v_mfma_f32_16x16x32_bf16 v[20:23], v[212:215], a[140:143], v[20:23]
    v_mfma_f32_16x16x32_bf16 v[24:27], v[216:219], a[140:143], v[24:27]
    v_mfma_f32_16x16x32_bf16 v[28:31], v[220:223], a[140:143], v[28:31]
    v_mfma_f32_16x16x32_bf16 v[16:19], v[224:227], a[144:147], v[16:19]
    v_mfma_f32_16x16x32_bf16 v[20:23], v[228:231], a[144:147], v[20:23]
    v_mfma_f32_16x16x32_bf16 v[24:27], v[232:235], a[144:147], v[24:27]
    v_mfma_f32_16x16x32_bf16 v[28:31], v[236:239], a[144:147], v[28:31]
    v_mfma_f32_16x16x32_bf16 v[16:19], v[240:243], a[148:151], v[16:19]
    v_mfma_f32_16x16x32_bf16 v[20:23], v[244:247], a[148:151], v[20:23]
    v_mfma_f32_16x16x32_bf16 v[24:27], v[248:251], a[148:151], v[24:27]
    v_mfma_f32_16x16x32_bf16 v[28:31], v[252:255], a[148:151], v[28:31]
    v_mfma_f32_16x16x32_bf16 v[16:19], a[0:3], a[152:155], v[16:19]
    v_mfma_f32_16x16x32_bf16 v[20:23], a[4:7], a[152:155], v[20:23]
    v_mfma_f32_16x16x32_bf16 v[24:27], a[8:11], a[152:155], v[24:27]
    v_mfma_f32_16x16x32_bf16 v[28:31], a[12:15], a[152:155], v[28:31]
    v_mfma_f32_16x16x32_bf16 v[16:19], a[16:19], a[156:159], v[16:19]
    v_mfma_f32_16x16x32_bf16 v[20:23], a[20:23], a[156:159], v[20:23]
    v_mfma_f32_16x16x32_bf16 v[24:27], a[24:27], a[156:159], v[24:27]
    v_mfma_f32_16x16x32_bf16 v[28:31], a[28:31], a[156:159], v[28:31]
    v_mfma_f32_16x16x32_bf16 v[16:19], a[32:35], a[160:163], v[16:19]
    v_mfma_f32_16x16x32_bf16 v[20:23], a[36:39], a[160:163], v[20:23]
    v_mfma_f32_16x16x32_bf16 v[24:27], a[40:43], a[160:163], v[24:27]
    v_mfma_f32_16x16x32_bf16 v[28:31], a[44:47], a[160:163], v[28:31]
    v_mfma_f32_16x16x32_bf16 v[16:19], a[48:51], a[164:167], v[16:19]
    v_mfma_f32_16x16x32_bf16 v[20:23], a[52:55], a[164:167], v[20:23]
    v_mfma_f32_16x16x32_bf16 v[24:27], a[56:59], a[164:167], v[24:27]
    v_mfma_f32_16x16x32_bf16 v[28:31], a[60:63], a[164:167], v[28:31]
    v_mfma_f32_16x16x32_bf16 v[16:19], a[64:67], a[168:171], v[16:19]
    v_mfma_f32_16x16x32_bf16 v[20:23], a[68:71], a[168:171], v[20:23]
    v_mfma_f32_16x16x32_bf16 v[24:27], a[72:75], a[168:171], v[24:27]
    v_mfma_f32_16x16x32_bf16 v[28:31], a[76:79], a[168:171], v[28:31]
    v_mfma_f32_16x16x32_bf16 v[16:19], a[80:83], a[172:175], v[16:19]
    v_mfma_f32_16x16x32_bf16 v[20:23], a[84:87], a[172:175], v[20:23]
    v_mfma_f32_16x16x32_bf16 v[24:27], a[88:91], a[172:175], v[24:27]
    v_mfma_f32_16x16x32_bf16 v[28:31], a[92:95], a[172:175], v[28:31]
    v_mfma_f32_16x16x32_bf16 v[16:19], a[96:99], a[176:179], v[16:19]
    v_mfma_f32_16x16x32_bf16 v[20:23], a[100:103], a[176:179], v[20:23]
    v_mfma_f32_16x16x32_bf16 v[24:27], a[104:107], a[176:179], v[24:27]
    v_mfma_f32_16x16x32_bf16 v[28:31], a[108:111], a[176:179], v[28:31]
    v_mfma_f32_16x16x32_bf16 v[16:19], a[112:115], a[180:183], v[16:19]
    v_mfma_f32_16x16x32_bf16 v[20:23], a[116:119], a[180:183], v[20:23]
    v_mfma_f32_16x16x32_bf16 v[24:27], a[120:123], a[180:183], v[24:27]
    v_mfma_f32_16x16x32_bf16 v[28:31], a[124:127], a[180:183], v[28:31]
    s_nop 7
    s_add_u32 s57, s57, 1
    v_cmp_u_f32 vcc, v16, v16
    s_cmp_ge_u32 s57, 3000
    s_cbranch_scc1 pok_60
    s_cbranch_vccnz plp_61
    s_branch pok_60
slow_pok_62:
    s_mov_b32 s57, 0
plp_63:
    s_sleep 14
    s_mov_b64 exec, vcc
    global_load_dword v128, v153, s[28:29] sc1
    s_mov_b64 exec, -1
    s_add_u32 s57, s57, 1
    s_waitcnt vmcnt(0)
    v_cmp_ne_u32 vcc, s30, v128
    s_cmp_ge_u32 s57, 400000
    s_cbranch_scc1 pok_62
    s_cbranch_vccnz plp_63
    s_sleep 6
    s_branch pok_62
slow_pok_64:
    s_mov_b32 s57, 0
plp_65:
    v_add_u32 v14, 1835008, v149
    v_lshlrev_b32 v32, 16, v130
    v_and_b32 v33, s76, v130
    v_lshlrev_b32 v34, 16, v131
    v_and_b32 v35, s76, v131
    global_load_dwordx4 a[184:187], v14, s[60:61] offset:0 sc1
    global_load_dwordx4 a[188:191], v14, s[60:61] offset:1024 sc1
    global_load_dwordx4 a[192:195], v14, s[60:61] offset:2048 sc1
    global_load_dwordx4 a[196:199], v14, s[60:61] offset:3072 sc1
    v_add_u32 v14, 4096, v14
    global_load_dwordx4 a[200:203], v14, s[60:61] offset:0 sc1
    global_load_dwordx4 a[204:207], v14, s[60:61] offset:1024 sc1
    global_load_dwordx4 a[208:211], v14, s[60:61] offset:2048 sc1
    global_load_dwordx4 a[212:215], v14, s[60:61] offset:3072 sc1
    v_add_u32 v14, 4096, v14
    global_load_dwordx4 a[216:219], v14, s[60:61] offset:0 sc1
    global_load_dwordx4 a[220:223], v14, s[60:61] offset:1024 sc1
    global_load_dwordx4 a[224:227], v14, s[60:61] offset:2048 sc1
    global_load_dwordx4 a[228:231], v14, s[60:61] offset:3072 sc1
    v_add_u32 v14, 4096, v14
    global_load_dwordx4 a[232:235], v14, s[60:61] offset:0 sc1
    global_load_dwordx4 a[236:239], v14, s[60:61] offset:1024 sc1
    v_add_u32 v14, 1822720, v14
    s_waitcnt vmcnt(0)
    v_mfma_f32_16x16x32_bf16 v[32:35], v[160:163], a[184:187], v[32:35]
    v_mfma_f32_16x16x32_bf16 v[36:39], v[164:167], a[184:187], 0
    v_mfma_f32_16x16x32_bf16 v[40:43], v[168:171], a[184:187], 0
    v_mfma_f32_16x16x32_bf16 v[44:47], v[172:175], a[184:187], 0
    v_mfma_f32_16x16x32_bf16 v[32:35], v[176:179], a[188:191], v[32:35]
    v_mfma_f32_16x16x32_bf16 v[36:39], v[180:183], a[188:191], v[36:39]
    v_mfma_f32_16x16x32_bf16 v[40:43], v[184:187], a[188:191], v[40:43]
    v_mfma_f32_16x16x32_bf16 v[44:47], v[188:191], a[188:191], v[44:47]
    v_mfma_f32_16x16x32_bf16 v[32:35], v[192:195], a[192:195], v[32:35]
    v_mfma_f32_16x16x32_bf16 v[36:39], v[196:199], a[192:195], v[36:39]
    v_mfma_f32_16x16x32_bf16 v[40:43], v[200:203], a[192:195], v[40:43]
    v_mfma_f32_16x16x32_bf16 v[44:47], v[204:207], a[192:195], v[44:47]
    v_mfma_f32_16x16x32_bf16 v[32:35], v[208:211], a[196:199], v[32:35]
    v_mfma_f32_16x16x32_bf16 v[36:39], v[212:215], a[196:199], v[36:39]
    v_mfma_f32_16x16x32_bf16 v[40:43], v[216:219], a[196:199], v[40:43]
    v_mfma_f32_16x16x32_bf16 v[44:47], v[220:223], a[196:199], v[44:47]
    v_mfma_f32_16x16x32_bf16 v[32:35], v[224:227], a[200:203], v[32:35]
    v_mfma_f32_16x16x32_bf16 v[36:39], v[228:231], a[200:203], v[36:39]
    v_mfma_f32_16x16x32_bf16 v[40:43], v[232:235], a[200:203], v[40:43]
    v_mfma_f32_16x16x32_bf16 v[44:47], v[236:239], a[200:203], v[44:47]
    v_mfma_f32_16x16x32_bf16 v[32:35], v[240:243], a[204:207], v[32:35]
    v_mfma_f32_16x16x32_bf16 v[36:39], v[244:247], a[204:207], v[36:39]
    v_mfma_f32_16x16x32_bf16 v[40:43], v[248:251], a[204:207], v[40:43]
    v_mfma_f32_16x16x32_bf16 v[44:47], v[252:255], a[204:207], v[44:47]
    v_mfma_f32_16x16x32_bf16 v[32:35], a[0:3], a[208:211], v[32:35]
    v_mfma_f32_16x16x32_bf16 v[36:39], a[4:7], a[208:211], v[36:39]
    v_mfma_f32_16x16x32_bf16 v[40:43], a[8:11], a[208:211], v[40:43]
    v_mfma_f32_16x16x32_bf16 v[44:47], a[12:15], a[208:211], v[44:47]
    v_mfma_f32_16x16x32_bf16 v[32:35], a[16:19], a[212:215], v[32:35]
    v_mfma_f32_16x16x32_bf16 v[36:39], a[20:23], a[212:215], v[36:39]
    v_mfma_f32_16x16x32_bf16 v[40:43], a[24:27], a[212:215], v[40:43]
    v_mfma_f32_16x16x32_bf16 v[44:47], a[28:31], a[212:215], v[44:47]
    v_mfma_f32_16x16x32_bf16 v[32:35], a[32:35], a[216:219], v[32:35]
    v_mfma_f32_16x16x32_bf16 v[36:39], a[36:39], a[216:219], v[36:39]
    v_mfma_f32_16x16x32_bf16 v[40:43], a[40:43], a[216:219], v[40:43]
    v_mfma_f32_16x16x32_bf16 v[44:47], a[44:47], a[216:219], v[44:47]
    v_mfma_f32_16x16x32_bf16 v[32:35], a[48:51], a[220:223], v[32:35]
    v_mfma_f32_16x16x32_bf16 v[36:39], a[52:55], a[220:223], v[36:39]
    v_mfma_f32_16x16x32_bf16 v[40:43], a[56:59], a[220:223], v[40:43]
    v_mfma_f32_16x16x32_bf16 v[44:47], a[60:63], a[220:223], v[44:47]
    v_mfma_f32_16x16x32_bf16 v[32:35], a[64:67], a[224:227], v[32:35]
    v_mfma_f32_16x16x32_bf16 v[36:39], a[68:71], a[224:227], v[36:39]
    v_mfma_f32_16x16x32_bf16 v[40:43], a[72:75], a[224:227], v[40:43]
    v_mfma_f32_16x16x32_bf16 v[44:47], a[76:79], a[224:227], v[44:47]
    v_mfma_f32_16x16x32_bf16 v[32:35], a[80:83], a[228:231], v[32:35]
    v_mfma_f32_16x16x32_bf16 v[36:39], a[84:87], a[228:231], v[36:39]
    v_mfma_f32_16x16x32_bf16 v[40:43], a[88:91], a[228:231], v[40:43]
    v_mfma_f32_16x16x32_bf16 v[44:47], a[92:95], a[228:231], v[44:47]
    v_mfma_f32_16x16x32_bf16 v[32:35], a[96:99], a[232:235], v[32:35]
    v_mfma_f32_16x16x32_bf16 v[36:39], a[100:103], a[232:235], v[36:39]
    v_mfma_f32_16x16x32_bf16 v[40:43], a[104:107], a[232:235], v[40:43]
    v_mfma_f32_16x16x32_bf16 v[44:47], a[108:111], a[232:235], v[44:47]
    v_mfma_f32_16x16x32_bf16 v[32:35], a[112:115], a[236:239], v[32:35]
    v_mfma_f32_16x16x32_bf16 v[36:39], a[116:119], a[236:239], v[36:39]
    v_mfma_f32_16x16x32_bf16 v[40:43], a[120:123], a[236:239], v[40:43]
    v_mfma_f32_16x16x32_bf16 v[44:47], a[124:127], a[236:239], v[44:47]
    s_nop 7
    s_add_u32 s57, s57, 1
    v_cmp_u_f32 vcc, v32, v32
    s_cmp_ge_u32 s57, 3000
    s_cbranch_scc1 pok_64
    s_cbranch_vccnz plp_65
    s_branch pok_64
slow_pok_66:
    s_mov_b32 s57, 0
plp_67:
    s_sleep 14
    s_mov_b64 exec, vcc
    global_load_dword v128, v153, s[28:29] sc1
    s_mov_b64 exec, -1
    s_add_u32 s57, s57, 1
    s_waitcnt vmcnt(0)
    v_cmp_ne_u32 vcc, s30, v128
    s_cmp_ge_u32 s57, 400000
    s_cbranch_scc1 pok_66
    s_cbranch_vccnz plp_67
    s_sleep 6
    s_branch pok_66
slow_pok_68:
    s_mov_b32 s57, 0
plp_69:
    v_add_u32 v14, 3670016, v149
    v_lshlrev_b32 v48, 16, v10
    v_and_b32 v49, s76, v10
    v_lshlrev_b32 v50, 16, v11
    v_and_b32 v51, s76, v11
    global_load_dwordx4 v[80:83], v14, s[60:61] offset:0 sc1
    global_load_dwordx4 v[84:87], v14, s[60:61] offset:1024 sc1
    global_load_dwordx4 v[88:91], v14, s[60:61] offset:2048 sc1
    global_load_dwordx4 v[92:95], v14, s[60:61] offset:3072 sc1
    v_add_u32 v14, 4096, v14
    global_load_dwordx4 v[96:99], v14, s[60:61] offset:0 sc1
    global_load_dwordx4 v[100:103], v14, s[60:61] offset:1024 sc1
    global_load_dwordx4 v[104:107], v14, s[60:61] offset:2048 sc1
    global_load_dwordx4 v[108:111], v14, s[60:61] offset:3072 sc1
    v_add_u32 v14, 4096, v14
    global_load_dwordx4 v[112:115], v14, s[60:61] offset:0 sc1
    global_load_dwordx4 v[116:119], v14, s[60:61] offset:1024 sc1
    global_load_dwordx4 v[120:123], v14, s[60:61] offset:2048 sc1
    global_load_dwordx4 a[240:243], v14, s[60:61] offset:3072 sc1
    v_add_u32 v14, 4096, v14
    global_load_dwordx4 a[244:247], v14, s[60:61] offset:0 sc1
    global_load_dwordx4 a[248:251], v14, s[60:61] offset:1024 sc1
    v_add_u32 v14, 1822720, v14
    s_waitcnt vmcnt(0)
    v_mfma_f32_16x16x32_bf16 v[48:51], v[160:163], v[80:83], v[48:51]
    v_mfma_f32_16x16x32_bf16 v[52:55], v[164:167], v[80:83], 0
    v_mfma_f32_16x16x32_bf16 v[56:59], v[168:171], v[80:83], 0
    v_mfma_f32_16x16x32_bf16 v[60:63], v[172:175], v[80:83], 0
    v_mfma_f32_16x16x32_bf16 v[48:51], v[176:179], v[84:87], v[48:51]
    v_mfma_f32_16x16x32_bf16 v[52:55], v[180:183], v[84:87], v[52:55]
    v_mfma_f32_16x16x32_bf16 v[56:59], v[184:187], v[84:87], v[56:59]
    v_mfma_f32_16x16x32_bf16 v[60:63], v[188:191], v[84:87], v[60:63]
    v_mfma_f32_16x16x32_bf16 v[48:51], v[192:195], v[88:91], v[48:51]
    v_mfma_f32_16x16x32_bf16 v[52:55], v[196:199], v[88:91], v[52:55]
    v_mfma_f32_16x16x32_bf16 v[56:59], v[200:203], v[88:91], v[56:59]
    v_mfma_f32_16x16x32_bf16 v[60:63], v[204:207], v[88:91], v[60:63]
    v_mfma_f32_16x16x32_bf16 v[48:51], v[208:211], v[92:95], v[48:51]
    v_mfma_f32_16x16x32_bf16 v[52:55], v[212:215], v[92:95], v[52:55]
    v_mfma_f32_16x16x32_bf16 v[56:59], v[216:219], v[92:95], v[56:59]
    v_mfma_f32_16x16x32_bf16 v[60:63], v[220:223], v[92:95], v[60:63]
    v_mfma_f32_16x16x32_bf16 v[48:51], v[224:227], v[96:99], v[48:51]
    v_mfma_f32_16x16x32_bf16 v[52:55], v[228:231], v[96:99], v[52:55]
    v_mfma_f32_16x16x32_bf16 v[56:59], v[232:235], v[96:99], v[56:59]
    v_mfma_f32_16x16x32_bf16 v[60:63], v[236:239], v[96:99], v[60:63]
    v_mfma_f32_16x16x32_bf16 v[48:51], v[240:243], v[100:103], v[48:51]
    v_mfma_f32_16x16x32_bf16 v[52:55], v[244:247], v[100:103], v[52:55]
    v_mfma_f32_16x16x32_bf16 v[56:59], v[248:251], v[100:103], v[56:59]
    v_mfma_f32_16x16x32_bf16 v[60:63], v[252:255], v[100:103], v[60:63]
    v_mfma_f32_16x16x32_bf16 v[48:51], a[0:3], v[104:107], v[48:51]
    v_mfma_f32_16x16x32_bf16 v[52:55], a[4:7], v[104:107], v[52:55]
    v_mfma_f32_16x16x32_bf16 v[56:59], a[8:11], v[104:107], v[56:59]
    v_mfma_f32_16x16x32_bf16 v[60:63], a[12:15], v[104:107], v[60:63]
    v_mfma_f32_16x16x32_bf16 v[48:51], a[16:19], v[108:111], v[48:51]
    v_mfma_f32_16x16x32_bf16 v[52:55], a[20:23], v[108:111], v[52:55]
    v_mfma_f32_16x16x32_bf16 v[56:59], a[24:27], v[108:111], v[56:59]
    v_mfma_f32_16x16x32_bf16 v[60:63], a[28:31], v[108:111], v[60:63]
    v_mfma_f32_16x16x32_bf16 v[48:51], a[32:35], v[112:115], v[48:51]
    v_mfma_f32_16x16x32_bf16 v[52:55], a[36:39], v[112:115], v[52:55]
    v_mfma_f32_16x16x32_bf16 v[56:59], a[40:43], v[112:115], v[56:59]
    v_mfma_f32_16x16x32_bf16 v[60:63], a[44:47], v[112:115], v[60:63]
    v_mfma_f32_16x16x32_bf16 v[48:51], a[48:51], v[116:119], v[48:51]
    v_mfma_f32_16x16x32_bf16 v[52:55], a[52:55], v[116:119], v[52:55]
    v_mfma_f32_16x16x32_bf16 v[56:59], a[56:59], v[116:119], v[56:59]
    v_mfma_f32_16x16x32_bf16 v[60:63], a[60:63], v[116:119], v[60:63]
    v_mfma_f32_16x16x32_bf16 v[48:51], a[64:67], v[120:123], v[48:51]
    v_mfma_f32_16x16x32_bf16 v[52:55], a[68:71], v[120:123], v[52:55]
    v_mfma_f32_16x16x32_bf16 v[56:59], a[72:75], v[120:123], v[56:59]
    v_mfma_f32_16x16x32_bf16 v[60:63], a[76:79], v[120:123], v[60:63]
    v_mfma_f32_16x16x32_bf16 v[48:51], a[80:83], a[240:243], v[48:51]
    v_mfma_f32_16x16x32_bf16 v[52:55], a[84:87], a[240:243], v[52:55]
    v_mfma_f32_16x16x32_bf16 v[56:59], a[88:91], a[240:243], v[56:59]
    v_mfma_f32_16x16x32_bf16 v[60:63], a[92:95], a[240:243], v[60:63]
    v_mfma_f32_16x16x32_bf16 v[48:51], a[96:99], a[244:247], v[48:51]
    v_mfma_f32_16x16x32_bf16 v[52:55], a[100:103], a[244:247], v[52:55]
    v_mfma_f32_16x16x32_bf16 v[56:59], a[104:107], a[244:247], v[56:59]
    v_mfma_f32_16x16x32_bf16 v[60:63], a[108:111], a[244:247], v[60:63]
    v_mfma_f32_16x16x32_bf16 v[48:51], a[112:115], a[248:251], v[48:51]
    v_mfma_f32_16x16x32_bf16 v[52:55], a[116:119], a[248:251], v[52:55]
    v_mfma_f32_16x16x32_bf16 v[56:59], a[120:123], a[248:251], v[56:59]
    v_mfma_f32_16x16x32_bf16 v[60:63], a[124:127], a[248:251], v[60:63]
    s_nop 7
    s_add_u32 s57, s57, 1
    v_cmp_u_f32 vcc, v48, v48
    s_cmp_ge_u32 s57, 3000
    s_cbranch_scc1 pok_68
    s_cbranch_vccnz plp_69
    s_branch pok_68
slow_pok_70:
    s_mov_b32 s57, 0
plp_71:
    v_add_u32 v14, 5505024, v149
    v_lshlrev_b32 v64, 16, v12
    v_and_b32 v65, s76, v12
    v_lshlrev_b32 v66, 16, v13
    v_and_b32 v67, s76, v13
    global_load_dwordx4 a[128:131], v14, s[60:61] offset:0 sc1
    global_load_dwordx4 a[132:135], v14, s[60:61] offset:1024 sc1
    global_load_dwordx4 a[136:139], v14, s[60:61] offset:2048 sc1
    global_load_dwordx4 a[140:143], v14, s[60:61] offset:3072 sc1
    v_add_u32 v14, 4096, v14
    global_load_dwordx4 a[144:147], v14, s[60:61] offset:0 sc1
    global_load_dwordx4 a[148:151], v14, s[60:61] offset:1024 sc1
    global_load_dwordx4 a[152:155], v14, s[60:61] offset:2048 sc1
    global_load_dwordx4 a[156:159], v14, s[60:61] offset:3072 sc1
    v_add_u32 v14, 4096, v14
    global_load_dwordx4 a[160:163], v14, s[60:61] offset:0 sc1
    global_load_dwordx4 a[164:167], v14, s[60:61] offset:1024 sc1
    global_load_dwordx4 a[168:171], v14, s[60:61] offset:2048 sc1
    global_load_dwordx4 a[172:175], v14, s[60:61] offset:3072 sc1
    v_add_u32 v14, 4096, v14
    global_load_dwordx4 a[176:179], v14, s[60:61] offset:0 sc1
    global_load_dwordx4 a[180:183], v14, s[60:61] offset:1024 sc1
    v_add_u32 v14, 1822720, v14
    s_waitcnt vmcnt(0)
    v_mfma_f32_16x16x32_bf16 v[64:67], v[160:163], a[128:131], v[64:67]
    v_mfma_f32_16x16x32_bf16 v[68:71], v[164:167], a[128:131], 0
    v_mfma_f32_16x16x32_bf16 v[72:75], v[168:171], a[128:131], 0
    v_mfma_f32_16x16x32_bf16 v[76:79], v[172:175], a[128:131], 0
    v_mfma_f32_16x16x32_bf16 v[64:67], v[176:179], a[132:135], v[64:67]
    v_mfma_f32_16x16x32_bf16 v[68:71], v[180:183], a[132:135], v[68:71]
    v_mfma_f32_16x16x32_bf16 v[72:75], v[184:187], a[132:135], v[72:75]
    v_mfma_f32_16x16x32_bf16 v[76:79], v[188:191], a[132:135], v[76:79]
    v_mfma_f32_16x16x32_bf16 v[64:67], v[192:195], a[136:139], v[64:67]
    v_mfma_f32_16x16x32_bf16 v[68:71], v[196:199], a[136:139], v[68:71]
    v_mfma_f32_16x16x32_bf16 v[72:75], v[200:203], a[136:139], v[72:75]
    v_mfma_f32_16x16x32_bf16 v[76:79], v[204:207], a[136:139], v[76:79]
    v_mfma_f32_16x16x32_bf16 v[64:67], v[208:211], a[140:143], v[64:67]
    v_mfma_f32_16x16x32_bf16 v[68:71], v[212:215], a[140:143], v[68:71]
    v_mfma_f32_16x16x32_bf16 v[72:75], v[216:219], a[140:143], v[72:75]
    v_mfma_f32_16x16x32_bf16 v[76:79], v[220:223], a[140:143], v[76:79]
    v_mfma_f32_16x16x32_bf16 v[64:67], v[224:227], a[144:147], v[64:67]
    v_mfma_f32_16x16x32_bf16 v[68:71], v[228:231], a[144:147], v[68:71]
    v_mfma_f32_16x16x32_bf16 v[72:75], v[232:235], a[144:147], v[72:75]
    v_mfma_f32_16x16x32_bf16 v[76:79], v[236:239], a[144:147], v[76:79]
    v_mfma_f32_16x16x32_bf16 v[64:67], v[240:243], a[148:151], v[64:67]
    v_mfma_f32_16x16x32_bf16 v[68:71], v[244:247], a[148:151], v[68:71]
    v_mfma_f32_16x16x32_bf16 v[72:75], v[248:251], a[148:151], v[72:75]
    v_mfma_f32_16x16x32_bf16 v[76:79], v[252:255], a[148:151], v[76:79]
    v_mfma_f32_16x16x32_bf16 v[64:67], a[0:3], a[152:155], v[64:67]
    v_mfma_f32_16x16x32_bf16 v[68:71], a[4:7], a[152:155], v[68:71]
    v_mfma_f32_16x16x32_bf16 v[72:75], a[8:11], a[152:155], v[72:75]
    v_mfma_f32_16x16x32_bf16 v[76:79], a[12:15], a[152:155], v[76:79]
    v_mfma_f32_16x16x32_bf16 v[64:67], a[16:19], a[156:159], v[64:67]
    v_mfma_f32_16x16x32_bf16 v[68:71], a[20:23], a[156:159], v[68:71]
    v_mfma_f32_16x16x32_bf16 v[72:75], a[24:27], a[156:159], v[72:75]
    v_mfma_f32_16x16x32_bf16 v[76:79], a[28:31], a[156:159], v[76:79]
    v_mfma_f32_16x16x32_bf16 v[64:67], a[32:35], a[160:163], v[64:67]
    v_mfma_f32_16x16x32_bf16 v[68:71], a[36:39], a[160:163], v[68:71]
    v_mfma_f32_16x16x32_bf16 v[72:75], a[40:43], a[160:163], v[72:75]
    v_mfma_f32_16x16x32_bf16 v[76:79], a[44:47], a[160:163], v[76:79]
    v_mfma_f32_16x16x32_bf16 v[64:67], a[48:51], a[164:167], v[64:67]
    v_mfma_f32_16x16x32_bf16 v[68:71], a[52:55], a[164:167], v[68:71]
    v_mfma_f32_16x16x32_bf16 v[72:75], a[56:59], a[164:167], v[72:75]
    v_mfma_f32_16x16x32_bf16 v[76:79], a[60:63], a[164:167], v[76:79]
    v_mfma_f32_16x16x32_bf16 v[64:67], a[64:67], a[168:171], v[64:67]
    v_mfma_f32_16x16x32_bf16 v[68:71], a[68:71], a[168:171], v[68:71]
    v_mfma_f32_16x16x32_bf16 v[72:75], a[72:75], a[168:171], v[72:75]
    v_mfma_f32_16x16x32_bf16 v[76:79], a[76:79], a[168:171], v[76:79]
    v_mfma_f32_16x16x32_bf16 v[64:67], a[80:83], a[172:175], v[64:67]
    v_mfma_f32_16x16x32_bf16 v[68:71], a[84:87], a[172:175], v[68:71]
    v_mfma_f32_16x16x32_bf16 v[72:75], a[88:91], a[172:175], v[72:75]
    v_mfma_f32_16x16x32_bf16 v[76:79], a[92:95], a[172:175], v[76:79]
    v_mfma_f32_16x16x32_bf16 v[64:67], a[96:99], a[176:179], v[64:67]
    v_mfma_f32_16x16x32_bf16 v[68:71], a[100:103], a[176:179], v[68:71]
    v_mfma_f32_16x16x32_bf16 v[72:75], a[104:107], a[176:179], v[72:75]
    v_mfma_f32_16x16x32_bf16 v[76:79], a[108:111], a[176:179], v[76:79]
    v_mfma_f32_16x16x32_bf16 v[64:67], a[112:115], a[180:183], v[64:67]
    v_mfma_f32_16x16x32_bf16 v[68:71], a[116:119], a[180:183], v[68:71]
    v_mfma_f32_16x16x32_bf16 v[72:75], a[120:123], a[180:183], v[72:75]
    v_mfma_f32_16x16x32_bf16 v[76:79], a[124:127], a[180:183], v[76:79]
    s_nop 7
    s_add_u32 s57, s57, 1
    v_cmp_u_f32 vcc, v64, v64
    s_cmp_ge_u32 s57, 3000
    s_cbranch_scc1 pok_70
    s_cbranch_vccnz plp_71
    s_branch pok_70
L_end:
    s_endpgm
.section .rodata,"a"
.p2align 6
.amdhsa_kernel sequential_preLN__ssm_conv_h3__glu_gated_glu__prompt_kernel
  .amdhsa_next_free_vgpr 512
  .amdhsa_next_free_sgpr 102
  .amdhsa_accum_offset 256
  .amdhsa_group_segment_fixed_size 0
  .amdhsa_kernarg_size 104
  .amdhsa_user_sgpr_count 2
  .amdhsa_user_sgpr_kernarg_segment_ptr 1
  .amdhsa_system_sgpr_workgroup_id_x 1
  .amdhsa_float_denorm_mode_32 3
  .amdhsa_float_denorm_mode_16_64 3
.end_amdhsa_kernel
```
